```python
import torch

def _softmax(x, axis=-1):
    return torch.softmax(x, dim=axis)
def _gelu(x):
    return torch.nn.functional.gelu(x, approximate="tanh")
def _silu(x):
    return torch.nn.functional.silu(x)
def _sigmoid(x):
    return torch.sigmoid(x)
def _layernorm(x, axis=-1, eps=1e-5):
    m = x.mean(dim=axis, keepdim=True)
    v = x.var(dim=axis, keepdim=True, unbiased=False)
    return (x - m) / torch.sqrt(v + eps)
def _scatter_add(tgt, idx, src, axis=0):
    return tgt.clone().index_add_(axis, idx, src)
def _segment_sum(src, seg, n):
    out = torch.zeros((n,) + src.shape[1:], dtype=src.dtype)
    return out.index_add_(0, seg, src)
def _pad(x, pw):
    flat = tuple(v for pair in reversed(pw) for v in pair)
    return torch.nn.functional.pad(x, flat)

kernel_name = 'standalone__geglu_ffn__prompt'

def setup_inputs():

    _w = (lambda a: (lambda t: t.to(torch.bfloat16) if t.is_floating_point() else t)(torch.as_tensor(a)))
    B, S, D, F = 1, 2048, 1024, 3584
    return {
        "x": _w((lambda *s: torch.randn(*s, dtype=torch.bfloat16) * 0.05)(B, S, D)),
        "w_gate": _w((lambda *s: torch.randn(*s, dtype=torch.bfloat16) * 0.05)(D, F)),
        "w_up": _w((lambda *s: torch.randn(*s, dtype=torch.bfloat16) * 0.05)(D, F)),
        "w_down": _w((lambda *s: torch.randn(*s, dtype=torch.bfloat16) * 0.05)(F, D)),
    }

def reference(x, w_gate, w_up, w_down):
    return (_gelu(x @ w_gate) * (x @ w_up)) @ w_down
```

```asm
; @launch kernel=k1_kernel grid=(256,1,1) block=(512,1,1) lds=156672
.amdgcn_target "amdgcn-amd-amdhsa--gfx950"
.text
.globl k1_kernel
.p2align 8
.type k1_kernel,@function
k1_kernel:

    s_cmp_ge_u32 s2, 256
    s_cbranch_scc1 K1_DONE
    s_load_dwordx4 s[4:7], s[0:1], 0
    s_load_dwordx2 s[8:9], s[0:1], 16
    s_load_dwordx2 s[10:11], s[0:1], 48
    s_load_dwordx2 s[56:57], s[0:1], 24
    v_lshrrev_b32 v1, 6, v0
    v_and_b32 v2, 63, v0
    s_nop 0
    v_readfirstlane_b32 s24, v1
    s_and_b32 s25, s2, 7
    s_lshr_b32 s26, s2, 3
    s_lshl_b32 s25, s25, 2
    s_and_b32 s32, s26, 3
    s_add_u32 s25, s25, s32
    s_lshr_b32 s26, s26, 2
    s_lshr_b32 s27, s24, 2
    s_and_b32 s28, s24, 3

    v_and_b32 v3, 15, v2
    v_lshrrev_b32 v4, 4, v2

    s_lshl_b32 s32, s28, 13
    v_lshlrev_b32 v5, 7, v3
    v_add_u32 v5, s32, v5
    v_and_b32 v7, 7, v3
    v_xor_b32 v8, v4, v7
    v_lshlrev_b32 v8, 4, v8
    v_add_u32 v28, v5, v8
    v_xor_b32 v29, 64, v28

    v_lshrrev_b32 v9, 1, v4
    v_lshlrev_b32 v9, 4, v9
    v_and_b32 v10, 1, v4
    v_lshlrev_b32 v10, 2, v10
    v_add_u32 v9, v9, v10
    v_lshrrev_b32 v10, 2, v2
    v_and_b32 v10, 3, v10
    v_add_u32 v9, v9, v10
    v_mul_u32_u24 v9, 224, v9
    v_and_b32 v10, 3, v2
    v_lshlrev_b32 v10, 3, v10
    v_add_u32 v9, v9, v10
    v_add_u32 v9, 98304, v9
    s_and_b32 s32, s25, 1

    s_cmp_eq_u32 s27, 0
    s_cbranch_scc0 K1_T1J
    s_mul_i32 s33, s32, 3
    s_mov_b32 s34, 0
    s_branch K1_JDONE
K1_T1J:
    s_cmp_eq_u32 s32, 0
    s_cselect_b32 s33, 4, 1
    s_cselect_b32 s34, 6, 0
K1_JDONE:
    s_lshl_b32 s35, s33, 5
    s_lshl_b32 s36, s34, 5
    v_add_u32 v7, s35, v9
    v_add_u32 v8, s36, v9

    s_mul_i32 s37, s25, 224
    s_and_b32 s32, s24, 1
    s_mul_i32 s32, s32, 448
    s_movk_i32 s38, 4682

    v_add_u32 v17, 0, v2
    v_add_u32 v17, s32, v17
    v_mul_lo_u32 v18, v17, s38
    v_lshrrev_b32 v18, 16, v18
    v_mul_u32_u24 v19, 14, v18
    v_sub_u32 v19, v17, v19
    v_and_b32 v20, 0x33, v18
    v_and_b32 v21, 4, v18
    v_lshlrev_b32 v21, 1, v21
    v_or_b32 v20, v20, v21
    v_and_b32 v21, 8, v18
    v_lshrrev_b32 v21, 1, v21
    v_or_b32 v20, v20, v21
    v_mul_u32_u24 v20, 7168, v20
    v_lshlrev_b32 v19, 4, v19
    v_add_u32 v20, v20, v19
    v_add_u32 v10, s37, v20

    v_add_u32 v17, 64, v2
    v_add_u32 v17, s32, v17
    v_mul_lo_u32 v18, v17, s38
    v_lshrrev_b32 v18, 16, v18
    v_mul_u32_u24 v19, 14, v18
    v_sub_u32 v19, v17, v19
    v_and_b32 v20, 0x33, v18
    v_and_b32 v21, 4, v18
    v_lshlrev_b32 v21, 1, v21
    v_or_b32 v20, v20, v21
    v_and_b32 v21, 8, v18
    v_lshrrev_b32 v21, 1, v21
    v_or_b32 v20, v20, v21
    v_mul_u32_u24 v20, 7168, v20
    v_lshlrev_b32 v19, 4, v19
    v_add_u32 v20, v20, v19
    v_add_u32 v11, s37, v20

    v_add_u32 v17, 128, v2
    v_add_u32 v17, s32, v17
    v_mul_lo_u32 v18, v17, s38
    v_lshrrev_b32 v18, 16, v18
    v_mul_u32_u24 v19, 14, v18
    v_sub_u32 v19, v17, v19
    v_and_b32 v20, 0x33, v18
    v_and_b32 v21, 4, v18
    v_lshlrev_b32 v21, 1, v21
    v_or_b32 v20, v20, v21
    v_and_b32 v21, 8, v18
    v_lshrrev_b32 v21, 1, v21
    v_or_b32 v20, v20, v21
    v_mul_u32_u24 v20, 7168, v20
    v_lshlrev_b32 v19, 4, v19
    v_add_u32 v20, v20, v19
    v_add_u32 v12, s37, v20

    v_add_u32 v17, 192, v2
    v_add_u32 v17, s32, v17
    v_mul_lo_u32 v18, v17, s38
    v_lshrrev_b32 v18, 16, v18
    v_mul_u32_u24 v19, 14, v18
    v_sub_u32 v19, v17, v19
    v_and_b32 v20, 0x33, v18
    v_and_b32 v21, 4, v18
    v_lshlrev_b32 v21, 1, v21
    v_or_b32 v20, v20, v21
    v_and_b32 v21, 8, v18
    v_lshrrev_b32 v21, 1, v21
    v_or_b32 v20, v20, v21
    v_mul_u32_u24 v20, 7168, v20
    v_lshlrev_b32 v19, 4, v19
    v_add_u32 v20, v20, v19
    v_add_u32 v13, s37, v20

    v_add_u32 v17, 256, v2
    v_add_u32 v17, s32, v17
    v_mul_lo_u32 v18, v17, s38
    v_lshrrev_b32 v18, 16, v18
    v_mul_u32_u24 v19, 14, v18
    v_sub_u32 v19, v17, v19
    v_and_b32 v20, 0x33, v18
    v_and_b32 v21, 4, v18
    v_lshlrev_b32 v21, 1, v21
    v_or_b32 v20, v20, v21
    v_and_b32 v21, 8, v18
    v_lshrrev_b32 v21, 1, v21
    v_or_b32 v20, v20, v21
    v_mul_u32_u24 v20, 7168, v20
    v_lshlrev_b32 v19, 4, v19
    v_add_u32 v20, v20, v19
    v_add_u32 v14, s37, v20

    v_add_u32 v17, 320, v2
    v_add_u32 v17, s32, v17
    v_mul_lo_u32 v18, v17, s38
    v_lshrrev_b32 v18, 16, v18
    v_mul_u32_u24 v19, 14, v18
    v_sub_u32 v19, v17, v19
    v_and_b32 v20, 0x33, v18
    v_and_b32 v21, 4, v18
    v_lshlrev_b32 v21, 1, v21
    v_or_b32 v20, v20, v21
    v_and_b32 v21, 8, v18
    v_lshrrev_b32 v21, 1, v21
    v_or_b32 v20, v20, v21
    v_mul_u32_u24 v20, 7168, v20
    v_lshlrev_b32 v19, 4, v19
    v_add_u32 v20, v20, v19
    v_add_u32 v15, s37, v20

    v_add_u32 v17, 384, v2
    v_add_u32 v17, s32, v17
    v_mul_lo_u32 v18, v17, s38
    v_lshrrev_b32 v18, 16, v18
    v_mul_u32_u24 v19, 14, v18
    v_sub_u32 v19, v17, v19
    v_and_b32 v20, 0x33, v18
    v_and_b32 v21, 4, v18
    v_lshlrev_b32 v21, 1, v21
    v_or_b32 v20, v20, v21
    v_and_b32 v21, 8, v18
    v_lshrrev_b32 v21, 1, v21
    v_or_b32 v20, v20, v21
    v_mul_u32_u24 v20, 7168, v20
    v_lshlrev_b32 v19, 4, v19
    v_add_u32 v20, v20, v19
    v_add_u32 v16, s37, v20

    s_lshl_b32 s39, s26, 8
    s_lshl_b32 s32, s28, 6
    s_add_u32 s39, s39, s32
    v_lshrrev_b32 v17, 3, v2
    v_add_u32 v18, s39, v17
    v_lshlrev_b32 v18, 11, v18
    v_and_b32 v19, 7, v2
    v_xor_b32 v19, v19, v17
    v_lshlrev_b32 v19, 4, v19
    v_add_u32 v22, v18, v19

    s_lshr_b32 s32, s39, 4
    s_mul_i32 s32, s32, 114688
    v_lshlrev_b32 v17, 4, v2
    v_add_u32 v17, s32, v17
    s_add_u32 s32, s37, s35
    s_lshl_b32 s32, s32, 4
    v_add_u32 v23, s32, v17
    s_add_u32 s32, s37, s36
    s_and_b32 s40, s32, 32
    s_lshr_b32 s40, s40, 2
    s_andn2_b32 s32, s32, 63
    s_lshl_b32 s32, s32, 4
    s_add_u32 s32, s32, s40
    v_add_u32 v24, s32, v17

    s_lshr_b32 s32, s24, 1
    s_mul_i32 s32, s32, 7168
    s_add_u32 s32, s32, 98304
    s_lshl_b32 s40, s28, 13
    s_cmp_eq_u32 s27, 0
    s_cselect_b32 s41, s32, s40

    s_waitcnt lgkmcnt(0)
    s_mov_b32 s12, s4
    s_and_b32 s13, s5, 0xffff
    s_mov_b32 s14, 4194304
    s_mov_b32 s15, 0x20000
    s_mov_b32 s20, s10
    s_and_b32 s21, s11, 0xffff
    s_mov_b32 s22, 14680064
    s_mov_b32 s23, 0x20000
    s_cmp_ge_u32 s24, 2
    s_cselect_b32 s16, s8, s6
    s_cselect_b32 s17, s9, s7
    s_and_b32 s17, s17, 0xffff
    s_mov_b32 s18, 7340032
    s_mov_b32 s19, 0x20000

    s_lshl_b32 s68, s2, 3
    s_add_u32 s68, s68, s24
    s_lshl_b32 s69, s68, 11
    s_cmp_ge_u32 s68, 1024
    s_cselect_b32 s64, s8, s6
    s_cselect_b32 s65, s9, s7
    s_and_b32 s65, s65, 0xffff
    s_mov_b32 s66, 7340032
    s_mov_b32 s67, 0x20000
    s_and_b32 s68, s68, 1023
    s_lshl_b32 s68, s68, 10
    v_lshlrev_b32 v30, 4, v2

    s_cmp_eq_u32 s27, 0
    s_cbranch_scc0 K1_TYPE1
    s_and_b32 s32, s24, 1
    s_cmp_eq_u32 s32, 0
    s_cbranch_scc0 K1_TYPE01
    s_mov_b32 s30, 0
    s_mov_b32 s45, 0
    s_mov_b32 s46, s41
    s_mov_b32 s70, 0
    v_mov_b32 v26, 0
    s_add_u32 m0, s41, 0
    s_nop 0
    buffer_load_dwordx4 v10, s[16:19], s30 offen lds
    s_add_u32 m0, s41, 1024
    s_nop 0
    buffer_load_dwordx4 v11, s[16:19], s30 offen lds
    s_add_u32 m0, s41, 2048
    s_nop 0
    buffer_load_dwordx4 v12, s[16:19], s30 offen lds
    s_add_u32 m0, s41, 3072
    s_nop 0
    buffer_load_dwordx4 v13, s[16:19], s30 offen lds
    s_add_u32 m0, s41, 4096
    s_nop 0
    buffer_load_dwordx4 v14, s[16:19], s30 offen lds
    s_add_u32 m0, s41, 5120
    s_nop 0
    buffer_load_dwordx4 v15, s[16:19], s30 offen lds
    s_add_u32 m0, s41, 6144
    s_nop 0
    buffer_load_dwordx4 v16, s[16:19], s30 offen lds
    s_add_u32 s30, s30, 458752
    s_add_u32 m0, s41, 28672
    s_nop 0
    buffer_load_dwordx4 v10, s[16:19], s30 offen lds
    s_add_u32 m0, s41, 29696
    s_nop 0
    buffer_load_dwordx4 v11, s[16:19], s30 offen lds
    s_add_u32 m0, s41, 30720
    s_nop 0
    buffer_load_dwordx4 v12, s[16:19], s30 offen lds
    s_add_u32 m0, s41, 31744
    s_nop 0
    buffer_load_dwordx4 v13, s[16:19], s30 offen lds
    v_mov_b32 v128, 0
    v_mov_b32 v129, 0
    v_mov_b32 v130, 0
    v_mov_b32 v131, 0
    v_mov_b32 v132, 0
    v_mov_b32 v133, 0
    v_mov_b32 v134, 0
    v_mov_b32 v135, 0
    v_mov_b32 v136, 0
    v_mov_b32 v137, 0
    v_mov_b32 v138, 0
    v_mov_b32 v139, 0
    v_mov_b32 v140, 0
    v_mov_b32 v141, 0
    v_mov_b32 v142, 0
    v_mov_b32 v143, 0
    v_mov_b32 v144, 0
    v_mov_b32 v145, 0
    v_mov_b32 v146, 0
    v_mov_b32 v147, 0
    v_mov_b32 v148, 0
    v_mov_b32 v149, 0
    v_mov_b32 v150, 0
    v_mov_b32 v151, 0
    v_mov_b32 v152, 0
    v_mov_b32 v153, 0
    v_mov_b32 v154, 0
    v_mov_b32 v155, 0
    v_mov_b32 v156, 0
    v_mov_b32 v157, 0
    v_mov_b32 v158, 0
    v_mov_b32 v159, 0
    v_mov_b32 v160, 0
    v_mov_b32 v161, 0
    v_mov_b32 v162, 0
    v_mov_b32 v163, 0
    v_mov_b32 v164, 0
    v_mov_b32 v165, 0
    v_mov_b32 v166, 0
    v_mov_b32 v167, 0
    v_mov_b32 v168, 0
    v_mov_b32 v169, 0
    v_mov_b32 v170, 0
    v_mov_b32 v171, 0
    v_mov_b32 v172, 0
    v_mov_b32 v173, 0
    v_mov_b32 v174, 0
    v_mov_b32 v175, 0
    v_mov_b32 v176, 0
    v_mov_b32 v177, 0
    v_mov_b32 v178, 0
    v_mov_b32 v179, 0
    v_mov_b32 v180, 0
    v_mov_b32 v181, 0
    v_mov_b32 v182, 0
    v_mov_b32 v183, 0
    v_mov_b32 v184, 0
    v_mov_b32 v185, 0
    v_mov_b32 v186, 0
    v_mov_b32 v187, 0
    v_mov_b32 v188, 0
    v_mov_b32 v189, 0
    v_mov_b32 v190, 0
    v_mov_b32 v191, 0
    v_mov_b32 v192, 0
    v_mov_b32 v193, 0
    v_mov_b32 v194, 0
    v_mov_b32 v195, 0
    v_mov_b32 v196, 0
    v_mov_b32 v197, 0
    v_mov_b32 v198, 0
    v_mov_b32 v199, 0
    v_mov_b32 v200, 0
    v_mov_b32 v201, 0
    v_mov_b32 v202, 0
    v_mov_b32 v203, 0
    v_mov_b32 v204, 0
    v_mov_b32 v205, 0
    v_mov_b32 v206, 0
    v_mov_b32 v207, 0
    v_mov_b32 v208, 0
    v_mov_b32 v209, 0
    v_mov_b32 v210, 0
    v_mov_b32 v211, 0
    v_mov_b32 v212, 0
    v_mov_b32 v213, 0
    v_mov_b32 v214, 0
    v_mov_b32 v215, 0
    v_mov_b32 v216, 0
    v_mov_b32 v217, 0
    v_mov_b32 v218, 0
    v_mov_b32 v219, 0
    v_mov_b32 v220, 0
    v_mov_b32 v221, 0
    v_mov_b32 v222, 0
    v_mov_b32 v223, 0
    v_mov_b32 v224, 0
    v_mov_b32 v225, 0
    v_mov_b32 v226, 0
    v_mov_b32 v227, 0
    v_mov_b32 v228, 0
    v_mov_b32 v229, 0
    v_mov_b32 v230, 0
    v_mov_b32 v231, 0
    v_mov_b32 v232, 0
    v_mov_b32 v233, 0
    v_mov_b32 v234, 0
    v_mov_b32 v235, 0
    v_mov_b32 v236, 0
    v_mov_b32 v237, 0
    v_mov_b32 v238, 0
    v_mov_b32 v239, 0
    v_mov_b32 v240, 0
    v_mov_b32 v241, 0
    v_mov_b32 v242, 0
    v_mov_b32 v243, 0
    v_mov_b32 v244, 0
    v_mov_b32 v245, 0
    v_mov_b32 v246, 0
    v_mov_b32 v247, 0
    v_mov_b32 v248, 0
    v_mov_b32 v249, 0
    v_mov_b32 v250, 0
    v_mov_b32 v251, 0
    v_mov_b32 v252, 0
    v_mov_b32 v253, 0
    v_mov_b32 v254, 0
    v_mov_b32 v255, 0
    s_waitcnt vmcnt(4)
    s_barrier
    v_add_u32 v5, s45, v28
    s_nop 0
    s_add_u32 m0, s41, 32768
    s_nop 0
    buffer_load_dwordx4 v14, s[16:19], s30 offen lds
    ds_read_b128 v[32:35], v5 offset:0
    ds_read_b128 v[36:39], v5 offset:2048
    ds_read_b128 v[40:43], v5 offset:4096
    ds_read_b128 v[44:47], v5 offset:6144
    ds_read_b64_tr_b16 v[48:49], v7 offset:0
    s_add_u32 m0, s41, 33792
    s_nop 0
    buffer_load_dwordx4 v15, s[16:19], s30 offen lds
    ds_read_b64_tr_b16 v[50:51], v7 offset:1792
    ds_read_b64_tr_b16 v[52:53], v7 offset:7168
    ds_read_b64_tr_b16 v[54:55], v7 offset:8960
    ds_read_b64_tr_b16 v[56:57], v7 offset:32
    ds_read_b64_tr_b16 v[58:59], v7 offset:1824
    s_add_u32 m0, s41, 34816
    s_nop 0
    buffer_load_dwordx4 v16, s[16:19], s30 offen lds
    s_add_u32 s30, s30, 458752
    ds_read_b64_tr_b16 v[60:61], v7 offset:7200
    ds_read_b64_tr_b16 v[62:63], v7 offset:8992
    ds_read_b64_tr_b16 v[64:65], v7 offset:64
    ds_read_b64_tr_b16 v[66:67], v7 offset:1856
    ds_read_b64_tr_b16 v[68:69], v7 offset:7232
    s_mov_b32 m0, 155648
    s_add_u32 s32, s69, 0
    buffer_load_dwordx4 v30, s[12:15], s32 offen lds
    ds_read_b64_tr_b16 v[70:71], v7 offset:9024
    ds_read_b64_tr_b16 v[72:73], v7 offset:96
    ds_read_b64_tr_b16 v[74:75], v7 offset:1888
    ds_read_b64_tr_b16 v[76:77], v7 offset:7264
    ds_read_b64_tr_b16 v[78:79], v7 offset:9056
    s_waitcnt vmcnt(63) lgkmcnt(0)
    s_barrier
    v_add_u32 v6, s45, v29
    s_add_u32 s45, s45, 32768
    s_cmp_eq_u32 s45, 98304
    s_cselect_b32 s45, 0, s45
    s_nop 0
    s_add_u32 m0, s41, 0
    s_nop 0
    buffer_load_dwordx4 v10, s[16:19], s30 offen lds
    v_mfma_f32_16x16x32_bf16 v[128:131], v[48:51], v[32:35], v[128:131]
    ds_read_b128 v[80:83], v6 offset:0
    v_mfma_f32_16x16x32_bf16 v[132:135], v[52:55], v[32:35], v[132:135]
    ds_read_b128 v[84:87], v6 offset:2048
    v_mfma_f32_16x16x32_bf16 v[136:139], v[56:59], v[32:35], v[136:139]
    ds_read_b128 v[88:91], v6 offset:4096
    v_mfma_f32_16x16x32_bf16 v[140:143], v[60:63], v[32:35], v[140:143]
    v_mfma_f32_16x16x32_bf16 v[144:147], v[64:67], v[32:35], v[144:147]
    ds_read_b128 v[92:95], v6 offset:6144
    v_mfma_f32_16x16x32_bf16 v[148:151], v[68:71], v[32:35], v[148:151]
    s_add_u32 m0, s41, 1024
    s_nop 0
    buffer_load_dwordx4 v11, s[16:19], s30 offen lds
    v_mfma_f32_16x16x32_bf16 v[152:155], v[72:75], v[32:35], v[152:155]
    ds_read_b64_tr_b16 v[96:97], v7 offset:14336
    v_mfma_f32_16x16x32_bf16 v[156:159], v[76:79], v[32:35], v[156:159]
    ds_read_b64_tr_b16 v[98:99], v7 offset:16128
    v_mfma_f32_16x16x32_bf16 v[160:163], v[48:51], v[36:39], v[160:163]
    v_mfma_f32_16x16x32_bf16 v[164:167], v[52:55], v[36:39], v[164:167]
    ds_read_b64_tr_b16 v[100:101], v7 offset:21504
    v_mfma_f32_16x16x32_bf16 v[168:171], v[56:59], v[36:39], v[168:171]
    ds_read_b64_tr_b16 v[102:103], v7 offset:23296
    v_mfma_f32_16x16x32_bf16 v[172:175], v[60:63], v[36:39], v[172:175]
    s_add_u32 m0, s41, 2048
    s_nop 0
    buffer_load_dwordx4 v12, s[16:19], s30 offen lds
    v_mfma_f32_16x16x32_bf16 v[176:179], v[64:67], v[36:39], v[176:179]
    v_mfma_f32_16x16x32_bf16 v[180:183], v[68:71], v[36:39], v[180:183]
    ds_read_b64_tr_b16 v[104:105], v7 offset:14368
    v_mfma_f32_16x16x32_bf16 v[184:187], v[72:75], v[36:39], v[184:187]
    ds_read_b64_tr_b16 v[106:107], v7 offset:16160
    v_mfma_f32_16x16x32_bf16 v[188:191], v[76:79], v[36:39], v[188:191]
    ds_read_b64_tr_b16 v[108:109], v7 offset:21536
    v_mfma_f32_16x16x32_bf16 v[192:195], v[48:51], v[40:43], v[192:195]
    ds_read_b64_tr_b16 v[110:111], v7 offset:23328
    v_mfma_f32_16x16x32_bf16 v[196:199], v[52:55], v[40:43], v[196:199]
    v_mfma_f32_16x16x32_bf16 v[200:203], v[56:59], v[40:43], v[200:203]
    s_add_u32 m0, s41, 3072
    s_nop 0
    buffer_load_dwordx4 v13, s[16:19], s30 offen lds
    v_mfma_f32_16x16x32_bf16 v[204:207], v[60:63], v[40:43], v[204:207]
    ds_read_b64_tr_b16 v[112:113], v7 offset:14400
    v_mfma_f32_16x16x32_bf16 v[208:211], v[64:67], v[40:43], v[208:211]
    ds_read_b64_tr_b16 v[114:115], v7 offset:16192
    v_mfma_f32_16x16x32_bf16 v[212:215], v[68:71], v[40:43], v[212:215]
    v_mfma_f32_16x16x32_bf16 v[216:219], v[72:75], v[40:43], v[216:219]
    ds_read_b64_tr_b16 v[116:117], v7 offset:21568
    v_mfma_f32_16x16x32_bf16 v[220:223], v[76:79], v[40:43], v[220:223]
    ds_read_b64_tr_b16 v[118:119], v7 offset:23360
    v_mfma_f32_16x16x32_bf16 v[224:227], v[48:51], v[44:47], v[224:227]
    s_mov_b32 m0, 155648
    s_add_u32 s32, s68, 0
    buffer_load_dwordx4 v30, s[64:67], s32 offen lds
    v_mfma_f32_16x16x32_bf16 v[228:231], v[52:55], v[44:47], v[228:231]
    ds_read_b64_tr_b16 v[120:121], v7 offset:14432
    v_mfma_f32_16x16x32_bf16 v[232:235], v[56:59], v[44:47], v[232:235]
    v_mfma_f32_16x16x32_bf16 v[236:239], v[60:63], v[44:47], v[236:239]
    ds_read_b64_tr_b16 v[122:123], v7 offset:16224
    v_mfma_f32_16x16x32_bf16 v[240:243], v[64:67], v[44:47], v[240:243]
    ds_read_b64_tr_b16 v[124:125], v7 offset:21600
    v_mfma_f32_16x16x32_bf16 v[244:247], v[68:71], v[44:47], v[244:247]
    ds_read_b64_tr_b16 v[126:127], v7 offset:23392
    v_mfma_f32_16x16x32_bf16 v[248:251], v[72:75], v[44:47], v[248:251]
    v_mfma_f32_16x16x32_bf16 v[252:255], v[76:79], v[44:47], v[252:255]
    s_waitcnt vmcnt(6) lgkmcnt(0)
    s_barrier
    v_add_u32 v5, s45, v28
    s_nop 0
    s_add_u32 m0, s41, 4096
    s_nop 0
    buffer_load_dwordx4 v14, s[16:19], s30 offen lds
    v_mfma_f32_16x16x32_bf16 v[128:131], v[96:99], v[80:83], v[128:131]
    ds_read_b128 v[32:35], v5 offset:0
    v_mfma_f32_16x16x32_bf16 v[132:135], v[100:103], v[80:83], v[132:135]
    ds_read_b128 v[36:39], v5 offset:2048
    v_mfma_f32_16x16x32_bf16 v[136:139], v[104:107], v[80:83], v[136:139]
    v_mfma_f32_16x16x32_bf16 v[140:143], v[108:111], v[80:83], v[140:143]
    ds_read_b128 v[40:43], v5 offset:4096
    v_mfma_f32_16x16x32_bf16 v[144:147], v[112:115], v[80:83], v[144:147]
    ds_read_b128 v[44:47], v5 offset:6144
    v_mfma_f32_16x16x32_bf16 v[148:151], v[116:119], v[80:83], v[148:151]
    ds_read_b64_tr_b16 v[48:49], v7 offset:28672
    v_mfma_f32_16x16x32_bf16 v[152:155], v[120:123], v[80:83], v[152:155]
    v_mfma_f32_16x16x32_bf16 v[156:159], v[124:127], v[80:83], v[156:159]
    s_add_u32 m0, s41, 5120
    s_nop 0
    buffer_load_dwordx4 v15, s[16:19], s30 offen lds
    v_mfma_f32_16x16x32_bf16 v[160:163], v[96:99], v[84:87], v[160:163]
    ds_read_b64_tr_b16 v[50:51], v7 offset:30464
    v_mfma_f32_16x16x32_bf16 v[164:167], v[100:103], v[84:87], v[164:167]
    ds_read_b64_tr_b16 v[52:53], v7 offset:35840
    v_mfma_f32_16x16x32_bf16 v[168:171], v[104:107], v[84:87], v[168:171]
    v_mfma_f32_16x16x32_bf16 v[172:175], v[108:111], v[84:87], v[172:175]
    ds_read_b64_tr_b16 v[54:55], v7 offset:37632
    v_mfma_f32_16x16x32_bf16 v[176:179], v[112:115], v[84:87], v[176:179]
    ds_read_b64_tr_b16 v[56:57], v7 offset:28704
    v_mfma_f32_16x16x32_bf16 v[180:183], v[116:119], v[84:87], v[180:183]
    ds_read_b64_tr_b16 v[58:59], v7 offset:30496
    v_mfma_f32_16x16x32_bf16 v[184:187], v[120:123], v[84:87], v[184:187]
    v_mfma_f32_16x16x32_bf16 v[188:191], v[124:127], v[84:87], v[188:191]
    s_add_u32 m0, s41, 6144
    s_nop 0
    buffer_load_dwordx4 v16, s[16:19], s30 offen lds
    s_add_u32 s30, s30, 458752
    v_mfma_f32_16x16x32_bf16 v[192:195], v[96:99], v[88:91], v[192:195]
    ds_read_b64_tr_b16 v[60:61], v7 offset:35872
    v_mfma_f32_16x16x32_bf16 v[196:199], v[100:103], v[88:91], v[196:199]
    ds_read_b64_tr_b16 v[62:63], v7 offset:37664
    v_mfma_f32_16x16x32_bf16 v[200:203], v[104:107], v[88:91], v[200:203]
    v_mfma_f32_16x16x32_bf16 v[204:207], v[108:111], v[88:91], v[204:207]
    ds_read_b64_tr_b16 v[64:65], v7 offset:28736
    v_mfma_f32_16x16x32_bf16 v[208:211], v[112:115], v[88:91], v[208:211]
    ds_read_b64_tr_b16 v[66:67], v7 offset:30528
    v_mfma_f32_16x16x32_bf16 v[212:215], v[116:119], v[88:91], v[212:215]
    ds_read_b64_tr_b16 v[68:69], v7 offset:35904
    v_mfma_f32_16x16x32_bf16 v[216:219], v[120:123], v[88:91], v[216:219]
    v_mfma_f32_16x16x32_bf16 v[220:223], v[124:127], v[88:91], v[220:223]
    s_mov_b32 m0, 155648
    s_add_u32 s32, s68, 1048576
    buffer_load_dwordx4 v30, s[64:67], s32 offen lds
    v_mfma_f32_16x16x32_bf16 v[224:227], v[96:99], v[92:95], v[224:227]
    ds_read_b64_tr_b16 v[70:71], v7 offset:37696
    v_mfma_f32_16x16x32_bf16 v[228:231], v[100:103], v[92:95], v[228:231]
    ds_read_b64_tr_b16 v[72:73], v7 offset:28768
    v_mfma_f32_16x16x32_bf16 v[232:235], v[104:107], v[92:95], v[232:235]
    v_mfma_f32_16x16x32_bf16 v[236:239], v[108:111], v[92:95], v[236:239]
    ds_read_b64_tr_b16 v[74:75], v7 offset:30560
    v_mfma_f32_16x16x32_bf16 v[240:243], v[112:115], v[92:95], v[240:243]
    ds_read_b64_tr_b16 v[76:77], v7 offset:35936
    v_mfma_f32_16x16x32_bf16 v[244:247], v[116:119], v[92:95], v[244:247]
    ds_read_b64_tr_b16 v[78:79], v7 offset:37728
    v_mfma_f32_16x16x32_bf16 v[248:251], v[120:123], v[92:95], v[248:251]
    v_mfma_f32_16x16x32_bf16 v[252:255], v[124:127], v[92:95], v[252:255]
    s_waitcnt vmcnt(63) lgkmcnt(0)
    s_barrier
    v_add_u32 v6, s45, v29
    s_add_u32 s45, s45, 32768
    s_cmp_eq_u32 s45, 98304
    s_cselect_b32 s45, 0, s45
    s_nop 0
    s_add_u32 m0, s41, 28672
    s_nop 0
    buffer_load_dwordx4 v10, s[16:19], s30 offen lds
    v_mfma_f32_16x16x32_bf16 v[128:131], v[48:51], v[32:35], v[128:131]
    ds_read_b128 v[80:83], v6 offset:0
    v_mfma_f32_16x16x32_bf16 v[132:135], v[52:55], v[32:35], v[132:135]
    ds_read_b128 v[84:87], v6 offset:2048
    v_mfma_f32_16x16x32_bf16 v[136:139], v[56:59], v[32:35], v[136:139]
    ds_read_b128 v[88:91], v6 offset:4096
    v_mfma_f32_16x16x32_bf16 v[140:143], v[60:63], v[32:35], v[140:143]
    v_mfma_f32_16x16x32_bf16 v[144:147], v[64:67], v[32:35], v[144:147]
    ds_read_b128 v[92:95], v6 offset:6144
    v_mfma_f32_16x16x32_bf16 v[148:151], v[68:71], v[32:35], v[148:151]
    s_add_u32 m0, s41, 29696
    s_nop 0
    buffer_load_dwordx4 v11, s[16:19], s30 offen lds
    v_mfma_f32_16x16x32_bf16 v[152:155], v[72:75], v[32:35], v[152:155]
    ds_read_b64_tr_b16 v[96:97], v7 offset:43008
    v_mfma_f32_16x16x32_bf16 v[156:159], v[76:79], v[32:35], v[156:159]
    ds_read_b64_tr_b16 v[98:99], v7 offset:44800
    v_mfma_f32_16x16x32_bf16 v[160:163], v[48:51], v[36:39], v[160:163]
    v_mfma_f32_16x16x32_bf16 v[164:167], v[52:55], v[36:39], v[164:167]
    ds_read_b64_tr_b16 v[100:101], v7 offset:50176
    v_mfma_f32_16x16x32_bf16 v[168:171], v[56:59], v[36:39], v[168:171]
    ds_read_b64_tr_b16 v[102:103], v7 offset:51968
    v_mfma_f32_16x16x32_bf16 v[172:175], v[60:63], v[36:39], v[172:175]
    s_add_u32 m0, s41, 30720
    s_nop 0
    buffer_load_dwordx4 v12, s[16:19], s30 offen lds
    v_mfma_f32_16x16x32_bf16 v[176:179], v[64:67], v[36:39], v[176:179]
    v_mfma_f32_16x16x32_bf16 v[180:183], v[68:71], v[36:39], v[180:183]
    ds_read_b64_tr_b16 v[104:105], v7 offset:43040
    v_mfma_f32_16x16x32_bf16 v[184:187], v[72:75], v[36:39], v[184:187]
    ds_read_b64_tr_b16 v[106:107], v7 offset:44832
    v_mfma_f32_16x16x32_bf16 v[188:191], v[76:79], v[36:39], v[188:191]
    ds_read_b64_tr_b16 v[108:109], v7 offset:50208
    v_mfma_f32_16x16x32_bf16 v[192:195], v[48:51], v[40:43], v[192:195]
    ds_read_b64_tr_b16 v[110:111], v7 offset:52000
    v_mfma_f32_16x16x32_bf16 v[196:199], v[52:55], v[40:43], v[196:199]
    v_mfma_f32_16x16x32_bf16 v[200:203], v[56:59], v[40:43], v[200:203]
    s_add_u32 m0, s41, 31744
    s_nop 0
    buffer_load_dwordx4 v13, s[16:19], s30 offen lds
    v_mfma_f32_16x16x32_bf16 v[204:207], v[60:63], v[40:43], v[204:207]
    ds_read_b64_tr_b16 v[112:113], v7 offset:43072
    v_mfma_f32_16x16x32_bf16 v[208:211], v[64:67], v[40:43], v[208:211]
    ds_read_b64_tr_b16 v[114:115], v7 offset:44864
    v_mfma_f32_16x16x32_bf16 v[212:215], v[68:71], v[40:43], v[212:215]
    v_mfma_f32_16x16x32_bf16 v[216:219], v[72:75], v[40:43], v[216:219]
    ds_read_b64_tr_b16 v[116:117], v7 offset:50240
    v_mfma_f32_16x16x32_bf16 v[220:223], v[76:79], v[40:43], v[220:223]
    ds_read_b64_tr_b16 v[118:119], v7 offset:52032
    v_mfma_f32_16x16x32_bf16 v[224:227], v[48:51], v[44:47], v[224:227]
    s_mov_b32 m0, 155648
    s_add_u32 s32, s68, 2097152
    buffer_load_dwordx4 v30, s[64:67], s32 offen lds
    v_mfma_f32_16x16x32_bf16 v[228:231], v[52:55], v[44:47], v[228:231]
    ds_read_b64_tr_b16 v[120:121], v7 offset:43104
    v_mfma_f32_16x16x32_bf16 v[232:235], v[56:59], v[44:47], v[232:235]
    v_mfma_f32_16x16x32_bf16 v[236:239], v[60:63], v[44:47], v[236:239]
    ds_read_b64_tr_b16 v[122:123], v7 offset:44896
    v_mfma_f32_16x16x32_bf16 v[240:243], v[64:67], v[44:47], v[240:243]
    ds_read_b64_tr_b16 v[124:125], v7 offset:50272
    v_mfma_f32_16x16x32_bf16 v[244:247], v[68:71], v[44:47], v[244:247]
    ds_read_b64_tr_b16 v[126:127], v7 offset:52064
    v_mfma_f32_16x16x32_bf16 v[248:251], v[72:75], v[44:47], v[248:251]
    v_mfma_f32_16x16x32_bf16 v[252:255], v[76:79], v[44:47], v[252:255]
    s_waitcnt vmcnt(6) lgkmcnt(0)
    s_barrier
    v_add_u32 v5, s45, v28
    s_nop 0
    s_add_u32 m0, s41, 32768
    s_nop 0
    buffer_load_dwordx4 v14, s[16:19], s30 offen lds
    v_mfma_f32_16x16x32_bf16 v[128:131], v[96:99], v[80:83], v[128:131]
    ds_read_b128 v[32:35], v5 offset:0
    v_mfma_f32_16x16x32_bf16 v[132:135], v[100:103], v[80:83], v[132:135]
    ds_read_b128 v[36:39], v5 offset:2048
    v_mfma_f32_16x16x32_bf16 v[136:139], v[104:107], v[80:83], v[136:139]
    v_mfma_f32_16x16x32_bf16 v[140:143], v[108:111], v[80:83], v[140:143]
    ds_read_b128 v[40:43], v5 offset:4096
    v_mfma_f32_16x16x32_bf16 v[144:147], v[112:115], v[80:83], v[144:147]
    ds_read_b128 v[44:47], v5 offset:6144
    v_mfma_f32_16x16x32_bf16 v[148:151], v[116:119], v[80:83], v[148:151]
    ds_read_b64_tr_b16 v[48:49], v7 offset:0
    v_mfma_f32_16x16x32_bf16 v[152:155], v[120:123], v[80:83], v[152:155]
    v_mfma_f32_16x16x32_bf16 v[156:159], v[124:127], v[80:83], v[156:159]
    s_add_u32 m0, s41, 33792
    s_nop 0
    buffer_load_dwordx4 v15, s[16:19], s30 offen lds
    v_mfma_f32_16x16x32_bf16 v[160:163], v[96:99], v[84:87], v[160:163]
    ds_read_b64_tr_b16 v[50:51], v7 offset:1792
    v_mfma_f32_16x16x32_bf16 v[164:167], v[100:103], v[84:87], v[164:167]
    ds_read_b64_tr_b16 v[52:53], v7 offset:7168
    v_mfma_f32_16x16x32_bf16 v[168:171], v[104:107], v[84:87], v[168:171]
    v_mfma_f32_16x16x32_bf16 v[172:175], v[108:111], v[84:87], v[172:175]
    ds_read_b64_tr_b16 v[54:55], v7 offset:8960
    v_mfma_f32_16x16x32_bf16 v[176:179], v[112:115], v[84:87], v[176:179]
    ds_read_b64_tr_b16 v[56:57], v7 offset:32
    v_mfma_f32_16x16x32_bf16 v[180:183], v[116:119], v[84:87], v[180:183]
    ds_read_b64_tr_b16 v[58:59], v7 offset:1824
    v_mfma_f32_16x16x32_bf16 v[184:187], v[120:123], v[84:87], v[184:187]
    v_mfma_f32_16x16x32_bf16 v[188:191], v[124:127], v[84:87], v[188:191]
    s_add_u32 m0, s41, 34816
    s_nop 0
    buffer_load_dwordx4 v16, s[16:19], s30 offen lds
    s_add_u32 s30, s30, 458752
    v_mfma_f32_16x16x32_bf16 v[192:195], v[96:99], v[88:91], v[192:195]
    ds_read_b64_tr_b16 v[60:61], v7 offset:7200
    v_mfma_f32_16x16x32_bf16 v[196:199], v[100:103], v[88:91], v[196:199]
    ds_read_b64_tr_b16 v[62:63], v7 offset:8992
    v_mfma_f32_16x16x32_bf16 v[200:203], v[104:107], v[88:91], v[200:203]
    v_mfma_f32_16x16x32_bf16 v[204:207], v[108:111], v[88:91], v[204:207]
    ds_read_b64_tr_b16 v[64:65], v7 offset:64
    v_mfma_f32_16x16x32_bf16 v[208:211], v[112:115], v[88:91], v[208:211]
    ds_read_b64_tr_b16 v[66:67], v7 offset:1856
    v_mfma_f32_16x16x32_bf16 v[212:215], v[116:119], v[88:91], v[212:215]
    ds_read_b64_tr_b16 v[68:69], v7 offset:7232
    v_mfma_f32_16x16x32_bf16 v[216:219], v[120:123], v[88:91], v[216:219]
    v_mfma_f32_16x16x32_bf16 v[220:223], v[124:127], v[88:91], v[220:223]
    s_mov_b32 m0, 155648
    s_add_u32 s32, s69, 1024
    buffer_load_dwordx4 v30, s[12:15], s32 offen lds
    v_mfma_f32_16x16x32_bf16 v[224:227], v[96:99], v[92:95], v[224:227]
    ds_read_b64_tr_b16 v[70:71], v7 offset:9024
    v_mfma_f32_16x16x32_bf16 v[228:231], v[100:103], v[92:95], v[228:231]
    ds_read_b64_tr_b16 v[72:73], v7 offset:96
    v_mfma_f32_16x16x32_bf16 v[232:235], v[104:107], v[92:95], v[232:235]
    v_mfma_f32_16x16x32_bf16 v[236:239], v[108:111], v[92:95], v[236:239]
    ds_read_b64_tr_b16 v[74:75], v7 offset:1888
    v_mfma_f32_16x16x32_bf16 v[240:243], v[112:115], v[92:95], v[240:243]
    ds_read_b64_tr_b16 v[76:77], v7 offset:7264
    v_mfma_f32_16x16x32_bf16 v[244:247], v[116:119], v[92:95], v[244:247]
    ds_read_b64_tr_b16 v[78:79], v7 offset:9056
    v_mfma_f32_16x16x32_bf16 v[248:251], v[120:123], v[92:95], v[248:251]
    v_mfma_f32_16x16x32_bf16 v[252:255], v[124:127], v[92:95], v[252:255]
    s_waitcnt vmcnt(63) lgkmcnt(0)
    s_barrier
    v_add_u32 v6, s45, v29
    s_add_u32 s45, s45, 32768
    s_cmp_eq_u32 s45, 98304
    s_cselect_b32 s45, 0, s45
    s_nop 0
    s_add_u32 m0, s41, 0
    s_nop 0
    buffer_load_dwordx4 v10, s[16:19], s30 offen lds
    v_mfma_f32_16x16x32_bf16 v[128:131], v[48:51], v[32:35], v[128:131]
    ds_read_b128 v[80:83], v6 offset:0
    v_mfma_f32_16x16x32_bf16 v[132:135], v[52:55], v[32:35], v[132:135]
    ds_read_b128 v[84:87], v6 offset:2048
    v_mfma_f32_16x16x32_bf16 v[136:139], v[56:59], v[32:35], v[136:139]
    ds_read_b128 v[88:91], v6 offset:4096
    v_mfma_f32_16x16x32_bf16 v[140:143], v[60:63], v[32:35], v[140:143]
    v_mfma_f32_16x16x32_bf16 v[144:147], v[64:67], v[32:35], v[144:147]
    ds_read_b128 v[92:95], v6 offset:6144
    v_mfma_f32_16x16x32_bf16 v[148:151], v[68:71], v[32:35], v[148:151]
    s_add_u32 m0, s41, 1024
    s_nop 0
    buffer_load_dwordx4 v11, s[16:19], s30 offen lds
    v_mfma_f32_16x16x32_bf16 v[152:155], v[72:75], v[32:35], v[152:155]
    ds_read_b64_tr_b16 v[96:97], v7 offset:14336
    v_mfma_f32_16x16x32_bf16 v[156:159], v[76:79], v[32:35], v[156:159]
    ds_read_b64_tr_b16 v[98:99], v7 offset:16128
    v_mfma_f32_16x16x32_bf16 v[160:163], v[48:51], v[36:39], v[160:163]
    v_mfma_f32_16x16x32_bf16 v[164:167], v[52:55], v[36:39], v[164:167]
    ds_read_b64_tr_b16 v[100:101], v7 offset:21504
    v_mfma_f32_16x16x32_bf16 v[168:171], v[56:59], v[36:39], v[168:171]
    ds_read_b64_tr_b16 v[102:103], v7 offset:23296
    v_mfma_f32_16x16x32_bf16 v[172:175], v[60:63], v[36:39], v[172:175]
    s_add_u32 m0, s41, 2048
    s_nop 0
    buffer_load_dwordx4 v12, s[16:19], s30 offen lds
    v_mfma_f32_16x16x32_bf16 v[176:179], v[64:67], v[36:39], v[176:179]
    v_mfma_f32_16x16x32_bf16 v[180:183], v[68:71], v[36:39], v[180:183]
    ds_read_b64_tr_b16 v[104:105], v7 offset:14368
    v_mfma_f32_16x16x32_bf16 v[184:187], v[72:75], v[36:39], v[184:187]
    ds_read_b64_tr_b16 v[106:107], v7 offset:16160
    v_mfma_f32_16x16x32_bf16 v[188:191], v[76:79], v[36:39], v[188:191]
    ds_read_b64_tr_b16 v[108:109], v7 offset:21536
    v_mfma_f32_16x16x32_bf16 v[192:195], v[48:51], v[40:43], v[192:195]
    ds_read_b64_tr_b16 v[110:111], v7 offset:23328
    v_mfma_f32_16x16x32_bf16 v[196:199], v[52:55], v[40:43], v[196:199]
    v_mfma_f32_16x16x32_bf16 v[200:203], v[56:59], v[40:43], v[200:203]
    s_add_u32 m0, s41, 3072
    s_nop 0
    buffer_load_dwordx4 v13, s[16:19], s30 offen lds
    v_mfma_f32_16x16x32_bf16 v[204:207], v[60:63], v[40:43], v[204:207]
    ds_read_b64_tr_b16 v[112:113], v7 offset:14400
    v_mfma_f32_16x16x32_bf16 v[208:211], v[64:67], v[40:43], v[208:211]
    ds_read_b64_tr_b16 v[114:115], v7 offset:16192
    v_mfma_f32_16x16x32_bf16 v[212:215], v[68:71], v[40:43], v[212:215]
    v_mfma_f32_16x16x32_bf16 v[216:219], v[72:75], v[40:43], v[216:219]
    ds_read_b64_tr_b16 v[116:117], v7 offset:21568
    v_mfma_f32_16x16x32_bf16 v[220:223], v[76:79], v[40:43], v[220:223]
    ds_read_b64_tr_b16 v[118:119], v7 offset:23360
    v_mfma_f32_16x16x32_bf16 v[224:227], v[48:51], v[44:47], v[224:227]
    s_mov_b32 m0, 155648
    s_add_u32 s32, s68, 3145728
    buffer_load_dwordx4 v30, s[64:67], s32 offen lds
    v_mfma_f32_16x16x32_bf16 v[228:231], v[52:55], v[44:47], v[228:231]
    ds_read_b64_tr_b16 v[120:121], v7 offset:14432
    v_mfma_f32_16x16x32_bf16 v[232:235], v[56:59], v[44:47], v[232:235]
    v_mfma_f32_16x16x32_bf16 v[236:239], v[60:63], v[44:47], v[236:239]
    ds_read_b64_tr_b16 v[122:123], v7 offset:16224
    v_mfma_f32_16x16x32_bf16 v[240:243], v[64:67], v[44:47], v[240:243]
    ds_read_b64_tr_b16 v[124:125], v7 offset:21600
    v_mfma_f32_16x16x32_bf16 v[244:247], v[68:71], v[44:47], v[244:247]
    ds_read_b64_tr_b16 v[126:127], v7 offset:23392
    v_mfma_f32_16x16x32_bf16 v[248:251], v[72:75], v[44:47], v[248:251]
    v_mfma_f32_16x16x32_bf16 v[252:255], v[76:79], v[44:47], v[252:255]
    s_waitcnt vmcnt(6) lgkmcnt(0)
    s_barrier
    v_add_u32 v5, s45, v28
    s_nop 0
    s_add_u32 m0, s41, 4096
    s_nop 0
    buffer_load_dwordx4 v14, s[16:19], s30 offen lds
    v_mfma_f32_16x16x32_bf16 v[128:131], v[96:99], v[80:83], v[128:131]
    ds_read_b128 v[32:35], v5 offset:0
    v_mfma_f32_16x16x32_bf16 v[132:135], v[100:103], v[80:83], v[132:135]
    ds_read_b128 v[36:39], v5 offset:2048
    v_mfma_f32_16x16x32_bf16 v[136:139], v[104:107], v[80:83], v[136:139]
    v_mfma_f32_16x16x32_bf16 v[140:143], v[108:111], v[80:83], v[140:143]
    ds_read_b128 v[40:43], v5 offset:4096
    v_mfma_f32_16x16x32_bf16 v[144:147], v[112:115], v[80:83], v[144:147]
    ds_read_b128 v[44:47], v5 offset:6144
    v_mfma_f32_16x16x32_bf16 v[148:151], v[116:119], v[80:83], v[148:151]
    ds_read_b64_tr_b16 v[48:49], v7 offset:28672
    v_mfma_f32_16x16x32_bf16 v[152:155], v[120:123], v[80:83], v[152:155]
    v_mfma_f32_16x16x32_bf16 v[156:159], v[124:127], v[80:83], v[156:159]
    s_add_u32 m0, s41, 5120
    s_nop 0
    buffer_load_dwordx4 v15, s[16:19], s30 offen lds
    v_mfma_f32_16x16x32_bf16 v[160:163], v[96:99], v[84:87], v[160:163]
    ds_read_b64_tr_b16 v[50:51], v7 offset:30464
    v_mfma_f32_16x16x32_bf16 v[164:167], v[100:103], v[84:87], v[164:167]
    ds_read_b64_tr_b16 v[52:53], v7 offset:35840
    v_mfma_f32_16x16x32_bf16 v[168:171], v[104:107], v[84:87], v[168:171]
    v_mfma_f32_16x16x32_bf16 v[172:175], v[108:111], v[84:87], v[172:175]
    ds_read_b64_tr_b16 v[54:55], v7 offset:37632
    v_mfma_f32_16x16x32_bf16 v[176:179], v[112:115], v[84:87], v[176:179]
    ds_read_b64_tr_b16 v[56:57], v7 offset:28704
    v_mfma_f32_16x16x32_bf16 v[180:183], v[116:119], v[84:87], v[180:183]
    ds_read_b64_tr_b16 v[58:59], v7 offset:30496
    v_mfma_f32_16x16x32_bf16 v[184:187], v[120:123], v[84:87], v[184:187]
    v_mfma_f32_16x16x32_bf16 v[188:191], v[124:127], v[84:87], v[188:191]
    s_add_u32 m0, s41, 6144
    s_nop 0
    buffer_load_dwordx4 v16, s[16:19], s30 offen lds
    s_add_u32 s30, s30, 458752
    v_mfma_f32_16x16x32_bf16 v[192:195], v[96:99], v[88:91], v[192:195]
    ds_read_b64_tr_b16 v[60:61], v7 offset:35872
    v_mfma_f32_16x16x32_bf16 v[196:199], v[100:103], v[88:91], v[196:199]
    ds_read_b64_tr_b16 v[62:63], v7 offset:37664
    v_mfma_f32_16x16x32_bf16 v[200:203], v[104:107], v[88:91], v[200:203]
    v_mfma_f32_16x16x32_bf16 v[204:207], v[108:111], v[88:91], v[204:207]
    ds_read_b64_tr_b16 v[64:65], v7 offset:28736
    v_mfma_f32_16x16x32_bf16 v[208:211], v[112:115], v[88:91], v[208:211]
    ds_read_b64_tr_b16 v[66:67], v7 offset:30528
    v_mfma_f32_16x16x32_bf16 v[212:215], v[116:119], v[88:91], v[212:215]
    ds_read_b64_tr_b16 v[68:69], v7 offset:35904
    v_mfma_f32_16x16x32_bf16 v[216:219], v[120:123], v[88:91], v[216:219]
    v_mfma_f32_16x16x32_bf16 v[220:223], v[124:127], v[88:91], v[220:223]
    s_mov_b32 m0, 155648
    s_add_u32 s32, s68, 4194304
    buffer_load_dwordx4 v30, s[64:67], s32 offen lds
    v_mfma_f32_16x16x32_bf16 v[224:227], v[96:99], v[92:95], v[224:227]
    ds_read_b64_tr_b16 v[70:71], v7 offset:37696
    v_mfma_f32_16x16x32_bf16 v[228:231], v[100:103], v[92:95], v[228:231]
    ds_read_b64_tr_b16 v[72:73], v7 offset:28768
    v_mfma_f32_16x16x32_bf16 v[232:235], v[104:107], v[92:95], v[232:235]
    v_mfma_f32_16x16x32_bf16 v[236:239], v[108:111], v[92:95], v[236:239]
    ds_read_b64_tr_b16 v[74:75], v7 offset:30560
    v_mfma_f32_16x16x32_bf16 v[240:243], v[112:115], v[92:95], v[240:243]
    ds_read_b64_tr_b16 v[76:77], v7 offset:35936
    v_mfma_f32_16x16x32_bf16 v[244:247], v[116:119], v[92:95], v[244:247]
    ds_read_b64_tr_b16 v[78:79], v7 offset:37728
    v_mfma_f32_16x16x32_bf16 v[248:251], v[120:123], v[92:95], v[248:251]
    v_mfma_f32_16x16x32_bf16 v[252:255], v[124:127], v[92:95], v[252:255]
    s_waitcnt vmcnt(63) lgkmcnt(0)
    s_barrier
    v_add_u32 v6, s45, v29
    s_add_u32 s45, s45, 32768
    s_cmp_eq_u32 s45, 98304
    s_cselect_b32 s45, 0, s45
    s_nop 0
    s_add_u32 m0, s41, 28672
    s_nop 0
    buffer_load_dwordx4 v10, s[16:19], s30 offen lds
    v_mfma_f32_16x16x32_bf16 v[128:131], v[48:51], v[32:35], v[128:131]
    ds_read_b128 v[80:83], v6 offset:0
    v_mfma_f32_16x16x32_bf16 v[132:135], v[52:55], v[32:35], v[132:135]
    ds_read_b128 v[84:87], v6 offset:2048
    v_mfma_f32_16x16x32_bf16 v[136:139], v[56:59], v[32:35], v[136:139]
    ds_read_b128 v[88:91], v6 offset:4096
    v_mfma_f32_16x16x32_bf16 v[140:143], v[60:63], v[32:35], v[140:143]
    v_mfma_f32_16x16x32_bf16 v[144:147], v[64:67], v[32:35], v[144:147]
    ds_read_b128 v[92:95], v6 offset:6144
    v_mfma_f32_16x16x32_bf16 v[148:151], v[68:71], v[32:35], v[148:151]
    s_add_u32 m0, s41, 29696
    s_nop 0
    buffer_load_dwordx4 v11, s[16:19], s30 offen lds
    v_mfma_f32_16x16x32_bf16 v[152:155], v[72:75], v[32:35], v[152:155]
    ds_read_b64_tr_b16 v[96:97], v7 offset:43008
    v_mfma_f32_16x16x32_bf16 v[156:159], v[76:79], v[32:35], v[156:159]
    ds_read_b64_tr_b16 v[98:99], v7 offset:44800
    v_mfma_f32_16x16x32_bf16 v[160:163], v[48:51], v[36:39], v[160:163]
    v_mfma_f32_16x16x32_bf16 v[164:167], v[52:55], v[36:39], v[164:167]
    ds_read_b64_tr_b16 v[100:101], v7 offset:50176
    v_mfma_f32_16x16x32_bf16 v[168:171], v[56:59], v[36:39], v[168:171]
    ds_read_b64_tr_b16 v[102:103], v7 offset:51968
    v_mfma_f32_16x16x32_bf16 v[172:175], v[60:63], v[36:39], v[172:175]
    s_add_u32 m0, s41, 30720
    s_nop 0
    buffer_load_dwordx4 v12, s[16:19], s30 offen lds
    v_mfma_f32_16x16x32_bf16 v[176:179], v[64:67], v[36:39], v[176:179]
    v_mfma_f32_16x16x32_bf16 v[180:183], v[68:71], v[36:39], v[180:183]
    ds_read_b64_tr_b16 v[104:105], v7 offset:43040
    v_mfma_f32_16x16x32_bf16 v[184:187], v[72:75], v[36:39], v[184:187]
    ds_read_b64_tr_b16 v[106:107], v7 offset:44832
    v_mfma_f32_16x16x32_bf16 v[188:191], v[76:79], v[36:39], v[188:191]
    ds_read_b64_tr_b16 v[108:109], v7 offset:50208
    v_mfma_f32_16x16x32_bf16 v[192:195], v[48:51], v[40:43], v[192:195]
    ds_read_b64_tr_b16 v[110:111], v7 offset:52000
    v_mfma_f32_16x16x32_bf16 v[196:199], v[52:55], v[40:43], v[196:199]
    v_mfma_f32_16x16x32_bf16 v[200:203], v[56:59], v[40:43], v[200:203]
    s_add_u32 m0, s41, 31744
    s_nop 0
    buffer_load_dwordx4 v13, s[16:19], s30 offen lds
    v_mfma_f32_16x16x32_bf16 v[204:207], v[60:63], v[40:43], v[204:207]
    ds_read_b64_tr_b16 v[112:113], v7 offset:43072
    v_mfma_f32_16x16x32_bf16 v[208:211], v[64:67], v[40:43], v[208:211]
    ds_read_b64_tr_b16 v[114:115], v7 offset:44864
    v_mfma_f32_16x16x32_bf16 v[212:215], v[68:71], v[40:43], v[212:215]
    v_mfma_f32_16x16x32_bf16 v[216:219], v[72:75], v[40:43], v[216:219]
    ds_read_b64_tr_b16 v[116:117], v7 offset:50240
    v_mfma_f32_16x16x32_bf16 v[220:223], v[76:79], v[40:43], v[220:223]
    ds_read_b64_tr_b16 v[118:119], v7 offset:52032
    v_mfma_f32_16x16x32_bf16 v[224:227], v[48:51], v[44:47], v[224:227]
    s_mov_b32 m0, 155648
    s_add_u32 s32, s68, 5242880
    buffer_load_dwordx4 v30, s[64:67], s32 offen lds
    v_mfma_f32_16x16x32_bf16 v[228:231], v[52:55], v[44:47], v[228:231]
    ds_read_b64_tr_b16 v[120:121], v7 offset:43104
    v_mfma_f32_16x16x32_bf16 v[232:235], v[56:59], v[44:47], v[232:235]
    v_mfma_f32_16x16x32_bf16 v[236:239], v[60:63], v[44:47], v[236:239]
    ds_read_b64_tr_b16 v[122:123], v7 offset:44896
    v_mfma_f32_16x16x32_bf16 v[240:243], v[64:67], v[44:47], v[240:243]
    ds_read_b64_tr_b16 v[124:125], v7 offset:50272
    v_mfma_f32_16x16x32_bf16 v[244:247], v[68:71], v[44:47], v[244:247]
    ds_read_b64_tr_b16 v[126:127], v7 offset:52064
    v_mfma_f32_16x16x32_bf16 v[248:251], v[72:75], v[44:47], v[248:251]
    v_mfma_f32_16x16x32_bf16 v[252:255], v[76:79], v[44:47], v[252:255]
    s_waitcnt vmcnt(6) lgkmcnt(0)
    s_barrier
    v_add_u32 v5, s45, v28
    s_nop 0
    s_add_u32 m0, s41, 32768
    s_nop 0
    buffer_load_dwordx4 v14, s[16:19], s30 offen lds
    v_mfma_f32_16x16x32_bf16 v[128:131], v[96:99], v[80:83], v[128:131]
    ds_read_b128 v[32:35], v5 offset:0
    v_mfma_f32_16x16x32_bf16 v[132:135], v[100:103], v[80:83], v[132:135]
    ds_read_b128 v[36:39], v5 offset:2048
    v_mfma_f32_16x16x32_bf16 v[136:139], v[104:107], v[80:83], v[136:139]
    v_mfma_f32_16x16x32_bf16 v[140:143], v[108:111], v[80:83], v[140:143]
    ds_read_b128 v[40:43], v5 offset:4096
    v_mfma_f32_16x16x32_bf16 v[144:147], v[112:115], v[80:83], v[144:147]
    ds_read_b128 v[44:47], v5 offset:6144
    v_mfma_f32_16x16x32_bf16 v[148:151], v[116:119], v[80:83], v[148:151]
    ds_read_b64_tr_b16 v[48:49], v7 offset:0
    v_mfma_f32_16x16x32_bf16 v[152:155], v[120:123], v[80:83], v[152:155]
    v_mfma_f32_16x16x32_bf16 v[156:159], v[124:127], v[80:83], v[156:159]
    s_add_u32 m0, s41, 33792
    s_nop 0
    buffer_load_dwordx4 v15, s[16:19], s30 offen lds
    v_mfma_f32_16x16x32_bf16 v[160:163], v[96:99], v[84:87], v[160:163]
    ds_read_b64_tr_b16 v[50:51], v7 offset:1792
    v_mfma_f32_16x16x32_bf16 v[164:167], v[100:103], v[84:87], v[164:167]
    ds_read_b64_tr_b16 v[52:53], v7 offset:7168
    v_mfma_f32_16x16x32_bf16 v[168:171], v[104:107], v[84:87], v[168:171]
    v_mfma_f32_16x16x32_bf16 v[172:175], v[108:111], v[84:87], v[172:175]
    ds_read_b64_tr_b16 v[54:55], v7 offset:8960
    v_mfma_f32_16x16x32_bf16 v[176:179], v[112:115], v[84:87], v[176:179]
    ds_read_b64_tr_b16 v[56:57], v7 offset:32
    v_mfma_f32_16x16x32_bf16 v[180:183], v[116:119], v[84:87], v[180:183]
    ds_read_b64_tr_b16 v[58:59], v7 offset:1824
    v_mfma_f32_16x16x32_bf16 v[184:187], v[120:123], v[84:87], v[184:187]
    v_mfma_f32_16x16x32_bf16 v[188:191], v[124:127], v[84:87], v[188:191]
    s_add_u32 m0, s41, 34816
    s_nop 0
    buffer_load_dwordx4 v16, s[16:19], s30 offen lds
    s_add_u32 s30, s30, 458752
    v_mfma_f32_16x16x32_bf16 v[192:195], v[96:99], v[88:91], v[192:195]
    ds_read_b64_tr_b16 v[60:61], v7 offset:7200
    v_mfma_f32_16x16x32_bf16 v[196:199], v[100:103], v[88:91], v[196:199]
    ds_read_b64_tr_b16 v[62:63], v7 offset:8992
    v_mfma_f32_16x16x32_bf16 v[200:203], v[104:107], v[88:91], v[200:203]
    v_mfma_f32_16x16x32_bf16 v[204:207], v[108:111], v[88:91], v[204:207]
    ds_read_b64_tr_b16 v[64:65], v7 offset:64
    v_mfma_f32_16x16x32_bf16 v[208:211], v[112:115], v[88:91], v[208:211]
    ds_read_b64_tr_b16 v[66:67], v7 offset:1856
    v_mfma_f32_16x16x32_bf16 v[212:215], v[116:119], v[88:91], v[212:215]
    ds_read_b64_tr_b16 v[68:69], v7 offset:7232
    v_mfma_f32_16x16x32_bf16 v[216:219], v[120:123], v[88:91], v[216:219]
    v_mfma_f32_16x16x32_bf16 v[220:223], v[124:127], v[88:91], v[220:223]
    s_mov_b32 m0, 155648
    s_add_u32 s32, s68, 6291456
    buffer_load_dwordx4 v30, s[64:67], s32 offen lds
    v_mfma_f32_16x16x32_bf16 v[224:227], v[96:99], v[92:95], v[224:227]
    ds_read_b64_tr_b16 v[70:71], v7 offset:9024
    v_mfma_f32_16x16x32_bf16 v[228:231], v[100:103], v[92:95], v[228:231]
    ds_read_b64_tr_b16 v[72:73], v7 offset:96
    v_mfma_f32_16x16x32_bf16 v[232:235], v[104:107], v[92:95], v[232:235]
    v_mfma_f32_16x16x32_bf16 v[236:239], v[108:111], v[92:95], v[236:239]
    ds_read_b64_tr_b16 v[74:75], v7 offset:1888
    v_mfma_f32_16x16x32_bf16 v[240:243], v[112:115], v[92:95], v[240:243]
    ds_read_b64_tr_b16 v[76:77], v7 offset:7264
    v_mfma_f32_16x16x32_bf16 v[244:247], v[116:119], v[92:95], v[244:247]
    ds_read_b64_tr_b16 v[78:79], v7 offset:9056
    v_mfma_f32_16x16x32_bf16 v[248:251], v[120:123], v[92:95], v[248:251]
    v_mfma_f32_16x16x32_bf16 v[252:255], v[124:127], v[92:95], v[252:255]
    s_waitcnt vmcnt(63) lgkmcnt(0)
    s_barrier
    v_add_u32 v6, s45, v29
    s_add_u32 s45, s45, 32768
    s_cmp_eq_u32 s45, 98304
    s_cselect_b32 s45, 0, s45
    s_nop 0
    s_add_u32 m0, s41, 0
    s_nop 0
    buffer_load_dwordx4 v10, s[16:19], s30 offen lds
    v_mfma_f32_16x16x32_bf16 v[128:131], v[48:51], v[32:35], v[128:131]
    ds_read_b128 v[80:83], v6 offset:0
    v_mfma_f32_16x16x32_bf16 v[132:135], v[52:55], v[32:35], v[132:135]
    ds_read_b128 v[84:87], v6 offset:2048
    v_mfma_f32_16x16x32_bf16 v[136:139], v[56:59], v[32:35], v[136:139]
    v_mfma_f32_16x16x32_bf16 v[140:143], v[60:63], v[32:35], v[140:143]
    ds_read_b128 v[88:91], v6 offset:4096
    v_mfma_f32_16x16x32_bf16 v[144:147], v[64:67], v[32:35], v[144:147]
    ds_read_b128 v[92:95], v6 offset:6144
    v_mfma_f32_16x16x32_bf16 v[148:151], v[68:71], v[32:35], v[148:151]
    ds_read_b64_tr_b16 v[96:97], v7 offset:14336
    v_mfma_f32_16x16x32_bf16 v[152:155], v[72:75], v[32:35], v[152:155]
    v_mfma_f32_16x16x32_bf16 v[156:159], v[76:79], v[32:35], v[156:159]
    s_add_u32 m0, s41, 1024
    s_nop 0
    buffer_load_dwordx4 v11, s[16:19], s30 offen lds
    v_mfma_f32_16x16x32_bf16 v[160:163], v[48:51], v[36:39], v[160:163]
    ds_read_b64_tr_b16 v[98:99], v7 offset:16128
    v_mfma_f32_16x16x32_bf16 v[164:167], v[52:55], v[36:39], v[164:167]
    ds_read_b64_tr_b16 v[100:101], v7 offset:21504
    v_mfma_f32_16x16x32_bf16 v[168:171], v[56:59], v[36:39], v[168:171]
    v_mfma_f32_16x16x32_bf16 v[172:175], v[60:63], v[36:39], v[172:175]
    ds_read_b64_tr_b16 v[102:103], v7 offset:23296
    v_mfma_f32_16x16x32_bf16 v[176:179], v[64:67], v[36:39], v[176:179]
    ds_read_b64_tr_b16 v[104:105], v7 offset:14368
    v_mfma_f32_16x16x32_bf16 v[180:183], v[68:71], v[36:39], v[180:183]
    ds_read_b64_tr_b16 v[106:107], v7 offset:16160
    v_mfma_f32_16x16x32_bf16 v[184:187], v[72:75], v[36:39], v[184:187]
    v_mfma_f32_16x16x32_bf16 v[188:191], v[76:79], v[36:39], v[188:191]
    s_add_u32 m0, s41, 2048
    s_nop 0
    buffer_load_dwordx4 v12, s[16:19], s30 offen lds
    v_mfma_f32_16x16x32_bf16 v[192:195], v[48:51], v[40:43], v[192:195]
    ds_read_b64_tr_b16 v[108:109], v7 offset:21536
    v_mfma_f32_16x16x32_bf16 v[196:199], v[52:55], v[40:43], v[196:199]
    ds_read_b64_tr_b16 v[110:111], v7 offset:23328
    v_mfma_f32_16x16x32_bf16 v[200:203], v[56:59], v[40:43], v[200:203]
    v_mfma_f32_16x16x32_bf16 v[204:207], v[60:63], v[40:43], v[204:207]
    ds_read_b64_tr_b16 v[112:113], v7 offset:14400
    v_mfma_f32_16x16x32_bf16 v[208:211], v[64:67], v[40:43], v[208:211]
    ds_read_b64_tr_b16 v[114:115], v7 offset:16192
    v_mfma_f32_16x16x32_bf16 v[212:215], v[68:71], v[40:43], v[212:215]
    ds_read_b64_tr_b16 v[116:117], v7 offset:21568
    v_mfma_f32_16x16x32_bf16 v[216:219], v[72:75], v[40:43], v[216:219]
    v_mfma_f32_16x16x32_bf16 v[220:223], v[76:79], v[40:43], v[220:223]
    s_add_u32 m0, s41, 3072
    s_nop 0
    buffer_load_dwordx4 v13, s[16:19], s30 offen lds
    v_mfma_f32_16x16x32_bf16 v[224:227], v[48:51], v[44:47], v[224:227]
    ds_read_b64_tr_b16 v[118:119], v7 offset:23360
    v_mfma_f32_16x16x32_bf16 v[228:231], v[52:55], v[44:47], v[228:231]
    ds_read_b64_tr_b16 v[120:121], v7 offset:14432
    v_mfma_f32_16x16x32_bf16 v[232:235], v[56:59], v[44:47], v[232:235]
    v_mfma_f32_16x16x32_bf16 v[236:239], v[60:63], v[44:47], v[236:239]
    ds_read_b64_tr_b16 v[122:123], v7 offset:16224
    v_mfma_f32_16x16x32_bf16 v[240:243], v[64:67], v[44:47], v[240:243]
    ds_read_b64_tr_b16 v[124:125], v7 offset:21600
    v_mfma_f32_16x16x32_bf16 v[244:247], v[68:71], v[44:47], v[244:247]
    ds_read_b64_tr_b16 v[126:127], v7 offset:23392
    v_mfma_f32_16x16x32_bf16 v[248:251], v[72:75], v[44:47], v[248:251]
    v_mfma_f32_16x16x32_bf16 v[252:255], v[76:79], v[44:47], v[252:255]
    s_waitcnt vmcnt(5) lgkmcnt(0)
    s_barrier
    v_add_u32 v5, s45, v28
    s_nop 0
    s_add_u32 m0, s41, 4096
    s_nop 0
    buffer_load_dwordx4 v14, s[16:19], s30 offen lds
    v_mfma_f32_16x16x32_bf16 v[128:131], v[96:99], v[80:83], v[128:131]
    ds_read_b128 v[32:35], v5 offset:0
    v_mfma_f32_16x16x32_bf16 v[132:135], v[100:103], v[80:83], v[132:135]
    ds_read_b128 v[36:39], v5 offset:2048
    v_mfma_f32_16x16x32_bf16 v[136:139], v[104:107], v[80:83], v[136:139]
    v_mfma_f32_16x16x32_bf16 v[140:143], v[108:111], v[80:83], v[140:143]
    ds_read_b128 v[40:43], v5 offset:4096
    v_mfma_f32_16x16x32_bf16 v[144:147], v[112:115], v[80:83], v[144:147]
    ds_read_b128 v[44:47], v5 offset:6144
    v_mfma_f32_16x16x32_bf16 v[148:151], v[116:119], v[80:83], v[148:151]
    ds_read_b64_tr_b16 v[48:49], v7 offset:28672
    v_mfma_f32_16x16x32_bf16 v[152:155], v[120:123], v[80:83], v[152:155]
    v_mfma_f32_16x16x32_bf16 v[156:159], v[124:127], v[80:83], v[156:159]
    ds_read_b64_tr_b16 v[50:51], v7 offset:30464
    v_mfma_f32_16x16x32_bf16 v[160:163], v[96:99], v[84:87], v[160:163]
    ds_read_b64_tr_b16 v[52:53], v7 offset:35840
    v_mfma_f32_16x16x32_bf16 v[164:167], v[100:103], v[84:87], v[164:167]
    v_mfma_f32_16x16x32_bf16 v[168:171], v[104:107], v[84:87], v[168:171]
    s_add_u32 m0, s41, 5120
    s_nop 0
    buffer_load_dwordx4 v15, s[16:19], s30 offen lds
    v_mfma_f32_16x16x32_bf16 v[172:175], v[108:111], v[84:87], v[172:175]
    ds_read_b64_tr_b16 v[54:55], v7 offset:37632
    v_mfma_f32_16x16x32_bf16 v[176:179], v[112:115], v[84:87], v[176:179]
    ds_read_b64_tr_b16 v[56:57], v7 offset:28704
    v_mfma_f32_16x16x32_bf16 v[180:183], v[116:119], v[84:87], v[180:183]
    v_mfma_f32_16x16x32_bf16 v[184:187], v[120:123], v[84:87], v[184:187]
    ds_read_b64_tr_b16 v[58:59], v7 offset:30496
    v_mfma_f32_16x16x32_bf16 v[188:191], v[124:127], v[84:87], v[188:191]
    ds_read_b64_tr_b16 v[60:61], v7 offset:35872
    v_mfma_f32_16x16x32_bf16 v[192:195], v[96:99], v[88:91], v[192:195]
    v_mfma_f32_16x16x32_bf16 v[196:199], v[100:103], v[88:91], v[196:199]
    ds_read_b64_tr_b16 v[62:63], v7 offset:37664
    v_mfma_f32_16x16x32_bf16 v[200:203], v[104:107], v[88:91], v[200:203]
    ds_read_b64_tr_b16 v[64:65], v7 offset:28736
    v_mfma_f32_16x16x32_bf16 v[204:207], v[108:111], v[88:91], v[204:207]
    ds_read_b64_tr_b16 v[66:67], v7 offset:30528
    v_mfma_f32_16x16x32_bf16 v[208:211], v[112:115], v[88:91], v[208:211]
    v_mfma_f32_16x16x32_bf16 v[212:215], v[116:119], v[88:91], v[212:215]
    s_add_u32 m0, s41, 6144
    s_nop 0
    buffer_load_dwordx4 v16, s[16:19], s30 offen lds
    s_add_u32 s30, s30, 458752
    v_mfma_f32_16x16x32_bf16 v[216:219], v[120:123], v[88:91], v[216:219]
    ds_read_b64_tr_b16 v[68:69], v7 offset:35904
    v_mfma_f32_16x16x32_bf16 v[220:223], v[124:127], v[88:91], v[220:223]
    v_mfma_f32_16x16x32_bf16 v[224:227], v[96:99], v[92:95], v[224:227]
    ds_read_b64_tr_b16 v[70:71], v7 offset:37696
    v_mfma_f32_16x16x32_bf16 v[228:231], v[100:103], v[92:95], v[228:231]
    ds_read_b64_tr_b16 v[72:73], v7 offset:28768
    v_mfma_f32_16x16x32_bf16 v[232:235], v[104:107], v[92:95], v[232:235]
    ds_read_b64_tr_b16 v[74:75], v7 offset:30560
    v_mfma_f32_16x16x32_bf16 v[236:239], v[108:111], v[92:95], v[236:239]
    v_mfma_f32_16x16x32_bf16 v[240:243], v[112:115], v[92:95], v[240:243]
    ds_read_b64_tr_b16 v[76:77], v7 offset:35936
    v_mfma_f32_16x16x32_bf16 v[244:247], v[116:119], v[92:95], v[244:247]
    ds_read_b64_tr_b16 v[78:79], v7 offset:37728
    v_mfma_f32_16x16x32_bf16 v[248:251], v[120:123], v[92:95], v[248:251]
    v_mfma_f32_16x16x32_bf16 v[252:255], v[124:127], v[92:95], v[252:255]
    s_waitcnt vmcnt(63) lgkmcnt(0)
    s_barrier
    v_add_u32 v6, s45, v29
    s_add_u32 s45, s45, 32768
    s_cmp_eq_u32 s45, 98304
    s_cselect_b32 s45, 0, s45
    s_nop 0
    s_add_u32 m0, s41, 28672
    s_nop 0
    buffer_load_dwordx4 v10, s[16:19], s30 offen lds
    v_mfma_f32_16x16x32_bf16 v[128:131], v[48:51], v[32:35], v[128:131]
    ds_read_b128 v[80:83], v6 offset:0
    v_mfma_f32_16x16x32_bf16 v[132:135], v[52:55], v[32:35], v[132:135]
    ds_read_b128 v[84:87], v6 offset:2048
    v_mfma_f32_16x16x32_bf16 v[136:139], v[56:59], v[32:35], v[136:139]
    v_mfma_f32_16x16x32_bf16 v[140:143], v[60:63], v[32:35], v[140:143]
    ds_read_b128 v[88:91], v6 offset:4096
    v_mfma_f32_16x16x32_bf16 v[144:147], v[64:67], v[32:35], v[144:147]
    ds_read_b128 v[92:95], v6 offset:6144
    v_mfma_f32_16x16x32_bf16 v[148:151], v[68:71], v[32:35], v[148:151]
    ds_read_b64_tr_b16 v[96:97], v7 offset:43008
    v_mfma_f32_16x16x32_bf16 v[152:155], v[72:75], v[32:35], v[152:155]
    v_mfma_f32_16x16x32_bf16 v[156:159], v[76:79], v[32:35], v[156:159]
    s_add_u32 m0, s41, 29696
    s_nop 0
    buffer_load_dwordx4 v11, s[16:19], s30 offen lds
    v_mfma_f32_16x16x32_bf16 v[160:163], v[48:51], v[36:39], v[160:163]
    ds_read_b64_tr_b16 v[98:99], v7 offset:44800
    v_mfma_f32_16x16x32_bf16 v[164:167], v[52:55], v[36:39], v[164:167]
    ds_read_b64_tr_b16 v[100:101], v7 offset:50176
    v_mfma_f32_16x16x32_bf16 v[168:171], v[56:59], v[36:39], v[168:171]
    v_mfma_f32_16x16x32_bf16 v[172:175], v[60:63], v[36:39], v[172:175]
    ds_read_b64_tr_b16 v[102:103], v7 offset:51968
    v_mfma_f32_16x16x32_bf16 v[176:179], v[64:67], v[36:39], v[176:179]
    ds_read_b64_tr_b16 v[104:105], v7 offset:43040
    v_mfma_f32_16x16x32_bf16 v[180:183], v[68:71], v[36:39], v[180:183]
    ds_read_b64_tr_b16 v[106:107], v7 offset:44832
    v_mfma_f32_16x16x32_bf16 v[184:187], v[72:75], v[36:39], v[184:187]
    v_mfma_f32_16x16x32_bf16 v[188:191], v[76:79], v[36:39], v[188:191]
    s_add_u32 m0, s41, 30720
    s_nop 0
    buffer_load_dwordx4 v12, s[16:19], s30 offen lds
    v_mfma_f32_16x16x32_bf16 v[192:195], v[48:51], v[40:43], v[192:195]
    ds_read_b64_tr_b16 v[108:109], v7 offset:50208
    v_mfma_f32_16x16x32_bf16 v[196:199], v[52:55], v[40:43], v[196:199]
    ds_read_b64_tr_b16 v[110:111], v7 offset:52000
    v_mfma_f32_16x16x32_bf16 v[200:203], v[56:59], v[40:43], v[200:203]
    v_mfma_f32_16x16x32_bf16 v[204:207], v[60:63], v[40:43], v[204:207]
    ds_read_b64_tr_b16 v[112:113], v7 offset:43072
    v_mfma_f32_16x16x32_bf16 v[208:211], v[64:67], v[40:43], v[208:211]
    ds_read_b64_tr_b16 v[114:115], v7 offset:44864
    v_mfma_f32_16x16x32_bf16 v[212:215], v[68:71], v[40:43], v[212:215]
    ds_read_b64_tr_b16 v[116:117], v7 offset:50240
    v_mfma_f32_16x16x32_bf16 v[216:219], v[72:75], v[40:43], v[216:219]
    v_mfma_f32_16x16x32_bf16 v[220:223], v[76:79], v[40:43], v[220:223]
    s_add_u32 m0, s41, 31744
    s_nop 0
    buffer_load_dwordx4 v13, s[16:19], s30 offen lds
    v_mfma_f32_16x16x32_bf16 v[224:227], v[48:51], v[44:47], v[224:227]
    ds_read_b64_tr_b16 v[118:119], v7 offset:52032
    v_mfma_f32_16x16x32_bf16 v[228:231], v[52:55], v[44:47], v[228:231]
    ds_read_b64_tr_b16 v[120:121], v7 offset:43104
    v_mfma_f32_16x16x32_bf16 v[232:235], v[56:59], v[44:47], v[232:235]
    v_mfma_f32_16x16x32_bf16 v[236:239], v[60:63], v[44:47], v[236:239]
    ds_read_b64_tr_b16 v[122:123], v7 offset:44896
    v_mfma_f32_16x16x32_bf16 v[240:243], v[64:67], v[44:47], v[240:243]
    ds_read_b64_tr_b16 v[124:125], v7 offset:50272
    v_mfma_f32_16x16x32_bf16 v[244:247], v[68:71], v[44:47], v[244:247]
    ds_read_b64_tr_b16 v[126:127], v7 offset:52064
    v_mfma_f32_16x16x32_bf16 v[248:251], v[72:75], v[44:47], v[248:251]
    v_mfma_f32_16x16x32_bf16 v[252:255], v[76:79], v[44:47], v[252:255]
    s_waitcnt vmcnt(4) lgkmcnt(0)
    s_barrier
    v_add_u32 v5, s45, v28
    s_nop 0
    s_add_u32 m0, s41, 32768
    s_nop 0
    buffer_load_dwordx4 v14, s[16:19], s30 offen lds
    v_mfma_f32_16x16x32_bf16 v[128:131], v[96:99], v[80:83], v[128:131]
    ds_read_b128 v[32:35], v5 offset:0
    v_mfma_f32_16x16x32_bf16 v[132:135], v[100:103], v[80:83], v[132:135]
    ds_read_b128 v[36:39], v5 offset:2048
    v_mfma_f32_16x16x32_bf16 v[136:139], v[104:107], v[80:83], v[136:139]
    v_mfma_f32_16x16x32_bf16 v[140:143], v[108:111], v[80:83], v[140:143]
    ds_read_b128 v[40:43], v5 offset:4096
    v_mfma_f32_16x16x32_bf16 v[144:147], v[112:115], v[80:83], v[144:147]
    ds_read_b128 v[44:47], v5 offset:6144
    v_mfma_f32_16x16x32_bf16 v[148:151], v[116:119], v[80:83], v[148:151]
    ds_read_b64_tr_b16 v[48:49], v7 offset:0
    v_mfma_f32_16x16x32_bf16 v[152:155], v[120:123], v[80:83], v[152:155]
    v_mfma_f32_16x16x32_bf16 v[156:159], v[124:127], v[80:83], v[156:159]
    ds_read_b64_tr_b16 v[50:51], v7 offset:1792
    v_mfma_f32_16x16x32_bf16 v[160:163], v[96:99], v[84:87], v[160:163]
    ds_read_b64_tr_b16 v[52:53], v7 offset:7168
    v_mfma_f32_16x16x32_bf16 v[164:167], v[100:103], v[84:87], v[164:167]
    v_mfma_f32_16x16x32_bf16 v[168:171], v[104:107], v[84:87], v[168:171]
    s_add_u32 m0, s41, 33792
    s_nop 0
    buffer_load_dwordx4 v15, s[16:19], s30 offen lds
    v_mfma_f32_16x16x32_bf16 v[172:175], v[108:111], v[84:87], v[172:175]
    ds_read_b64_tr_b16 v[54:55], v7 offset:8960
    v_mfma_f32_16x16x32_bf16 v[176:179], v[112:115], v[84:87], v[176:179]
    ds_read_b64_tr_b16 v[56:57], v7 offset:32
    v_mfma_f32_16x16x32_bf16 v[180:183], v[116:119], v[84:87], v[180:183]
    v_mfma_f32_16x16x32_bf16 v[184:187], v[120:123], v[84:87], v[184:187]
    ds_read_b64_tr_b16 v[58:59], v7 offset:1824
    v_mfma_f32_16x16x32_bf16 v[188:191], v[124:127], v[84:87], v[188:191]
    ds_read_b64_tr_b16 v[60:61], v7 offset:7200
    v_mfma_f32_16x16x32_bf16 v[192:195], v[96:99], v[88:91], v[192:195]
    v_mfma_f32_16x16x32_bf16 v[196:199], v[100:103], v[88:91], v[196:199]
    ds_read_b64_tr_b16 v[62:63], v7 offset:8992
    v_mfma_f32_16x16x32_bf16 v[200:203], v[104:107], v[88:91], v[200:203]
    ds_read_b64_tr_b16 v[64:65], v7 offset:64
    v_mfma_f32_16x16x32_bf16 v[204:207], v[108:111], v[88:91], v[204:207]
    ds_read_b64_tr_b16 v[66:67], v7 offset:1856
    v_mfma_f32_16x16x32_bf16 v[208:211], v[112:115], v[88:91], v[208:211]
    v_mfma_f32_16x16x32_bf16 v[212:215], v[116:119], v[88:91], v[212:215]
    s_add_u32 m0, s41, 34816
    s_nop 0
    buffer_load_dwordx4 v16, s[16:19], s30 offen lds
    s_add_u32 s30, s30, 458752
    v_mfma_f32_16x16x32_bf16 v[216:219], v[120:123], v[88:91], v[216:219]
    ds_read_b64_tr_b16 v[68:69], v7 offset:7232
    v_mfma_f32_16x16x32_bf16 v[220:223], v[124:127], v[88:91], v[220:223]
    v_mfma_f32_16x16x32_bf16 v[224:227], v[96:99], v[92:95], v[224:227]
    ds_read_b64_tr_b16 v[70:71], v7 offset:9024
    v_mfma_f32_16x16x32_bf16 v[228:231], v[100:103], v[92:95], v[228:231]
    ds_read_b64_tr_b16 v[72:73], v7 offset:96
    v_mfma_f32_16x16x32_bf16 v[232:235], v[104:107], v[92:95], v[232:235]
    ds_read_b64_tr_b16 v[74:75], v7 offset:1888
    v_mfma_f32_16x16x32_bf16 v[236:239], v[108:111], v[92:95], v[236:239]
    v_mfma_f32_16x16x32_bf16 v[240:243], v[112:115], v[92:95], v[240:243]
    ds_read_b64_tr_b16 v[76:77], v7 offset:7264
    v_mfma_f32_16x16x32_bf16 v[244:247], v[116:119], v[92:95], v[244:247]
    ds_read_b64_tr_b16 v[78:79], v7 offset:9056
    v_mfma_f32_16x16x32_bf16 v[248:251], v[120:123], v[92:95], v[248:251]
    v_mfma_f32_16x16x32_bf16 v[252:255], v[124:127], v[92:95], v[252:255]
    s_waitcnt vmcnt(63) lgkmcnt(0)
    s_barrier
    s_mov_b32 s29, 3
K1T00_LOOP:
    v_add_u32 v6, s45, v29
    s_add_u32 s45, s45, 32768
    s_cmp_eq_u32 s45, 98304
    s_cselect_b32 s45, 0, s45
    s_nop 0
    s_add_u32 m0, s41, 0
    s_nop 0
    buffer_load_dwordx4 v10, s[16:19], s30 offen lds
    v_mfma_f32_16x16x32_bf16 v[128:131], v[48:51], v[32:35], v[128:131]
    ds_read_b128 v[80:83], v6 offset:0
    v_mfma_f32_16x16x32_bf16 v[132:135], v[52:55], v[32:35], v[132:135]
    ds_read_b128 v[84:87], v6 offset:2048
    v_mfma_f32_16x16x32_bf16 v[136:139], v[56:59], v[32:35], v[136:139]
    v_mfma_f32_16x16x32_bf16 v[140:143], v[60:63], v[32:35], v[140:143]
    ds_read_b128 v[88:91], v6 offset:4096
    v_mfma_f32_16x16x32_bf16 v[144:147], v[64:67], v[32:35], v[144:147]
    ds_read_b128 v[92:95], v6 offset:6144
    v_mfma_f32_16x16x32_bf16 v[148:151], v[68:71], v[32:35], v[148:151]
    ds_read_b64_tr_b16 v[96:97], v7 offset:14336
    v_mfma_f32_16x16x32_bf16 v[152:155], v[72:75], v[32:35], v[152:155]
    v_mfma_f32_16x16x32_bf16 v[156:159], v[76:79], v[32:35], v[156:159]
    s_add_u32 m0, s41, 1024
    s_nop 0
    buffer_load_dwordx4 v11, s[16:19], s30 offen lds
    v_mfma_f32_16x16x32_bf16 v[160:163], v[48:51], v[36:39], v[160:163]
    ds_read_b64_tr_b16 v[98:99], v7 offset:16128
    v_mfma_f32_16x16x32_bf16 v[164:167], v[52:55], v[36:39], v[164:167]
    ds_read_b64_tr_b16 v[100:101], v7 offset:21504
    v_mfma_f32_16x16x32_bf16 v[168:171], v[56:59], v[36:39], v[168:171]
    v_mfma_f32_16x16x32_bf16 v[172:175], v[60:63], v[36:39], v[172:175]
    ds_read_b64_tr_b16 v[102:103], v7 offset:23296
    v_mfma_f32_16x16x32_bf16 v[176:179], v[64:67], v[36:39], v[176:179]
    ds_read_b64_tr_b16 v[104:105], v7 offset:14368
    v_mfma_f32_16x16x32_bf16 v[180:183], v[68:71], v[36:39], v[180:183]
    ds_read_b64_tr_b16 v[106:107], v7 offset:16160
    v_mfma_f32_16x16x32_bf16 v[184:187], v[72:75], v[36:39], v[184:187]
    v_mfma_f32_16x16x32_bf16 v[188:191], v[76:79], v[36:39], v[188:191]
    s_add_u32 m0, s41, 2048
    s_nop 0
    buffer_load_dwordx4 v12, s[16:19], s30 offen lds
    v_mfma_f32_16x16x32_bf16 v[192:195], v[48:51], v[40:43], v[192:195]
    ds_read_b64_tr_b16 v[108:109], v7 offset:21536
    v_mfma_f32_16x16x32_bf16 v[196:199], v[52:55], v[40:43], v[196:199]
    ds_read_b64_tr_b16 v[110:111], v7 offset:23328
    v_mfma_f32_16x16x32_bf16 v[200:203], v[56:59], v[40:43], v[200:203]
    v_mfma_f32_16x16x32_bf16 v[204:207], v[60:63], v[40:43], v[204:207]
    ds_read_b64_tr_b16 v[112:113], v7 offset:14400
    v_mfma_f32_16x16x32_bf16 v[208:211], v[64:67], v[40:43], v[208:211]
    ds_read_b64_tr_b16 v[114:115], v7 offset:16192
    v_mfma_f32_16x16x32_bf16 v[212:215], v[68:71], v[40:43], v[212:215]
    ds_read_b64_tr_b16 v[116:117], v7 offset:21568
    v_mfma_f32_16x16x32_bf16 v[216:219], v[72:75], v[40:43], v[216:219]
    v_mfma_f32_16x16x32_bf16 v[220:223], v[76:79], v[40:43], v[220:223]
    s_add_u32 m0, s41, 3072
    s_nop 0
    buffer_load_dwordx4 v13, s[16:19], s30 offen lds
    v_mfma_f32_16x16x32_bf16 v[224:227], v[48:51], v[44:47], v[224:227]
    ds_read_b64_tr_b16 v[118:119], v7 offset:23360
    v_mfma_f32_16x16x32_bf16 v[228:231], v[52:55], v[44:47], v[228:231]
    ds_read_b64_tr_b16 v[120:121], v7 offset:14432
    v_mfma_f32_16x16x32_bf16 v[232:235], v[56:59], v[44:47], v[232:235]
    v_mfma_f32_16x16x32_bf16 v[236:239], v[60:63], v[44:47], v[236:239]
    ds_read_b64_tr_b16 v[122:123], v7 offset:16224
    v_mfma_f32_16x16x32_bf16 v[240:243], v[64:67], v[44:47], v[240:243]
    ds_read_b64_tr_b16 v[124:125], v7 offset:21600
    v_mfma_f32_16x16x32_bf16 v[244:247], v[68:71], v[44:47], v[244:247]
    ds_read_b64_tr_b16 v[126:127], v7 offset:23392
    v_mfma_f32_16x16x32_bf16 v[248:251], v[72:75], v[44:47], v[248:251]
    v_mfma_f32_16x16x32_bf16 v[252:255], v[76:79], v[44:47], v[252:255]
    s_waitcnt vmcnt(4) lgkmcnt(0)
    s_barrier
    v_add_u32 v5, s45, v28
    s_nop 0
    s_add_u32 m0, s41, 4096
    s_nop 0
    buffer_load_dwordx4 v14, s[16:19], s30 offen lds
    v_mfma_f32_16x16x32_bf16 v[128:131], v[96:99], v[80:83], v[128:131]
    ds_read_b128 v[32:35], v5 offset:0
    v_mfma_f32_16x16x32_bf16 v[132:135], v[100:103], v[80:83], v[132:135]
    ds_read_b128 v[36:39], v5 offset:2048
    v_mfma_f32_16x16x32_bf16 v[136:139], v[104:107], v[80:83], v[136:139]
    v_mfma_f32_16x16x32_bf16 v[140:143], v[108:111], v[80:83], v[140:143]
    ds_read_b128 v[40:43], v5 offset:4096
    v_mfma_f32_16x16x32_bf16 v[144:147], v[112:115], v[80:83], v[144:147]
    ds_read_b128 v[44:47], v5 offset:6144
    v_mfma_f32_16x16x32_bf16 v[148:151], v[116:119], v[80:83], v[148:151]
    ds_read_b64_tr_b16 v[48:49], v7 offset:28672
    v_mfma_f32_16x16x32_bf16 v[152:155], v[120:123], v[80:83], v[152:155]
    v_mfma_f32_16x16x32_bf16 v[156:159], v[124:127], v[80:83], v[156:159]
    ds_read_b64_tr_b16 v[50:51], v7 offset:30464
    v_mfma_f32_16x16x32_bf16 v[160:163], v[96:99], v[84:87], v[160:163]
    ds_read_b64_tr_b16 v[52:53], v7 offset:35840
    v_mfma_f32_16x16x32_bf16 v[164:167], v[100:103], v[84:87], v[164:167]
    v_mfma_f32_16x16x32_bf16 v[168:171], v[104:107], v[84:87], v[168:171]
    s_add_u32 m0, s41, 5120
    s_nop 0
    buffer_load_dwordx4 v15, s[16:19], s30 offen lds
    v_mfma_f32_16x16x32_bf16 v[172:175], v[108:111], v[84:87], v[172:175]
    ds_read_b64_tr_b16 v[54:55], v7 offset:37632
    v_mfma_f32_16x16x32_bf16 v[176:179], v[112:115], v[84:87], v[176:179]
    ds_read_b64_tr_b16 v[56:57], v7 offset:28704
    v_mfma_f32_16x16x32_bf16 v[180:183], v[116:119], v[84:87], v[180:183]
    v_mfma_f32_16x16x32_bf16 v[184:187], v[120:123], v[84:87], v[184:187]
    ds_read_b64_tr_b16 v[58:59], v7 offset:30496
    v_mfma_f32_16x16x32_bf16 v[188:191], v[124:127], v[84:87], v[188:191]
    ds_read_b64_tr_b16 v[60:61], v7 offset:35872
    v_mfma_f32_16x16x32_bf16 v[192:195], v[96:99], v[88:91], v[192:195]
    v_mfma_f32_16x16x32_bf16 v[196:199], v[100:103], v[88:91], v[196:199]
    ds_read_b64_tr_b16 v[62:63], v7 offset:37664
    v_mfma_f32_16x16x32_bf16 v[200:203], v[104:107], v[88:91], v[200:203]
    ds_read_b64_tr_b16 v[64:65], v7 offset:28736
    v_mfma_f32_16x16x32_bf16 v[204:207], v[108:111], v[88:91], v[204:207]
    ds_read_b64_tr_b16 v[66:67], v7 offset:30528
    v_mfma_f32_16x16x32_bf16 v[208:211], v[112:115], v[88:91], v[208:211]
    v_mfma_f32_16x16x32_bf16 v[212:215], v[116:119], v[88:91], v[212:215]
    s_add_u32 m0, s41, 6144
    s_nop 0
    buffer_load_dwordx4 v16, s[16:19], s30 offen lds
    s_add_u32 s30, s30, 458752
    v_mfma_f32_16x16x32_bf16 v[216:219], v[120:123], v[88:91], v[216:219]
    ds_read_b64_tr_b16 v[68:69], v7 offset:35904
    v_mfma_f32_16x16x32_bf16 v[220:223], v[124:127], v[88:91], v[220:223]
    v_mfma_f32_16x16x32_bf16 v[224:227], v[96:99], v[92:95], v[224:227]
    ds_read_b64_tr_b16 v[70:71], v7 offset:37696
    v_mfma_f32_16x16x32_bf16 v[228:231], v[100:103], v[92:95], v[228:231]
    ds_read_b64_tr_b16 v[72:73], v7 offset:28768
    v_mfma_f32_16x16x32_bf16 v[232:235], v[104:107], v[92:95], v[232:235]
    ds_read_b64_tr_b16 v[74:75], v7 offset:30560
    v_mfma_f32_16x16x32_bf16 v[236:239], v[108:111], v[92:95], v[236:239]
    v_mfma_f32_16x16x32_bf16 v[240:243], v[112:115], v[92:95], v[240:243]
    ds_read_b64_tr_b16 v[76:77], v7 offset:35936
    v_mfma_f32_16x16x32_bf16 v[244:247], v[116:119], v[92:95], v[244:247]
    ds_read_b64_tr_b16 v[78:79], v7 offset:37728
    v_mfma_f32_16x16x32_bf16 v[248:251], v[120:123], v[92:95], v[248:251]
    v_mfma_f32_16x16x32_bf16 v[252:255], v[124:127], v[92:95], v[252:255]
    s_waitcnt vmcnt(63) lgkmcnt(0)
    s_barrier
    v_add_u32 v6, s45, v29
    s_add_u32 s45, s45, 32768
    s_cmp_eq_u32 s45, 98304
    s_cselect_b32 s45, 0, s45
    s_nop 0
    s_add_u32 m0, s41, 28672
    s_nop 0
    buffer_load_dwordx4 v10, s[16:19], s30 offen lds
    v_mfma_f32_16x16x32_bf16 v[128:131], v[48:51], v[32:35], v[128:131]
    ds_read_b128 v[80:83], v6 offset:0
    v_mfma_f32_16x16x32_bf16 v[132:135], v[52:55], v[32:35], v[132:135]
    ds_read_b128 v[84:87], v6 offset:2048
    v_mfma_f32_16x16x32_bf16 v[136:139], v[56:59], v[32:35], v[136:139]
    v_mfma_f32_16x16x32_bf16 v[140:143], v[60:63], v[32:35], v[140:143]
    ds_read_b128 v[88:91], v6 offset:4096
    v_mfma_f32_16x16x32_bf16 v[144:147], v[64:67], v[32:35], v[144:147]
    ds_read_b128 v[92:95], v6 offset:6144
    v_mfma_f32_16x16x32_bf16 v[148:151], v[68:71], v[32:35], v[148:151]
    ds_read_b64_tr_b16 v[96:97], v7 offset:43008
    v_mfma_f32_16x16x32_bf16 v[152:155], v[72:75], v[32:35], v[152:155]
    v_mfma_f32_16x16x32_bf16 v[156:159], v[76:79], v[32:35], v[156:159]
    s_add_u32 m0, s41, 29696
    s_nop 0
    buffer_load_dwordx4 v11, s[16:19], s30 offen lds
    v_mfma_f32_16x16x32_bf16 v[160:163], v[48:51], v[36:39], v[160:163]
    ds_read_b64_tr_b16 v[98:99], v7 offset:44800
    v_mfma_f32_16x16x32_bf16 v[164:167], v[52:55], v[36:39], v[164:167]
    ds_read_b64_tr_b16 v[100:101], v7 offset:50176
    v_mfma_f32_16x16x32_bf16 v[168:171], v[56:59], v[36:39], v[168:171]
    v_mfma_f32_16x16x32_bf16 v[172:175], v[60:63], v[36:39], v[172:175]
    ds_read_b64_tr_b16 v[102:103], v7 offset:51968
    v_mfma_f32_16x16x32_bf16 v[176:179], v[64:67], v[36:39], v[176:179]
    ds_read_b64_tr_b16 v[104:105], v7 offset:43040
    v_mfma_f32_16x16x32_bf16 v[180:183], v[68:71], v[36:39], v[180:183]
    ds_read_b64_tr_b16 v[106:107], v7 offset:44832
    v_mfma_f32_16x16x32_bf16 v[184:187], v[72:75], v[36:39], v[184:187]
    v_mfma_f32_16x16x32_bf16 v[188:191], v[76:79], v[36:39], v[188:191]
    s_add_u32 m0, s41, 30720
    s_nop 0
    buffer_load_dwordx4 v12, s[16:19], s30 offen lds
    v_mfma_f32_16x16x32_bf16 v[192:195], v[48:51], v[40:43], v[192:195]
    ds_read_b64_tr_b16 v[108:109], v7 offset:50208
    v_mfma_f32_16x16x32_bf16 v[196:199], v[52:55], v[40:43], v[196:199]
    ds_read_b64_tr_b16 v[110:111], v7 offset:52000
    v_mfma_f32_16x16x32_bf16 v[200:203], v[56:59], v[40:43], v[200:203]
    v_mfma_f32_16x16x32_bf16 v[204:207], v[60:63], v[40:43], v[204:207]
    ds_read_b64_tr_b16 v[112:113], v7 offset:43072
    v_mfma_f32_16x16x32_bf16 v[208:211], v[64:67], v[40:43], v[208:211]
    ds_read_b64_tr_b16 v[114:115], v7 offset:44864
    v_mfma_f32_16x16x32_bf16 v[212:215], v[68:71], v[40:43], v[212:215]
    ds_read_b64_tr_b16 v[116:117], v7 offset:50240
    v_mfma_f32_16x16x32_bf16 v[216:219], v[72:75], v[40:43], v[216:219]
    v_mfma_f32_16x16x32_bf16 v[220:223], v[76:79], v[40:43], v[220:223]
    s_add_u32 m0, s41, 31744
    s_nop 0
    buffer_load_dwordx4 v13, s[16:19], s30 offen lds
    v_mfma_f32_16x16x32_bf16 v[224:227], v[48:51], v[44:47], v[224:227]
    ds_read_b64_tr_b16 v[118:119], v7 offset:52032
    v_mfma_f32_16x16x32_bf16 v[228:231], v[52:55], v[44:47], v[228:231]
    ds_read_b64_tr_b16 v[120:121], v7 offset:43104
    v_mfma_f32_16x16x32_bf16 v[232:235], v[56:59], v[44:47], v[232:235]
    v_mfma_f32_16x16x32_bf16 v[236:239], v[60:63], v[44:47], v[236:239]
    ds_read_b64_tr_b16 v[122:123], v7 offset:44896
    v_mfma_f32_16x16x32_bf16 v[240:243], v[64:67], v[44:47], v[240:243]
    ds_read_b64_tr_b16 v[124:125], v7 offset:50272
    v_mfma_f32_16x16x32_bf16 v[244:247], v[68:71], v[44:47], v[244:247]
    ds_read_b64_tr_b16 v[126:127], v7 offset:52064
    v_mfma_f32_16x16x32_bf16 v[248:251], v[72:75], v[44:47], v[248:251]
    v_mfma_f32_16x16x32_bf16 v[252:255], v[76:79], v[44:47], v[252:255]
    s_waitcnt vmcnt(4) lgkmcnt(0)
    s_barrier
    v_add_u32 v5, s45, v28
    s_nop 0
    s_add_u32 m0, s41, 32768
    s_nop 0
    buffer_load_dwordx4 v14, s[16:19], s30 offen lds
    v_mfma_f32_16x16x32_bf16 v[128:131], v[96:99], v[80:83], v[128:131]
    ds_read_b128 v[32:35], v5 offset:0
    v_mfma_f32_16x16x32_bf16 v[132:135], v[100:103], v[80:83], v[132:135]
    ds_read_b128 v[36:39], v5 offset:2048
    v_mfma_f32_16x16x32_bf16 v[136:139], v[104:107], v[80:83], v[136:139]
    v_mfma_f32_16x16x32_bf16 v[140:143], v[108:111], v[80:83], v[140:143]
    ds_read_b128 v[40:43], v5 offset:4096
    v_mfma_f32_16x16x32_bf16 v[144:147], v[112:115], v[80:83], v[144:147]
    ds_read_b128 v[44:47], v5 offset:6144
    v_mfma_f32_16x16x32_bf16 v[148:151], v[116:119], v[80:83], v[148:151]
    ds_read_b64_tr_b16 v[48:49], v7 offset:0
    v_mfma_f32_16x16x32_bf16 v[152:155], v[120:123], v[80:83], v[152:155]
    v_mfma_f32_16x16x32_bf16 v[156:159], v[124:127], v[80:83], v[156:159]
    ds_read_b64_tr_b16 v[50:51], v7 offset:1792
    v_mfma_f32_16x16x32_bf16 v[160:163], v[96:99], v[84:87], v[160:163]
    ds_read_b64_tr_b16 v[52:53], v7 offset:7168
    v_mfma_f32_16x16x32_bf16 v[164:167], v[100:103], v[84:87], v[164:167]
    v_mfma_f32_16x16x32_bf16 v[168:171], v[104:107], v[84:87], v[168:171]
    s_add_u32 m0, s41, 33792
    s_nop 0
    buffer_load_dwordx4 v15, s[16:19], s30 offen lds
    v_mfma_f32_16x16x32_bf16 v[172:175], v[108:111], v[84:87], v[172:175]
    ds_read_b64_tr_b16 v[54:55], v7 offset:8960
    v_mfma_f32_16x16x32_bf16 v[176:179], v[112:115], v[84:87], v[176:179]
    ds_read_b64_tr_b16 v[56:57], v7 offset:32
    v_mfma_f32_16x16x32_bf16 v[180:183], v[116:119], v[84:87], v[180:183]
    v_mfma_f32_16x16x32_bf16 v[184:187], v[120:123], v[84:87], v[184:187]
    ds_read_b64_tr_b16 v[58:59], v7 offset:1824
    v_mfma_f32_16x16x32_bf16 v[188:191], v[124:127], v[84:87], v[188:191]
    ds_read_b64_tr_b16 v[60:61], v7 offset:7200
    v_mfma_f32_16x16x32_bf16 v[192:195], v[96:99], v[88:91], v[192:195]
    v_mfma_f32_16x16x32_bf16 v[196:199], v[100:103], v[88:91], v[196:199]
    ds_read_b64_tr_b16 v[62:63], v7 offset:8992
    v_mfma_f32_16x16x32_bf16 v[200:203], v[104:107], v[88:91], v[200:203]
    ds_read_b64_tr_b16 v[64:65], v7 offset:64
    v_mfma_f32_16x16x32_bf16 v[204:207], v[108:111], v[88:91], v[204:207]
    ds_read_b64_tr_b16 v[66:67], v7 offset:1856
    v_mfma_f32_16x16x32_bf16 v[208:211], v[112:115], v[88:91], v[208:211]
    v_mfma_f32_16x16x32_bf16 v[212:215], v[116:119], v[88:91], v[212:215]
    s_add_u32 m0, s41, 34816
    s_nop 0
    buffer_load_dwordx4 v16, s[16:19], s30 offen lds
    s_add_u32 s30, s30, 458752
    v_mfma_f32_16x16x32_bf16 v[216:219], v[120:123], v[88:91], v[216:219]
    ds_read_b64_tr_b16 v[68:69], v7 offset:7232
    v_mfma_f32_16x16x32_bf16 v[220:223], v[124:127], v[88:91], v[220:223]
    v_mfma_f32_16x16x32_bf16 v[224:227], v[96:99], v[92:95], v[224:227]
    ds_read_b64_tr_b16 v[70:71], v7 offset:9024
    v_mfma_f32_16x16x32_bf16 v[228:231], v[100:103], v[92:95], v[228:231]
    ds_read_b64_tr_b16 v[72:73], v7 offset:96
    v_mfma_f32_16x16x32_bf16 v[232:235], v[104:107], v[92:95], v[232:235]
    ds_read_b64_tr_b16 v[74:75], v7 offset:1888
    v_mfma_f32_16x16x32_bf16 v[236:239], v[108:111], v[92:95], v[236:239]
    v_mfma_f32_16x16x32_bf16 v[240:243], v[112:115], v[92:95], v[240:243]
    ds_read_b64_tr_b16 v[76:77], v7 offset:7264
    v_mfma_f32_16x16x32_bf16 v[244:247], v[116:119], v[92:95], v[244:247]
    ds_read_b64_tr_b16 v[78:79], v7 offset:9056
    v_mfma_f32_16x16x32_bf16 v[248:251], v[120:123], v[92:95], v[248:251]
    v_mfma_f32_16x16x32_bf16 v[252:255], v[124:127], v[92:95], v[252:255]
    s_waitcnt vmcnt(63) lgkmcnt(0)
    s_barrier
    s_sub_u32 s29, s29, 1
    s_cmp_lg_u32 s29, 0
    s_cbranch_scc1 K1T00_LOOP
    v_add_u32 v6, s45, v29
    s_add_u32 s45, s45, 32768
    s_cmp_eq_u32 s45, 98304
    s_cselect_b32 s45, 0, s45
    s_nop 0
    s_add_u32 m0, s41, 0
    s_nop 0
    buffer_load_dwordx4 v10, s[16:19], s30 offen lds
    v_mfma_f32_16x16x32_bf16 v[128:131], v[48:51], v[32:35], v[128:131]
    ds_read_b128 v[80:83], v6 offset:0
    v_mfma_f32_16x16x32_bf16 v[132:135], v[52:55], v[32:35], v[132:135]
    ds_read_b128 v[84:87], v6 offset:2048
    v_mfma_f32_16x16x32_bf16 v[136:139], v[56:59], v[32:35], v[136:139]
    v_mfma_f32_16x16x32_bf16 v[140:143], v[60:63], v[32:35], v[140:143]
    ds_read_b128 v[88:91], v6 offset:4096
    v_mfma_f32_16x16x32_bf16 v[144:147], v[64:67], v[32:35], v[144:147]
    ds_read_b128 v[92:95], v6 offset:6144
    v_mfma_f32_16x16x32_bf16 v[148:151], v[68:71], v[32:35], v[148:151]
    ds_read_b64_tr_b16 v[96:97], v7 offset:14336
    v_mfma_f32_16x16x32_bf16 v[152:155], v[72:75], v[32:35], v[152:155]
    v_mfma_f32_16x16x32_bf16 v[156:159], v[76:79], v[32:35], v[156:159]
    s_add_u32 m0, s41, 1024
    s_nop 0
    buffer_load_dwordx4 v11, s[16:19], s30 offen lds
    v_mfma_f32_16x16x32_bf16 v[160:163], v[48:51], v[36:39], v[160:163]
    ds_read_b64_tr_b16 v[98:99], v7 offset:16128
    v_mfma_f32_16x16x32_bf16 v[164:167], v[52:55], v[36:39], v[164:167]
    ds_read_b64_tr_b16 v[100:101], v7 offset:21504
    v_mfma_f32_16x16x32_bf16 v[168:171], v[56:59], v[36:39], v[168:171]
    v_mfma_f32_16x16x32_bf16 v[172:175], v[60:63], v[36:39], v[172:175]
    ds_read_b64_tr_b16 v[102:103], v7 offset:23296
    v_mfma_f32_16x16x32_bf16 v[176:179], v[64:67], v[36:39], v[176:179]
    ds_read_b64_tr_b16 v[104:105], v7 offset:14368
    v_mfma_f32_16x16x32_bf16 v[180:183], v[68:71], v[36:39], v[180:183]
    ds_read_b64_tr_b16 v[106:107], v7 offset:16160
    v_mfma_f32_16x16x32_bf16 v[184:187], v[72:75], v[36:39], v[184:187]
    v_mfma_f32_16x16x32_bf16 v[188:191], v[76:79], v[36:39], v[188:191]
    s_add_u32 m0, s41, 2048
    s_nop 0
    buffer_load_dwordx4 v12, s[16:19], s30 offen lds
    v_mfma_f32_16x16x32_bf16 v[192:195], v[48:51], v[40:43], v[192:195]
    ds_read_b64_tr_b16 v[108:109], v7 offset:21536
    v_mfma_f32_16x16x32_bf16 v[196:199], v[52:55], v[40:43], v[196:199]
    ds_read_b64_tr_b16 v[110:111], v7 offset:23328
    v_mfma_f32_16x16x32_bf16 v[200:203], v[56:59], v[40:43], v[200:203]
    v_mfma_f32_16x16x32_bf16 v[204:207], v[60:63], v[40:43], v[204:207]
    ds_read_b64_tr_b16 v[112:113], v7 offset:14400
    v_mfma_f32_16x16x32_bf16 v[208:211], v[64:67], v[40:43], v[208:211]
    ds_read_b64_tr_b16 v[114:115], v7 offset:16192
    v_mfma_f32_16x16x32_bf16 v[212:215], v[68:71], v[40:43], v[212:215]
    ds_read_b64_tr_b16 v[116:117], v7 offset:21568
    v_mfma_f32_16x16x32_bf16 v[216:219], v[72:75], v[40:43], v[216:219]
    v_mfma_f32_16x16x32_bf16 v[220:223], v[76:79], v[40:43], v[220:223]
    s_add_u32 m0, s41, 3072
    s_nop 0
    buffer_load_dwordx4 v13, s[16:19], s30 offen lds
    v_mfma_f32_16x16x32_bf16 v[224:227], v[48:51], v[44:47], v[224:227]
    ds_read_b64_tr_b16 v[118:119], v7 offset:23360
    v_mfma_f32_16x16x32_bf16 v[228:231], v[52:55], v[44:47], v[228:231]
    ds_read_b64_tr_b16 v[120:121], v7 offset:14432
    v_mfma_f32_16x16x32_bf16 v[232:235], v[56:59], v[44:47], v[232:235]
    v_mfma_f32_16x16x32_bf16 v[236:239], v[60:63], v[44:47], v[236:239]
    ds_read_b64_tr_b16 v[122:123], v7 offset:16224
    v_mfma_f32_16x16x32_bf16 v[240:243], v[64:67], v[44:47], v[240:243]
    ds_read_b64_tr_b16 v[124:125], v7 offset:21600
    v_mfma_f32_16x16x32_bf16 v[244:247], v[68:71], v[44:47], v[244:247]
    ds_read_b64_tr_b16 v[126:127], v7 offset:23392
    v_mfma_f32_16x16x32_bf16 v[248:251], v[72:75], v[44:47], v[248:251]
    v_mfma_f32_16x16x32_bf16 v[252:255], v[76:79], v[44:47], v[252:255]
    s_waitcnt vmcnt(4) lgkmcnt(0)
    s_barrier
    v_add_u32 v5, s45, v28
    s_nop 0
    s_add_u32 m0, s41, 4096
    s_nop 0
    buffer_load_dwordx4 v14, s[16:19], s30 offen lds
    v_mfma_f32_16x16x32_bf16 v[128:131], v[96:99], v[80:83], v[128:131]
    ds_read_b128 v[32:35], v5 offset:0
    v_mfma_f32_16x16x32_bf16 v[132:135], v[100:103], v[80:83], v[132:135]
    ds_read_b128 v[36:39], v5 offset:2048
    v_mfma_f32_16x16x32_bf16 v[136:139], v[104:107], v[80:83], v[136:139]
    v_mfma_f32_16x16x32_bf16 v[140:143], v[108:111], v[80:83], v[140:143]
    ds_read_b128 v[40:43], v5 offset:4096
    v_mfma_f32_16x16x32_bf16 v[144:147], v[112:115], v[80:83], v[144:147]
    ds_read_b128 v[44:47], v5 offset:6144
    v_mfma_f32_16x16x32_bf16 v[148:151], v[116:119], v[80:83], v[148:151]
    ds_read_b64_tr_b16 v[48:49], v7 offset:28672
    v_mfma_f32_16x16x32_bf16 v[152:155], v[120:123], v[80:83], v[152:155]
    v_mfma_f32_16x16x32_bf16 v[156:159], v[124:127], v[80:83], v[156:159]
    ds_read_b64_tr_b16 v[50:51], v7 offset:30464
    v_mfma_f32_16x16x32_bf16 v[160:163], v[96:99], v[84:87], v[160:163]
    ds_read_b64_tr_b16 v[52:53], v7 offset:35840
    v_mfma_f32_16x16x32_bf16 v[164:167], v[100:103], v[84:87], v[164:167]
    v_mfma_f32_16x16x32_bf16 v[168:171], v[104:107], v[84:87], v[168:171]
    s_add_u32 m0, s41, 5120
    s_nop 0
    buffer_load_dwordx4 v15, s[16:19], s30 offen lds
    v_mfma_f32_16x16x32_bf16 v[172:175], v[108:111], v[84:87], v[172:175]
    ds_read_b64_tr_b16 v[54:55], v7 offset:37632
    v_mfma_f32_16x16x32_bf16 v[176:179], v[112:115], v[84:87], v[176:179]
    ds_read_b64_tr_b16 v[56:57], v7 offset:28704
    v_mfma_f32_16x16x32_bf16 v[180:183], v[116:119], v[84:87], v[180:183]
    v_mfma_f32_16x16x32_bf16 v[184:187], v[120:123], v[84:87], v[184:187]
    ds_read_b64_tr_b16 v[58:59], v7 offset:30496
    v_mfma_f32_16x16x32_bf16 v[188:191], v[124:127], v[84:87], v[188:191]
    ds_read_b64_tr_b16 v[60:61], v7 offset:35872
    v_mfma_f32_16x16x32_bf16 v[192:195], v[96:99], v[88:91], v[192:195]
    v_mfma_f32_16x16x32_bf16 v[196:199], v[100:103], v[88:91], v[196:199]
    ds_read_b64_tr_b16 v[62:63], v7 offset:37664
    v_mfma_f32_16x16x32_bf16 v[200:203], v[104:107], v[88:91], v[200:203]
    ds_read_b64_tr_b16 v[64:65], v7 offset:28736
    v_mfma_f32_16x16x32_bf16 v[204:207], v[108:111], v[88:91], v[204:207]
    ds_read_b64_tr_b16 v[66:67], v7 offset:30528
    v_mfma_f32_16x16x32_bf16 v[208:211], v[112:115], v[88:91], v[208:211]
    v_mfma_f32_16x16x32_bf16 v[212:215], v[116:119], v[88:91], v[212:215]
    s_add_u32 m0, s41, 6144
    s_nop 0
    buffer_load_dwordx4 v16, s[16:19], s30 offen lds
    s_add_u32 s30, s30, 458752
    v_mfma_f32_16x16x32_bf16 v[216:219], v[120:123], v[88:91], v[216:219]
    ds_read_b64_tr_b16 v[68:69], v7 offset:35904
    v_mfma_f32_16x16x32_bf16 v[220:223], v[124:127], v[88:91], v[220:223]
    v_mfma_f32_16x16x32_bf16 v[224:227], v[96:99], v[92:95], v[224:227]
    ds_read_b64_tr_b16 v[70:71], v7 offset:37696
    v_mfma_f32_16x16x32_bf16 v[228:231], v[100:103], v[92:95], v[228:231]
    ds_read_b64_tr_b16 v[72:73], v7 offset:28768
    v_mfma_f32_16x16x32_bf16 v[232:235], v[104:107], v[92:95], v[232:235]
    ds_read_b64_tr_b16 v[74:75], v7 offset:30560
    v_mfma_f32_16x16x32_bf16 v[236:239], v[108:111], v[92:95], v[236:239]
    v_mfma_f32_16x16x32_bf16 v[240:243], v[112:115], v[92:95], v[240:243]
    ds_read_b64_tr_b16 v[76:77], v7 offset:35936
    v_mfma_f32_16x16x32_bf16 v[244:247], v[116:119], v[92:95], v[244:247]
    ds_read_b64_tr_b16 v[78:79], v7 offset:37728
    v_mfma_f32_16x16x32_bf16 v[248:251], v[120:123], v[92:95], v[248:251]
    v_mfma_f32_16x16x32_bf16 v[252:255], v[124:127], v[92:95], v[252:255]
    s_waitcnt vmcnt(63) lgkmcnt(0)
    s_barrier
    v_add_u32 v6, s45, v29
    s_add_u32 s45, s45, 32768
    s_cmp_eq_u32 s45, 98304
    s_cselect_b32 s45, 0, s45
    s_nop 0
    s_add_u32 m0, s41, 28672
    s_nop 0
    buffer_load_dwordx4 v10, s[16:19], s30 offen lds
    v_mfma_f32_16x16x32_bf16 v[128:131], v[48:51], v[32:35], v[128:131]
    ds_read_b128 v[80:83], v6 offset:0
    v_mfma_f32_16x16x32_bf16 v[132:135], v[52:55], v[32:35], v[132:135]
    ds_read_b128 v[84:87], v6 offset:2048
    v_mfma_f32_16x16x32_bf16 v[136:139], v[56:59], v[32:35], v[136:139]
    v_mfma_f32_16x16x32_bf16 v[140:143], v[60:63], v[32:35], v[140:143]
    ds_read_b128 v[88:91], v6 offset:4096
    v_mfma_f32_16x16x32_bf16 v[144:147], v[64:67], v[32:35], v[144:147]
    ds_read_b128 v[92:95], v6 offset:6144
    v_mfma_f32_16x16x32_bf16 v[148:151], v[68:71], v[32:35], v[148:151]
    ds_read_b64_tr_b16 v[96:97], v7 offset:43008
    v_mfma_f32_16x16x32_bf16 v[152:155], v[72:75], v[32:35], v[152:155]
    v_mfma_f32_16x16x32_bf16 v[156:159], v[76:79], v[32:35], v[156:159]
    s_add_u32 m0, s41, 29696
    s_nop 0
    buffer_load_dwordx4 v11, s[16:19], s30 offen lds
    v_mfma_f32_16x16x32_bf16 v[160:163], v[48:51], v[36:39], v[160:163]
    ds_read_b64_tr_b16 v[98:99], v7 offset:44800
    v_mfma_f32_16x16x32_bf16 v[164:167], v[52:55], v[36:39], v[164:167]
    ds_read_b64_tr_b16 v[100:101], v7 offset:50176
    v_mfma_f32_16x16x32_bf16 v[168:171], v[56:59], v[36:39], v[168:171]
    v_mfma_f32_16x16x32_bf16 v[172:175], v[60:63], v[36:39], v[172:175]
    ds_read_b64_tr_b16 v[102:103], v7 offset:51968
    v_mfma_f32_16x16x32_bf16 v[176:179], v[64:67], v[36:39], v[176:179]
    ds_read_b64_tr_b16 v[104:105], v7 offset:43040
    v_mfma_f32_16x16x32_bf16 v[180:183], v[68:71], v[36:39], v[180:183]
    ds_read_b64_tr_b16 v[106:107], v7 offset:44832
    v_mfma_f32_16x16x32_bf16 v[184:187], v[72:75], v[36:39], v[184:187]
    v_mfma_f32_16x16x32_bf16 v[188:191], v[76:79], v[36:39], v[188:191]
    s_add_u32 m0, s41, 30720
    s_nop 0
    buffer_load_dwordx4 v12, s[16:19], s30 offen lds
    v_mfma_f32_16x16x32_bf16 v[192:195], v[48:51], v[40:43], v[192:195]
    ds_read_b64_tr_b16 v[108:109], v7 offset:50208
    v_mfma_f32_16x16x32_bf16 v[196:199], v[52:55], v[40:43], v[196:199]
    ds_read_b64_tr_b16 v[110:111], v7 offset:52000
    v_mfma_f32_16x16x32_bf16 v[200:203], v[56:59], v[40:43], v[200:203]
    v_mfma_f32_16x16x32_bf16 v[204:207], v[60:63], v[40:43], v[204:207]
    ds_read_b64_tr_b16 v[112:113], v7 offset:43072
    v_mfma_f32_16x16x32_bf16 v[208:211], v[64:67], v[40:43], v[208:211]
    ds_read_b64_tr_b16 v[114:115], v7 offset:44864
    v_mfma_f32_16x16x32_bf16 v[212:215], v[68:71], v[40:43], v[212:215]
    ds_read_b64_tr_b16 v[116:117], v7 offset:50240
    v_mfma_f32_16x16x32_bf16 v[216:219], v[72:75], v[40:43], v[216:219]
    v_mfma_f32_16x16x32_bf16 v[220:223], v[76:79], v[40:43], v[220:223]
    s_add_u32 m0, s41, 31744
    s_nop 0
    buffer_load_dwordx4 v13, s[16:19], s30 offen lds
    v_mfma_f32_16x16x32_bf16 v[224:227], v[48:51], v[44:47], v[224:227]
    ds_read_b64_tr_b16 v[118:119], v7 offset:52032
    v_mfma_f32_16x16x32_bf16 v[228:231], v[52:55], v[44:47], v[228:231]
    ds_read_b64_tr_b16 v[120:121], v7 offset:43104
    v_mfma_f32_16x16x32_bf16 v[232:235], v[56:59], v[44:47], v[232:235]
    v_mfma_f32_16x16x32_bf16 v[236:239], v[60:63], v[44:47], v[236:239]
    ds_read_b64_tr_b16 v[122:123], v7 offset:44896
    v_mfma_f32_16x16x32_bf16 v[240:243], v[64:67], v[44:47], v[240:243]
    ds_read_b64_tr_b16 v[124:125], v7 offset:50272
    v_mfma_f32_16x16x32_bf16 v[244:247], v[68:71], v[44:47], v[244:247]
    ds_read_b64_tr_b16 v[126:127], v7 offset:52064
    v_mfma_f32_16x16x32_bf16 v[248:251], v[72:75], v[44:47], v[248:251]
    v_mfma_f32_16x16x32_bf16 v[252:255], v[76:79], v[44:47], v[252:255]
    s_waitcnt vmcnt(4) lgkmcnt(0)
    s_barrier
    v_add_u32 v5, s45, v28
    s_nop 0
    s_add_u32 m0, s41, 32768
    s_nop 0
    buffer_load_dwordx4 v14, s[16:19], s30 offen lds
    v_mfma_f32_16x16x32_bf16 v[128:131], v[96:99], v[80:83], v[128:131]
    ds_read_b128 v[32:35], v5 offset:0
    v_mfma_f32_16x16x32_bf16 v[132:135], v[100:103], v[80:83], v[132:135]
    ds_read_b128 v[36:39], v5 offset:2048
    v_mfma_f32_16x16x32_bf16 v[136:139], v[104:107], v[80:83], v[136:139]
    v_mfma_f32_16x16x32_bf16 v[140:143], v[108:111], v[80:83], v[140:143]
    ds_read_b128 v[40:43], v5 offset:4096
    v_mfma_f32_16x16x32_bf16 v[144:147], v[112:115], v[80:83], v[144:147]
    ds_read_b128 v[44:47], v5 offset:6144
    v_mfma_f32_16x16x32_bf16 v[148:151], v[116:119], v[80:83], v[148:151]
    ds_read_b64_tr_b16 v[48:49], v7 offset:0
    v_mfma_f32_16x16x32_bf16 v[152:155], v[120:123], v[80:83], v[152:155]
    v_mfma_f32_16x16x32_bf16 v[156:159], v[124:127], v[80:83], v[156:159]
    ds_read_b64_tr_b16 v[50:51], v7 offset:1792
    v_mfma_f32_16x16x32_bf16 v[160:163], v[96:99], v[84:87], v[160:163]
    ds_read_b64_tr_b16 v[52:53], v7 offset:7168
    v_mfma_f32_16x16x32_bf16 v[164:167], v[100:103], v[84:87], v[164:167]
    v_mfma_f32_16x16x32_bf16 v[168:171], v[104:107], v[84:87], v[168:171]
    s_add_u32 m0, s41, 33792
    s_nop 0
    buffer_load_dwordx4 v15, s[16:19], s30 offen lds
    v_mfma_f32_16x16x32_bf16 v[172:175], v[108:111], v[84:87], v[172:175]
    ds_read_b64_tr_b16 v[54:55], v7 offset:8960
    v_mfma_f32_16x16x32_bf16 v[176:179], v[112:115], v[84:87], v[176:179]
    ds_read_b64_tr_b16 v[56:57], v7 offset:32
    v_mfma_f32_16x16x32_bf16 v[180:183], v[116:119], v[84:87], v[180:183]
    v_mfma_f32_16x16x32_bf16 v[184:187], v[120:123], v[84:87], v[184:187]
    ds_read_b64_tr_b16 v[58:59], v7 offset:1824
    v_mfma_f32_16x16x32_bf16 v[188:191], v[124:127], v[84:87], v[188:191]
    ds_read_b64_tr_b16 v[60:61], v7 offset:7200
    v_mfma_f32_16x16x32_bf16 v[192:195], v[96:99], v[88:91], v[192:195]
    v_mfma_f32_16x16x32_bf16 v[196:199], v[100:103], v[88:91], v[196:199]
    ds_read_b64_tr_b16 v[62:63], v7 offset:8992
    v_mfma_f32_16x16x32_bf16 v[200:203], v[104:107], v[88:91], v[200:203]
    ds_read_b64_tr_b16 v[64:65], v7 offset:64
    v_mfma_f32_16x16x32_bf16 v[204:207], v[108:111], v[88:91], v[204:207]
    ds_read_b64_tr_b16 v[66:67], v7 offset:1856
    v_mfma_f32_16x16x32_bf16 v[208:211], v[112:115], v[88:91], v[208:211]
    v_mfma_f32_16x16x32_bf16 v[212:215], v[116:119], v[88:91], v[212:215]
    s_add_u32 m0, s41, 34816
    s_nop 0
    buffer_load_dwordx4 v16, s[16:19], s30 offen lds
    s_add_u32 s30, s30, 458752
    v_mfma_f32_16x16x32_bf16 v[216:219], v[120:123], v[88:91], v[216:219]
    ds_read_b64_tr_b16 v[68:69], v7 offset:7232
    v_mfma_f32_16x16x32_bf16 v[220:223], v[124:127], v[88:91], v[220:223]
    v_mfma_f32_16x16x32_bf16 v[224:227], v[96:99], v[92:95], v[224:227]
    ds_read_b64_tr_b16 v[70:71], v7 offset:9024
    v_mfma_f32_16x16x32_bf16 v[228:231], v[100:103], v[92:95], v[228:231]
    ds_read_b64_tr_b16 v[72:73], v7 offset:96
    v_mfma_f32_16x16x32_bf16 v[232:235], v[104:107], v[92:95], v[232:235]
    ds_read_b64_tr_b16 v[74:75], v7 offset:1888
    v_mfma_f32_16x16x32_bf16 v[236:239], v[108:111], v[92:95], v[236:239]
    v_mfma_f32_16x16x32_bf16 v[240:243], v[112:115], v[92:95], v[240:243]
    ds_read_b64_tr_b16 v[76:77], v7 offset:7264
    v_mfma_f32_16x16x32_bf16 v[244:247], v[116:119], v[92:95], v[244:247]
    ds_read_b64_tr_b16 v[78:79], v7 offset:9056
    v_mfma_f32_16x16x32_bf16 v[248:251], v[120:123], v[92:95], v[248:251]
    v_mfma_f32_16x16x32_bf16 v[252:255], v[124:127], v[92:95], v[252:255]
    s_waitcnt vmcnt(63) lgkmcnt(0)
    s_barrier
    v_add_u32 v6, s45, v29
    s_add_u32 s45, s45, 32768
    s_cmp_eq_u32 s45, 98304
    s_cselect_b32 s45, 0, s45
    s_nop 0
    ds_read_b128 v[80:83], v6 offset:0
    v_mfma_f32_16x16x32_bf16 v[128:131], v[48:51], v[32:35], v[128:131]
    ds_read_b128 v[84:87], v6 offset:2048
    v_mfma_f32_16x16x32_bf16 v[132:135], v[52:55], v[32:35], v[132:135]
    v_mfma_f32_16x16x32_bf16 v[136:139], v[56:59], v[32:35], v[136:139]
    ds_read_b128 v[88:91], v6 offset:4096
    v_mfma_f32_16x16x32_bf16 v[140:143], v[60:63], v[32:35], v[140:143]
    ds_read_b128 v[92:95], v6 offset:6144
    v_mfma_f32_16x16x32_bf16 v[144:147], v[64:67], v[32:35], v[144:147]
    v_mfma_f32_16x16x32_bf16 v[148:151], v[68:71], v[32:35], v[148:151]
    ds_read_b64_tr_b16 v[96:97], v7 offset:14336
    v_mfma_f32_16x16x32_bf16 v[152:155], v[72:75], v[32:35], v[152:155]
    v_mfma_f32_16x16x32_bf16 v[156:159], v[76:79], v[32:35], v[156:159]
    ds_read_b64_tr_b16 v[98:99], v7 offset:16128
    v_mfma_f32_16x16x32_bf16 v[160:163], v[48:51], v[36:39], v[160:163]
    ds_read_b64_tr_b16 v[100:101], v7 offset:21504
    v_mfma_f32_16x16x32_bf16 v[164:167], v[52:55], v[36:39], v[164:167]
    v_mfma_f32_16x16x32_bf16 v[168:171], v[56:59], v[36:39], v[168:171]
    ds_read_b64_tr_b16 v[102:103], v7 offset:23296
    v_mfma_f32_16x16x32_bf16 v[172:175], v[60:63], v[36:39], v[172:175]
    ds_read_b64_tr_b16 v[104:105], v7 offset:14368
    v_mfma_f32_16x16x32_bf16 v[176:179], v[64:67], v[36:39], v[176:179]
    v_mfma_f32_16x16x32_bf16 v[180:183], v[68:71], v[36:39], v[180:183]
    ds_read_b64_tr_b16 v[106:107], v7 offset:16160
    v_mfma_f32_16x16x32_bf16 v[184:187], v[72:75], v[36:39], v[184:187]
    v_mfma_f32_16x16x32_bf16 v[188:191], v[76:79], v[36:39], v[188:191]
    ds_read_b64_tr_b16 v[108:109], v7 offset:21536
    v_mfma_f32_16x16x32_bf16 v[192:195], v[48:51], v[40:43], v[192:195]
    ds_read_b64_tr_b16 v[110:111], v7 offset:23328
    v_mfma_f32_16x16x32_bf16 v[196:199], v[52:55], v[40:43], v[196:199]
    v_mfma_f32_16x16x32_bf16 v[200:203], v[56:59], v[40:43], v[200:203]
    ds_read_b64_tr_b16 v[112:113], v7 offset:14400
    v_mfma_f32_16x16x32_bf16 v[204:207], v[60:63], v[40:43], v[204:207]
    ds_read_b64_tr_b16 v[114:115], v7 offset:16192
    v_mfma_f32_16x16x32_bf16 v[208:211], v[64:67], v[40:43], v[208:211]
    v_mfma_f32_16x16x32_bf16 v[212:215], v[68:71], v[40:43], v[212:215]
    ds_read_b64_tr_b16 v[116:117], v7 offset:21568
    v_mfma_f32_16x16x32_bf16 v[216:219], v[72:75], v[40:43], v[216:219]
    v_mfma_f32_16x16x32_bf16 v[220:223], v[76:79], v[40:43], v[220:223]
    ds_read_b64_tr_b16 v[118:119], v7 offset:23360
    v_mfma_f32_16x16x32_bf16 v[224:227], v[48:51], v[44:47], v[224:227]
    ds_read_b64_tr_b16 v[120:121], v7 offset:14432
    v_mfma_f32_16x16x32_bf16 v[228:231], v[52:55], v[44:47], v[228:231]
    v_mfma_f32_16x16x32_bf16 v[232:235], v[56:59], v[44:47], v[232:235]
    ds_read_b64_tr_b16 v[122:123], v7 offset:16224
    v_mfma_f32_16x16x32_bf16 v[236:239], v[60:63], v[44:47], v[236:239]
    ds_read_b64_tr_b16 v[124:125], v7 offset:21600
    v_mfma_f32_16x16x32_bf16 v[240:243], v[64:67], v[44:47], v[240:243]
    v_mfma_f32_16x16x32_bf16 v[244:247], v[68:71], v[44:47], v[244:247]
    ds_read_b64_tr_b16 v[126:127], v7 offset:23392
    v_mfma_f32_16x16x32_bf16 v[248:251], v[72:75], v[44:47], v[248:251]
    v_mfma_f32_16x16x32_bf16 v[252:255], v[76:79], v[44:47], v[252:255]
    s_waitcnt vmcnt(0) lgkmcnt(0)
    s_barrier
    v_add_u32 v5, s45, v28
    s_nop 0
    ds_read_b128 v[32:35], v5 offset:0
    v_mfma_f32_16x16x32_bf16 v[128:131], v[96:99], v[80:83], v[128:131]
    ds_read_b128 v[36:39], v5 offset:2048
    v_mfma_f32_16x16x32_bf16 v[132:135], v[100:103], v[80:83], v[132:135]
    v_mfma_f32_16x16x32_bf16 v[136:139], v[104:107], v[80:83], v[136:139]
    ds_read_b128 v[40:43], v5 offset:4096
    v_mfma_f32_16x16x32_bf16 v[140:143], v[108:111], v[80:83], v[140:143]
    ds_read_b128 v[44:47], v5 offset:6144
    v_mfma_f32_16x16x32_bf16 v[144:147], v[112:115], v[80:83], v[144:147]
    v_mfma_f32_16x16x32_bf16 v[148:151], v[116:119], v[80:83], v[148:151]
    ds_read_b64_tr_b16 v[48:49], v7 offset:28672
    v_mfma_f32_16x16x32_bf16 v[152:155], v[120:123], v[80:83], v[152:155]
    v_mfma_f32_16x16x32_bf16 v[156:159], v[124:127], v[80:83], v[156:159]
    ds_read_b64_tr_b16 v[50:51], v7 offset:30464
    v_mfma_f32_16x16x32_bf16 v[160:163], v[96:99], v[84:87], v[160:163]
    ds_read_b64_tr_b16 v[52:53], v7 offset:35840
    v_mfma_f32_16x16x32_bf16 v[164:167], v[100:103], v[84:87], v[164:167]
    v_mfma_f32_16x16x32_bf16 v[168:171], v[104:107], v[84:87], v[168:171]
    ds_read_b64_tr_b16 v[54:55], v7 offset:37632
    v_mfma_f32_16x16x32_bf16 v[172:175], v[108:111], v[84:87], v[172:175]
    ds_read_b64_tr_b16 v[56:57], v7 offset:28704
    v_mfma_f32_16x16x32_bf16 v[176:179], v[112:115], v[84:87], v[176:179]
    v_mfma_f32_16x16x32_bf16 v[180:183], v[116:119], v[84:87], v[180:183]
    ds_read_b64_tr_b16 v[58:59], v7 offset:30496
    v_mfma_f32_16x16x32_bf16 v[184:187], v[120:123], v[84:87], v[184:187]
    v_mfma_f32_16x16x32_bf16 v[188:191], v[124:127], v[84:87], v[188:191]
    ds_read_b64_tr_b16 v[60:61], v7 offset:35872
    v_mfma_f32_16x16x32_bf16 v[192:195], v[96:99], v[88:91], v[192:195]
    ds_read_b64_tr_b16 v[62:63], v7 offset:37664
    v_mfma_f32_16x16x32_bf16 v[196:199], v[100:103], v[88:91], v[196:199]
    v_mfma_f32_16x16x32_bf16 v[200:203], v[104:107], v[88:91], v[200:203]
    ds_read_b64_tr_b16 v[64:65], v7 offset:28736
    v_mfma_f32_16x16x32_bf16 v[204:207], v[108:111], v[88:91], v[204:207]
    ds_read_b64_tr_b16 v[66:67], v7 offset:30528
    v_mfma_f32_16x16x32_bf16 v[208:211], v[112:115], v[88:91], v[208:211]
    v_mfma_f32_16x16x32_bf16 v[212:215], v[116:119], v[88:91], v[212:215]
    ds_read_b64_tr_b16 v[68:69], v7 offset:35904
    v_mfma_f32_16x16x32_bf16 v[216:219], v[120:123], v[88:91], v[216:219]
    v_mfma_f32_16x16x32_bf16 v[220:223], v[124:127], v[88:91], v[220:223]
    ds_read_b64_tr_b16 v[70:71], v7 offset:37696
    v_mfma_f32_16x16x32_bf16 v[224:227], v[96:99], v[92:95], v[224:227]
    ds_read_b64_tr_b16 v[72:73], v7 offset:28768
    v_mfma_f32_16x16x32_bf16 v[228:231], v[100:103], v[92:95], v[228:231]
    v_mfma_f32_16x16x32_bf16 v[232:235], v[104:107], v[92:95], v[232:235]
    ds_read_b64_tr_b16 v[74:75], v7 offset:30560
    v_mfma_f32_16x16x32_bf16 v[236:239], v[108:111], v[92:95], v[236:239]
    ds_read_b64_tr_b16 v[76:77], v7 offset:35936
    v_mfma_f32_16x16x32_bf16 v[240:243], v[112:115], v[92:95], v[240:243]
    v_mfma_f32_16x16x32_bf16 v[244:247], v[116:119], v[92:95], v[244:247]
    ds_read_b64_tr_b16 v[78:79], v7 offset:37728
    v_mfma_f32_16x16x32_bf16 v[248:251], v[120:123], v[92:95], v[248:251]
    v_mfma_f32_16x16x32_bf16 v[252:255], v[124:127], v[92:95], v[252:255]
    s_waitcnt vmcnt(63) lgkmcnt(0)
    s_barrier
    v_add_u32 v6, s45, v29
    s_add_u32 s45, s45, 32768
    s_cmp_eq_u32 s45, 98304
    s_cselect_b32 s45, 0, s45
    s_nop 0
    ds_read_b128 v[80:83], v6 offset:0
    v_mfma_f32_16x16x32_bf16 v[128:131], v[48:51], v[32:35], v[128:131]
    ds_read_b128 v[84:87], v6 offset:2048
    v_mfma_f32_16x16x32_bf16 v[132:135], v[52:55], v[32:35], v[132:135]
    v_mfma_f32_16x16x32_bf16 v[136:139], v[56:59], v[32:35], v[136:139]
    ds_read_b128 v[88:91], v6 offset:4096
    v_mfma_f32_16x16x32_bf16 v[140:143], v[60:63], v[32:35], v[140:143]
    ds_read_b128 v[92:95], v6 offset:6144
    v_mfma_f32_16x16x32_bf16 v[144:147], v[64:67], v[32:35], v[144:147]
    v_mfma_f32_16x16x32_bf16 v[148:151], v[68:71], v[32:35], v[148:151]
    ds_read_b64_tr_b16 v[96:97], v7 offset:43008
    v_mfma_f32_16x16x32_bf16 v[152:155], v[72:75], v[32:35], v[152:155]
    v_mfma_f32_16x16x32_bf16 v[156:159], v[76:79], v[32:35], v[156:159]
    ds_read_b64_tr_b16 v[98:99], v7 offset:44800
    v_mfma_f32_16x16x32_bf16 v[160:163], v[48:51], v[36:39], v[160:163]
    ds_read_b64_tr_b16 v[100:101], v7 offset:50176
    v_mfma_f32_16x16x32_bf16 v[164:167], v[52:55], v[36:39], v[164:167]
    v_mfma_f32_16x16x32_bf16 v[168:171], v[56:59], v[36:39], v[168:171]
    ds_read_b64_tr_b16 v[102:103], v7 offset:51968
    v_mfma_f32_16x16x32_bf16 v[172:175], v[60:63], v[36:39], v[172:175]
    ds_read_b64_tr_b16 v[104:105], v7 offset:43040
    v_mfma_f32_16x16x32_bf16 v[176:179], v[64:67], v[36:39], v[176:179]
    v_mfma_f32_16x16x32_bf16 v[180:183], v[68:71], v[36:39], v[180:183]
    ds_read_b64_tr_b16 v[106:107], v7 offset:44832
    v_mfma_f32_16x16x32_bf16 v[184:187], v[72:75], v[36:39], v[184:187]
    v_mfma_f32_16x16x32_bf16 v[188:191], v[76:79], v[36:39], v[188:191]
    ds_read_b64_tr_b16 v[108:109], v7 offset:50208
    v_mfma_f32_16x16x32_bf16 v[192:195], v[48:51], v[40:43], v[192:195]
    ds_read_b64_tr_b16 v[110:111], v7 offset:52000
    v_mfma_f32_16x16x32_bf16 v[196:199], v[52:55], v[40:43], v[196:199]
    v_mfma_f32_16x16x32_bf16 v[200:203], v[56:59], v[40:43], v[200:203]
    ds_read_b64_tr_b16 v[112:113], v7 offset:43072
    v_mfma_f32_16x16x32_bf16 v[204:207], v[60:63], v[40:43], v[204:207]
    ds_read_b64_tr_b16 v[114:115], v7 offset:44864
    v_mfma_f32_16x16x32_bf16 v[208:211], v[64:67], v[40:43], v[208:211]
    v_mfma_f32_16x16x32_bf16 v[212:215], v[68:71], v[40:43], v[212:215]
    ds_read_b64_tr_b16 v[116:117], v7 offset:50240
    v_mfma_f32_16x16x32_bf16 v[216:219], v[72:75], v[40:43], v[216:219]
    v_mfma_f32_16x16x32_bf16 v[220:223], v[76:79], v[40:43], v[220:223]
    ds_read_b64_tr_b16 v[118:119], v7 offset:52032
    v_mfma_f32_16x16x32_bf16 v[224:227], v[48:51], v[44:47], v[224:227]
    ds_read_b64_tr_b16 v[120:121], v7 offset:43104
    v_mfma_f32_16x16x32_bf16 v[228:231], v[52:55], v[44:47], v[228:231]
    v_mfma_f32_16x16x32_bf16 v[232:235], v[56:59], v[44:47], v[232:235]
    ds_read_b64_tr_b16 v[122:123], v7 offset:44896
    v_mfma_f32_16x16x32_bf16 v[236:239], v[60:63], v[44:47], v[236:239]
    ds_read_b64_tr_b16 v[124:125], v7 offset:50272
    v_mfma_f32_16x16x32_bf16 v[240:243], v[64:67], v[44:47], v[240:243]
    v_mfma_f32_16x16x32_bf16 v[244:247], v[68:71], v[44:47], v[244:247]
    ds_read_b64_tr_b16 v[126:127], v7 offset:52064
    v_mfma_f32_16x16x32_bf16 v[248:251], v[72:75], v[44:47], v[248:251]
    v_mfma_f32_16x16x32_bf16 v[252:255], v[76:79], v[44:47], v[252:255]
    s_waitcnt vmcnt(63) lgkmcnt(0)
    v_mfma_f32_16x16x32_bf16 v[128:131], v[96:99], v[80:83], v[128:131]
    v_mfma_f32_16x16x32_bf16 v[132:135], v[100:103], v[80:83], v[132:135]
    v_mfma_f32_16x16x32_bf16 v[136:139], v[104:107], v[80:83], v[136:139]
    v_mfma_f32_16x16x32_bf16 v[140:143], v[108:111], v[80:83], v[140:143]
    v_mfma_f32_16x16x32_bf16 v[144:147], v[112:115], v[80:83], v[144:147]
    v_mfma_f32_16x16x32_bf16 v[148:151], v[116:119], v[80:83], v[148:151]
    v_mfma_f32_16x16x32_bf16 v[152:155], v[120:123], v[80:83], v[152:155]
    v_mfma_f32_16x16x32_bf16 v[156:159], v[124:127], v[80:83], v[156:159]
    v_mfma_f32_16x16x32_bf16 v[160:163], v[96:99], v[84:87], v[160:163]
    v_mfma_f32_16x16x32_bf16 v[164:167], v[100:103], v[84:87], v[164:167]
    v_mfma_f32_16x16x32_bf16 v[168:171], v[104:107], v[84:87], v[168:171]
    v_mfma_f32_16x16x32_bf16 v[172:175], v[108:111], v[84:87], v[172:175]
    v_mfma_f32_16x16x32_bf16 v[176:179], v[112:115], v[84:87], v[176:179]
    v_mfma_f32_16x16x32_bf16 v[180:183], v[116:119], v[84:87], v[180:183]
    v_mfma_f32_16x16x32_bf16 v[184:187], v[120:123], v[84:87], v[184:187]
    v_mfma_f32_16x16x32_bf16 v[188:191], v[124:127], v[84:87], v[188:191]
    v_mfma_f32_16x16x32_bf16 v[192:195], v[96:99], v[88:91], v[192:195]
    v_mfma_f32_16x16x32_bf16 v[196:199], v[100:103], v[88:91], v[196:199]
    v_mfma_f32_16x16x32_bf16 v[200:203], v[104:107], v[88:91], v[200:203]
    v_mfma_f32_16x16x32_bf16 v[204:207], v[108:111], v[88:91], v[204:207]
    v_mfma_f32_16x16x32_bf16 v[208:211], v[112:115], v[88:91], v[208:211]
    v_mfma_f32_16x16x32_bf16 v[212:215], v[116:119], v[88:91], v[212:215]
    v_mfma_f32_16x16x32_bf16 v[216:219], v[120:123], v[88:91], v[216:219]
    v_mfma_f32_16x16x32_bf16 v[220:223], v[124:127], v[88:91], v[220:223]
    v_mfma_f32_16x16x32_bf16 v[224:227], v[96:99], v[92:95], v[224:227]
    v_mfma_f32_16x16x32_bf16 v[228:231], v[100:103], v[92:95], v[228:231]
    v_mfma_f32_16x16x32_bf16 v[232:235], v[104:107], v[92:95], v[232:235]
    v_mfma_f32_16x16x32_bf16 v[236:239], v[108:111], v[92:95], v[236:239]
    v_mfma_f32_16x16x32_bf16 v[240:243], v[112:115], v[92:95], v[240:243]
    v_mfma_f32_16x16x32_bf16 v[244:247], v[116:119], v[92:95], v[244:247]
    v_mfma_f32_16x16x32_bf16 v[248:251], v[120:123], v[92:95], v[248:251]
    v_mfma_f32_16x16x32_bf16 v[252:255], v[124:127], v[92:95], v[252:255]
    s_nop 7
    s_nop 7

    s_and_b32 s57, s57, 0xffff
    s_mov_b32 s58, 7340032
    s_mov_b32 s59, 0x20000
    s_mul_i32 s32, s2, 28672
    s_lshl_b32 s40, s24, 12
    s_add_u32 s32, s32, s40
    v_lshlrev_b32 v27, 4, v2

    s_cmp_eq_u32 s24, 7
    s_cbranch_scc1 K1T00_NOPF
    buffer_load_dwordx4 v[96:99], v27, s[56:59], s32 offen offset:0
    buffer_load_dwordx4 v[100:103], v27, s[56:59], s32 offen offset:1024
    buffer_load_dwordx4 v[104:107], v27, s[56:59], s32 offen offset:2048
    buffer_load_dwordx4 v[108:111], v27, s[56:59], s32 offen offset:3072
K1T00_NOPF:
K1_EPI0:
    s_mov_b32 s42, 0xc0135761
    s_mov_b32 s43, 0xbdd2d3e8
    v_mov_b32 v25, s42
    s_mov_b32 s44, 0xffff0000
    s_mov_b32 s48, 0
    s_mov_b32 s49, 114688
    s_mov_b32 s50, 229376
    s_mov_b32 s51, 344064
    v_cvt_pk_bf16_f32 v32, v128, v129
    v_cvt_pk_bf16_f32 v33, v130, v131
    v_lshlrev_b32 v128, 16, v32
    v_and_b32 v129, s44, v32
    v_lshlrev_b32 v130, 16, v33
    v_and_b32 v131, s44, v33
    v_cvt_pk_bf16_f32 v32, v132, v133
    v_cvt_pk_bf16_f32 v33, v134, v135
    v_lshlrev_b32 v132, 16, v32
    v_and_b32 v133, s44, v32
    v_lshlrev_b32 v134, 16, v33
    v_and_b32 v135, s44, v33
    v_mul_f32 v32, v128, v128
    v_mul_f32 v33, v129, v129
    v_mul_f32 v34, v130, v130
    v_mul_f32 v35, v131, v131
    v_fma_f32 v32, v32, s43, v25
    v_fma_f32 v33, v33, s43, v25
    v_fma_f32 v34, v34, s43, v25
    v_fma_f32 v35, v35, s43, v25
    v_mul_f32 v32, v32, v128
    v_mul_f32 v33, v33, v129
    v_mul_f32 v34, v34, v130
    v_mul_f32 v35, v35, v131
    v_exp_f32 v32, v32
    v_exp_f32 v33, v33
    v_exp_f32 v34, v34
    v_exp_f32 v35, v35
    v_add_f32 v32, 1.0, v32
    v_add_f32 v33, 1.0, v33
    v_add_f32 v34, 1.0, v34
    v_add_f32 v35, 1.0, v35
    v_rcp_f32 v32, v32
    v_rcp_f32 v33, v33
    v_rcp_f32 v34, v34
    v_rcp_f32 v35, v35
    v_mul_f32 v32, v32, v128
    v_mul_f32 v33, v33, v129
    v_mul_f32 v34, v34, v130
    v_mul_f32 v35, v35, v131
    v_cvt_pk_bf16_f32 v36, v32, v33
    v_cvt_pk_bf16_f32 v37, v34, v35
    v_lshlrev_b32 v32, 16, v36
    v_and_b32 v33, s44, v36
    v_lshlrev_b32 v34, 16, v37
    v_and_b32 v35, s44, v37
    v_mul_f32 v32, v32, v132
    v_mul_f32 v33, v33, v133
    v_mul_f32 v34, v34, v134
    v_mul_f32 v35, v35, v135
    v_cvt_pk_bf16_f32 v64, v32, v33
    v_cvt_pk_bf16_f32 v65, v34, v35
    v_cvt_pk_bf16_f32 v40, v136, v137
    v_cvt_pk_bf16_f32 v41, v138, v139
    v_lshlrev_b32 v136, 16, v40
    v_and_b32 v137, s44, v40
    v_lshlrev_b32 v138, 16, v41
    v_and_b32 v139, s44, v41
    v_cvt_pk_bf16_f32 v40, v140, v141
    v_cvt_pk_bf16_f32 v41, v142, v143
    v_lshlrev_b32 v140, 16, v40
    v_and_b32 v141, s44, v40
    v_lshlrev_b32 v142, 16, v41
    v_and_b32 v143, s44, v41
    v_mul_f32 v40, v136, v136
    v_mul_f32 v41, v137, v137
    v_mul_f32 v42, v138, v138
    v_mul_f32 v43, v139, v139
    v_fma_f32 v40, v40, s43, v25
    v_fma_f32 v41, v41, s43, v25
    v_fma_f32 v42, v42, s43, v25
    v_fma_f32 v43, v43, s43, v25
    v_mul_f32 v40, v40, v136
    v_mul_f32 v41, v41, v137
    v_mul_f32 v42, v42, v138
    v_mul_f32 v43, v43, v139
    v_exp_f32 v40, v40
    v_exp_f32 v41, v41
    v_exp_f32 v42, v42
    v_exp_f32 v43, v43
    v_add_f32 v40, 1.0, v40
    v_add_f32 v41, 1.0, v41
    v_add_f32 v42, 1.0, v42
    v_add_f32 v43, 1.0, v43
    v_rcp_f32 v40, v40
    v_rcp_f32 v41, v41
    v_rcp_f32 v42, v42
    v_rcp_f32 v43, v43
    v_mul_f32 v40, v40, v136
    v_mul_f32 v41, v41, v137
    v_mul_f32 v42, v42, v138
    v_mul_f32 v43, v43, v139
    v_cvt_pk_bf16_f32 v44, v40, v41
    v_cvt_pk_bf16_f32 v45, v42, v43
    v_lshlrev_b32 v40, 16, v44
    v_and_b32 v41, s44, v44
    v_lshlrev_b32 v42, 16, v45
    v_and_b32 v43, s44, v45
    v_mul_f32 v40, v40, v140
    v_mul_f32 v41, v41, v141
    v_mul_f32 v42, v42, v142
    v_mul_f32 v43, v43, v143
    v_cvt_pk_bf16_f32 v66, v40, v41
    v_cvt_pk_bf16_f32 v67, v42, v43
    buffer_store_dwordx4 v[64:67], v23, s[20:23], s48 offen offset:0 sc0 sc1
    v_cvt_pk_bf16_f32 v32, v144, v145
    v_cvt_pk_bf16_f32 v33, v146, v147
    v_lshlrev_b32 v144, 16, v32
    v_and_b32 v145, s44, v32
    v_lshlrev_b32 v146, 16, v33
    v_and_b32 v147, s44, v33
    v_cvt_pk_bf16_f32 v32, v148, v149
    v_cvt_pk_bf16_f32 v33, v150, v151
    v_lshlrev_b32 v148, 16, v32
    v_and_b32 v149, s44, v32
    v_lshlrev_b32 v150, 16, v33
    v_and_b32 v151, s44, v33
    v_mul_f32 v32, v144, v144
    v_mul_f32 v33, v145, v145
    v_mul_f32 v34, v146, v146
    v_mul_f32 v35, v147, v147
    v_fma_f32 v32, v32, s43, v25
    v_fma_f32 v33, v33, s43, v25
    v_fma_f32 v34, v34, s43, v25
    v_fma_f32 v35, v35, s43, v25
    v_mul_f32 v32, v32, v144
    v_mul_f32 v33, v33, v145
    v_mul_f32 v34, v34, v146
    v_mul_f32 v35, v35, v147
    v_exp_f32 v32, v32
    v_exp_f32 v33, v33
    v_exp_f32 v34, v34
    v_exp_f32 v35, v35
    v_add_f32 v32, 1.0, v32
    v_add_f32 v33, 1.0, v33
    v_add_f32 v34, 1.0, v34
    v_add_f32 v35, 1.0, v35
    v_rcp_f32 v32, v32
    v_rcp_f32 v33, v33
    v_rcp_f32 v34, v34
    v_rcp_f32 v35, v35
    v_mul_f32 v32, v32, v144
    v_mul_f32 v33, v33, v145
    v_mul_f32 v34, v34, v146
    v_mul_f32 v35, v35, v147
    v_cvt_pk_bf16_f32 v36, v32, v33
    v_cvt_pk_bf16_f32 v37, v34, v35
    v_lshlrev_b32 v32, 16, v36
    v_and_b32 v33, s44, v36
    v_lshlrev_b32 v34, 16, v37
    v_and_b32 v35, s44, v37
    v_mul_f32 v32, v32, v148
    v_mul_f32 v33, v33, v149
    v_mul_f32 v34, v34, v150
    v_mul_f32 v35, v35, v151
    v_cvt_pk_bf16_f32 v68, v32, v33
    v_cvt_pk_bf16_f32 v69, v34, v35
    v_cvt_pk_bf16_f32 v40, v152, v153
    v_cvt_pk_bf16_f32 v41, v154, v155
    v_lshlrev_b32 v152, 16, v40
    v_and_b32 v153, s44, v40
    v_lshlrev_b32 v154, 16, v41
    v_and_b32 v155, s44, v41
    v_cvt_pk_bf16_f32 v40, v156, v157
    v_cvt_pk_bf16_f32 v41, v158, v159
    v_lshlrev_b32 v156, 16, v40
    v_and_b32 v157, s44, v40
    v_lshlrev_b32 v158, 16, v41
    v_and_b32 v159, s44, v41
    v_mul_f32 v40, v152, v152
    v_mul_f32 v41, v153, v153
    v_mul_f32 v42, v154, v154
    v_mul_f32 v43, v155, v155
    v_fma_f32 v40, v40, s43, v25
    v_fma_f32 v41, v41, s43, v25
    v_fma_f32 v42, v42, s43, v25
    v_fma_f32 v43, v43, s43, v25
    v_mul_f32 v40, v40, v152
    v_mul_f32 v41, v41, v153
    v_mul_f32 v42, v42, v154
    v_mul_f32 v43, v43, v155
    v_exp_f32 v40, v40
    v_exp_f32 v41, v41
    v_exp_f32 v42, v42
    v_exp_f32 v43, v43
    v_add_f32 v40, 1.0, v40
    v_add_f32 v41, 1.0, v41
    v_add_f32 v42, 1.0, v42
    v_add_f32 v43, 1.0, v43
    v_rcp_f32 v40, v40
    v_rcp_f32 v41, v41
    v_rcp_f32 v42, v42
    v_rcp_f32 v43, v43
    v_mul_f32 v40, v40, v152
    v_mul_f32 v41, v41, v153
    v_mul_f32 v42, v42, v154
    v_mul_f32 v43, v43, v155
    v_cvt_pk_bf16_f32 v44, v40, v41
    v_cvt_pk_bf16_f32 v45, v42, v43
    v_lshlrev_b32 v40, 16, v44
    v_and_b32 v41, s44, v44
    v_lshlrev_b32 v42, 16, v45
    v_and_b32 v43, s44, v45
    v_mul_f32 v40, v40, v156
    v_mul_f32 v41, v41, v157
    v_mul_f32 v42, v42, v158
    v_mul_f32 v43, v43, v159
    v_cvt_pk_bf16_f32 v70, v40, v41
    v_cvt_pk_bf16_f32 v71, v42, v43
    buffer_store_dwordx4 v[68:71], v23, s[20:23], s48 offen offset:1024 sc0 sc1
    v_cvt_pk_bf16_f32 v32, v160, v161
    v_cvt_pk_bf16_f32 v33, v162, v163
    v_lshlrev_b32 v160, 16, v32
    v_and_b32 v161, s44, v32
    v_lshlrev_b32 v162, 16, v33
    v_and_b32 v163, s44, v33
    v_cvt_pk_bf16_f32 v32, v164, v165
    v_cvt_pk_bf16_f32 v33, v166, v167
    v_lshlrev_b32 v164, 16, v32
    v_and_b32 v165, s44, v32
    v_lshlrev_b32 v166, 16, v33
    v_and_b32 v167, s44, v33
    v_mul_f32 v32, v160, v160
    v_mul_f32 v33, v161, v161
    v_mul_f32 v34, v162, v162
    v_mul_f32 v35, v163, v163
    v_fma_f32 v32, v32, s43, v25
    v_fma_f32 v33, v33, s43, v25
    v_fma_f32 v34, v34, s43, v25
    v_fma_f32 v35, v35, s43, v25
    v_mul_f32 v32, v32, v160
    v_mul_f32 v33, v33, v161
    v_mul_f32 v34, v34, v162
    v_mul_f32 v35, v35, v163
    v_exp_f32 v32, v32
    v_exp_f32 v33, v33
    v_exp_f32 v34, v34
    v_exp_f32 v35, v35
    v_add_f32 v32, 1.0, v32
    v_add_f32 v33, 1.0, v33
    v_add_f32 v34, 1.0, v34
    v_add_f32 v35, 1.0, v35
    v_rcp_f32 v32, v32
    v_rcp_f32 v33, v33
    v_rcp_f32 v34, v34
    v_rcp_f32 v35, v35
    v_mul_f32 v32, v32, v160
    v_mul_f32 v33, v33, v161
    v_mul_f32 v34, v34, v162
    v_mul_f32 v35, v35, v163
    v_cvt_pk_bf16_f32 v36, v32, v33
    v_cvt_pk_bf16_f32 v37, v34, v35
    v_lshlrev_b32 v32, 16, v36
    v_and_b32 v33, s44, v36
    v_lshlrev_b32 v34, 16, v37
    v_and_b32 v35, s44, v37
    v_mul_f32 v32, v32, v164
    v_mul_f32 v33, v33, v165
    v_mul_f32 v34, v34, v166
    v_mul_f32 v35, v35, v167
    v_cvt_pk_bf16_f32 v72, v32, v33
    v_cvt_pk_bf16_f32 v73, v34, v35
    v_cvt_pk_bf16_f32 v40, v168, v169
    v_cvt_pk_bf16_f32 v41, v170, v171
    v_lshlrev_b32 v168, 16, v40
    v_and_b32 v169, s44, v40
    v_lshlrev_b32 v170, 16, v41
    v_and_b32 v171, s44, v41
    v_cvt_pk_bf16_f32 v40, v172, v173
    v_cvt_pk_bf16_f32 v41, v174, v175
    v_lshlrev_b32 v172, 16, v40
    v_and_b32 v173, s44, v40
    v_lshlrev_b32 v174, 16, v41
    v_and_b32 v175, s44, v41
    v_mul_f32 v40, v168, v168
    v_mul_f32 v41, v169, v169
    v_mul_f32 v42, v170, v170
    v_mul_f32 v43, v171, v171
    v_fma_f32 v40, v40, s43, v25
    v_fma_f32 v41, v41, s43, v25
    v_fma_f32 v42, v42, s43, v25
    v_fma_f32 v43, v43, s43, v25
    v_mul_f32 v40, v40, v168
    v_mul_f32 v41, v41, v169
    v_mul_f32 v42, v42, v170
    v_mul_f32 v43, v43, v171
    v_exp_f32 v40, v40
    v_exp_f32 v41, v41
    v_exp_f32 v42, v42
    v_exp_f32 v43, v43
    v_add_f32 v40, 1.0, v40
    v_add_f32 v41, 1.0, v41
    v_add_f32 v42, 1.0, v42
    v_add_f32 v43, 1.0, v43
    v_rcp_f32 v40, v40
    v_rcp_f32 v41, v41
    v_rcp_f32 v42, v42
    v_rcp_f32 v43, v43
    v_mul_f32 v40, v40, v168
    v_mul_f32 v41, v41, v169
    v_mul_f32 v42, v42, v170
    v_mul_f32 v43, v43, v171
    v_cvt_pk_bf16_f32 v44, v40, v41
    v_cvt_pk_bf16_f32 v45, v42, v43
    v_lshlrev_b32 v40, 16, v44
    v_and_b32 v41, s44, v44
    v_lshlrev_b32 v42, 16, v45
    v_and_b32 v43, s44, v45
    v_mul_f32 v40, v40, v172
    v_mul_f32 v41, v41, v173
    v_mul_f32 v42, v42, v174
    v_mul_f32 v43, v43, v175
    v_cvt_pk_bf16_f32 v74, v40, v41
    v_cvt_pk_bf16_f32 v75, v42, v43
    buffer_store_dwordx4 v[72:75], v23, s[20:23], s49 offen offset:0 sc0 sc1
    v_cvt_pk_bf16_f32 v32, v176, v177
    v_cvt_pk_bf16_f32 v33, v178, v179
    v_lshlrev_b32 v176, 16, v32
    v_and_b32 v177, s44, v32
    v_lshlrev_b32 v178, 16, v33
    v_and_b32 v179, s44, v33
    v_cvt_pk_bf16_f32 v32, v180, v181
    v_cvt_pk_bf16_f32 v33, v182, v183
    v_lshlrev_b32 v180, 16, v32
    v_and_b32 v181, s44, v32
    v_lshlrev_b32 v182, 16, v33
    v_and_b32 v183, s44, v33
    v_mul_f32 v32, v176, v176
    v_mul_f32 v33, v177, v177
    v_mul_f32 v34, v178, v178
    v_mul_f32 v35, v179, v179
    v_fma_f32 v32, v32, s43, v25
    v_fma_f32 v33, v33, s43, v25
    v_fma_f32 v34, v34, s43, v25
    v_fma_f32 v35, v35, s43, v25
    v_mul_f32 v32, v32, v176
    v_mul_f32 v33, v33, v177
    v_mul_f32 v34, v34, v178
    v_mul_f32 v35, v35, v179
    v_exp_f32 v32, v32
    v_exp_f32 v33, v33
    v_exp_f32 v34, v34
    v_exp_f32 v35, v35
    v_add_f32 v32, 1.0, v32
    v_add_f32 v33, 1.0, v33
    v_add_f32 v34, 1.0, v34
    v_add_f32 v35, 1.0, v35
    v_rcp_f32 v32, v32
    v_rcp_f32 v33, v33
    v_rcp_f32 v34, v34
    v_rcp_f32 v35, v35
    v_mul_f32 v32, v32, v176
    v_mul_f32 v33, v33, v177
    v_mul_f32 v34, v34, v178
    v_mul_f32 v35, v35, v179
    v_cvt_pk_bf16_f32 v36, v32, v33
    v_cvt_pk_bf16_f32 v37, v34, v35
    v_lshlrev_b32 v32, 16, v36
    v_and_b32 v33, s44, v36
    v_lshlrev_b32 v34, 16, v37
    v_and_b32 v35, s44, v37
    v_mul_f32 v32, v32, v180
    v_mul_f32 v33, v33, v181
    v_mul_f32 v34, v34, v182
    v_mul_f32 v35, v35, v183
    v_cvt_pk_bf16_f32 v76, v32, v33
    v_cvt_pk_bf16_f32 v77, v34, v35
    v_cvt_pk_bf16_f32 v40, v184, v185
    v_cvt_pk_bf16_f32 v41, v186, v187
    v_lshlrev_b32 v184, 16, v40
    v_and_b32 v185, s44, v40
    v_lshlrev_b32 v186, 16, v41
    v_and_b32 v187, s44, v41
    v_cvt_pk_bf16_f32 v40, v188, v189
    v_cvt_pk_bf16_f32 v41, v190, v191
    v_lshlrev_b32 v188, 16, v40
    v_and_b32 v189, s44, v40
    v_lshlrev_b32 v190, 16, v41
    v_and_b32 v191, s44, v41
    v_mul_f32 v40, v184, v184
    v_mul_f32 v41, v185, v185
    v_mul_f32 v42, v186, v186
    v_mul_f32 v43, v187, v187
    v_fma_f32 v40, v40, s43, v25
    v_fma_f32 v41, v41, s43, v25
    v_fma_f32 v42, v42, s43, v25
    v_fma_f32 v43, v43, s43, v25
    v_mul_f32 v40, v40, v184
    v_mul_f32 v41, v41, v185
    v_mul_f32 v42, v42, v186
    v_mul_f32 v43, v43, v187
    v_exp_f32 v40, v40
    v_exp_f32 v41, v41
    v_exp_f32 v42, v42
    v_exp_f32 v43, v43
    v_add_f32 v40, 1.0, v40
    v_add_f32 v41, 1.0, v41
    v_add_f32 v42, 1.0, v42
    v_add_f32 v43, 1.0, v43
    v_rcp_f32 v40, v40
    v_rcp_f32 v41, v41
    v_rcp_f32 v42, v42
    v_rcp_f32 v43, v43
    v_mul_f32 v40, v40, v184
    v_mul_f32 v41, v41, v185
    v_mul_f32 v42, v42, v186
    v_mul_f32 v43, v43, v187
    v_cvt_pk_bf16_f32 v44, v40, v41
    v_cvt_pk_bf16_f32 v45, v42, v43
    v_lshlrev_b32 v40, 16, v44
    v_and_b32 v41, s44, v44
    v_lshlrev_b32 v42, 16, v45
    v_and_b32 v43, s44, v45
    v_mul_f32 v40, v40, v188
    v_mul_f32 v41, v41, v189
    v_mul_f32 v42, v42, v190
    v_mul_f32 v43, v43, v191
    v_cvt_pk_bf16_f32 v78, v40, v41
    v_cvt_pk_bf16_f32 v79, v42, v43
    buffer_store_dwordx4 v[76:79], v23, s[20:23], s49 offen offset:1024 sc0 sc1
    v_cvt_pk_bf16_f32 v32, v192, v193
    v_cvt_pk_bf16_f32 v33, v194, v195
    v_lshlrev_b32 v192, 16, v32
    v_and_b32 v193, s44, v32
    v_lshlrev_b32 v194, 16, v33
    v_and_b32 v195, s44, v33
    v_cvt_pk_bf16_f32 v32, v196, v197
    v_cvt_pk_bf16_f32 v33, v198, v199
    v_lshlrev_b32 v196, 16, v32
    v_and_b32 v197, s44, v32
    v_lshlrev_b32 v198, 16, v33
    v_and_b32 v199, s44, v33
    v_mul_f32 v32, v192, v192
    v_mul_f32 v33, v193, v193
    v_mul_f32 v34, v194, v194
    v_mul_f32 v35, v195, v195
    v_fma_f32 v32, v32, s43, v25
    v_fma_f32 v33, v33, s43, v25
    v_fma_f32 v34, v34, s43, v25
    v_fma_f32 v35, v35, s43, v25
    v_mul_f32 v32, v32, v192
    v_mul_f32 v33, v33, v193
    v_mul_f32 v34, v34, v194
    v_mul_f32 v35, v35, v195
    v_exp_f32 v32, v32
    v_exp_f32 v33, v33
    v_exp_f32 v34, v34
    v_exp_f32 v35, v35
    v_add_f32 v32, 1.0, v32
    v_add_f32 v33, 1.0, v33
    v_add_f32 v34, 1.0, v34
    v_add_f32 v35, 1.0, v35
    v_rcp_f32 v32, v32
    v_rcp_f32 v33, v33
    v_rcp_f32 v34, v34
    v_rcp_f32 v35, v35
    v_mul_f32 v32, v32, v192
    v_mul_f32 v33, v33, v193
    v_mul_f32 v34, v34, v194
    v_mul_f32 v35, v35, v195
    v_cvt_pk_bf16_f32 v36, v32, v33
    v_cvt_pk_bf16_f32 v37, v34, v35
    v_lshlrev_b32 v32, 16, v36
    v_and_b32 v33, s44, v36
    v_lshlrev_b32 v34, 16, v37
    v_and_b32 v35, s44, v37
    v_mul_f32 v32, v32, v196
    v_mul_f32 v33, v33, v197
    v_mul_f32 v34, v34, v198
    v_mul_f32 v35, v35, v199
    v_cvt_pk_bf16_f32 v80, v32, v33
    v_cvt_pk_bf16_f32 v81, v34, v35
    v_cvt_pk_bf16_f32 v40, v200, v201
    v_cvt_pk_bf16_f32 v41, v202, v203
    v_lshlrev_b32 v200, 16, v40
    v_and_b32 v201, s44, v40
    v_lshlrev_b32 v202, 16, v41
    v_and_b32 v203, s44, v41
    v_cvt_pk_bf16_f32 v40, v204, v205
    v_cvt_pk_bf16_f32 v41, v206, v207
    v_lshlrev_b32 v204, 16, v40
    v_and_b32 v205, s44, v40
    v_lshlrev_b32 v206, 16, v41
    v_and_b32 v207, s44, v41
    v_mul_f32 v40, v200, v200
    v_mul_f32 v41, v201, v201
    v_mul_f32 v42, v202, v202
    v_mul_f32 v43, v203, v203
    v_fma_f32 v40, v40, s43, v25
    v_fma_f32 v41, v41, s43, v25
    v_fma_f32 v42, v42, s43, v25
    v_fma_f32 v43, v43, s43, v25
    v_mul_f32 v40, v40, v200
    v_mul_f32 v41, v41, v201
    v_mul_f32 v42, v42, v202
    v_mul_f32 v43, v43, v203
    v_exp_f32 v40, v40
    v_exp_f32 v41, v41
    v_exp_f32 v42, v42
    v_exp_f32 v43, v43
    v_add_f32 v40, 1.0, v40
    v_add_f32 v41, 1.0, v41
    v_add_f32 v42, 1.0, v42
    v_add_f32 v43, 1.0, v43
    v_rcp_f32 v40, v40
    v_rcp_f32 v41, v41
    v_rcp_f32 v42, v42
    v_rcp_f32 v43, v43
    v_mul_f32 v40, v40, v200
    v_mul_f32 v41, v41, v201
    v_mul_f32 v42, v42, v202
    v_mul_f32 v43, v43, v203
    v_cvt_pk_bf16_f32 v44, v40, v41
    v_cvt_pk_bf16_f32 v45, v42, v43
    v_lshlrev_b32 v40, 16, v44
    v_and_b32 v41, s44, v44
    v_lshlrev_b32 v42, 16, v45
    v_and_b32 v43, s44, v45
    v_mul_f32 v40, v40, v204
    v_mul_f32 v41, v41, v205
    v_mul_f32 v42, v42, v206
    v_mul_f32 v43, v43, v207
    v_cvt_pk_bf16_f32 v82, v40, v41
    v_cvt_pk_bf16_f32 v83, v42, v43
    buffer_store_dwordx4 v[80:83], v23, s[20:23], s50 offen offset:0 sc0 sc1
    v_cvt_pk_bf16_f32 v32, v208, v209
    v_cvt_pk_bf16_f32 v33, v210, v211
    v_lshlrev_b32 v208, 16, v32
    v_and_b32 v209, s44, v32
    v_lshlrev_b32 v210, 16, v33
    v_and_b32 v211, s44, v33
    v_cvt_pk_bf16_f32 v32, v212, v213
    v_cvt_pk_bf16_f32 v33, v214, v215
    v_lshlrev_b32 v212, 16, v32
    v_and_b32 v213, s44, v32
    v_lshlrev_b32 v214, 16, v33
    v_and_b32 v215, s44, v33
    v_mul_f32 v32, v208, v208
    v_mul_f32 v33, v209, v209
    v_mul_f32 v34, v210, v210
    v_mul_f32 v35, v211, v211
    v_fma_f32 v32, v32, s43, v25
    v_fma_f32 v33, v33, s43, v25
    v_fma_f32 v34, v34, s43, v25
    v_fma_f32 v35, v35, s43, v25
    v_mul_f32 v32, v32, v208
    v_mul_f32 v33, v33, v209
    v_mul_f32 v34, v34, v210
    v_mul_f32 v35, v35, v211
    v_exp_f32 v32, v32
    v_exp_f32 v33, v33
    v_exp_f32 v34, v34
    v_exp_f32 v35, v35
    v_add_f32 v32, 1.0, v32
    v_add_f32 v33, 1.0, v33
    v_add_f32 v34, 1.0, v34
    v_add_f32 v35, 1.0, v35
    v_rcp_f32 v32, v32
    v_rcp_f32 v33, v33
    v_rcp_f32 v34, v34
    v_rcp_f32 v35, v35
    v_mul_f32 v32, v32, v208
    v_mul_f32 v33, v33, v209
    v_mul_f32 v34, v34, v210
    v_mul_f32 v35, v35, v211
    v_cvt_pk_bf16_f32 v36, v32, v33
    v_cvt_pk_bf16_f32 v37, v34, v35
    v_lshlrev_b32 v32, 16, v36
    v_and_b32 v33, s44, v36
    v_lshlrev_b32 v34, 16, v37
    v_and_b32 v35, s44, v37
    v_mul_f32 v32, v32, v212
    v_mul_f32 v33, v33, v213
    v_mul_f32 v34, v34, v214
    v_mul_f32 v35, v35, v215
    v_cvt_pk_bf16_f32 v84, v32, v33
    v_cvt_pk_bf16_f32 v85, v34, v35
    v_cvt_pk_bf16_f32 v40, v216, v217
    v_cvt_pk_bf16_f32 v41, v218, v219
    v_lshlrev_b32 v216, 16, v40
    v_and_b32 v217, s44, v40
    v_lshlrev_b32 v218, 16, v41
    v_and_b32 v219, s44, v41
    v_cvt_pk_bf16_f32 v40, v220, v221
    v_cvt_pk_bf16_f32 v41, v222, v223
    v_lshlrev_b32 v220, 16, v40
    v_and_b32 v221, s44, v40
    v_lshlrev_b32 v222, 16, v41
    v_and_b32 v223, s44, v41
    v_mul_f32 v40, v216, v216
    v_mul_f32 v41, v217, v217
    v_mul_f32 v42, v218, v218
    v_mul_f32 v43, v219, v219
    v_fma_f32 v40, v40, s43, v25
    v_fma_f32 v41, v41, s43, v25
    v_fma_f32 v42, v42, s43, v25
    v_fma_f32 v43, v43, s43, v25
    v_mul_f32 v40, v40, v216
    v_mul_f32 v41, v41, v217
    v_mul_f32 v42, v42, v218
    v_mul_f32 v43, v43, v219
    v_exp_f32 v40, v40
    v_exp_f32 v41, v41
    v_exp_f32 v42, v42
    v_exp_f32 v43, v43
    v_add_f32 v40, 1.0, v40
    v_add_f32 v41, 1.0, v41
    v_add_f32 v42, 1.0, v42
    v_add_f32 v43, 1.0, v43
    v_rcp_f32 v40, v40
    v_rcp_f32 v41, v41
    v_rcp_f32 v42, v42
    v_rcp_f32 v43, v43
    v_mul_f32 v40, v40, v216
    v_mul_f32 v41, v41, v217
    v_mul_f32 v42, v42, v218
    v_mul_f32 v43, v43, v219
    v_cvt_pk_bf16_f32 v44, v40, v41
    v_cvt_pk_bf16_f32 v45, v42, v43
    v_lshlrev_b32 v40, 16, v44
    v_and_b32 v41, s44, v44
    v_lshlrev_b32 v42, 16, v45
    v_and_b32 v43, s44, v45
    v_mul_f32 v40, v40, v220
    v_mul_f32 v41, v41, v221
    v_mul_f32 v42, v42, v222
    v_mul_f32 v43, v43, v223
    v_cvt_pk_bf16_f32 v86, v40, v41
    v_cvt_pk_bf16_f32 v87, v42, v43
    buffer_store_dwordx4 v[84:87], v23, s[20:23], s50 offen offset:1024 sc0 sc1
    v_cvt_pk_bf16_f32 v32, v224, v225
    v_cvt_pk_bf16_f32 v33, v226, v227
    v_lshlrev_b32 v224, 16, v32
    v_and_b32 v225, s44, v32
    v_lshlrev_b32 v226, 16, v33
    v_and_b32 v227, s44, v33
    v_cvt_pk_bf16_f32 v32, v228, v229
    v_cvt_pk_bf16_f32 v33, v230, v231
    v_lshlrev_b32 v228, 16, v32
    v_and_b32 v229, s44, v32
    v_lshlrev_b32 v230, 16, v33
    v_and_b32 v231, s44, v33
    v_mul_f32 v32, v224, v224
    v_mul_f32 v33, v225, v225
    v_mul_f32 v34, v226, v226
    v_mul_f32 v35, v227, v227
    v_fma_f32 v32, v32, s43, v25
    v_fma_f32 v33, v33, s43, v25
    v_fma_f32 v34, v34, s43, v25
    v_fma_f32 v35, v35, s43, v25
    v_mul_f32 v32, v32, v224
    v_mul_f32 v33, v33, v225
    v_mul_f32 v34, v34, v226
    v_mul_f32 v35, v35, v227
    v_exp_f32 v32, v32
    v_exp_f32 v33, v33
    v_exp_f32 v34, v34
    v_exp_f32 v35, v35
    v_add_f32 v32, 1.0, v32
    v_add_f32 v33, 1.0, v33
    v_add_f32 v34, 1.0, v34
    v_add_f32 v35, 1.0, v35
    v_rcp_f32 v32, v32
    v_rcp_f32 v33, v33
    v_rcp_f32 v34, v34
    v_rcp_f32 v35, v35
    v_mul_f32 v32, v32, v224
    v_mul_f32 v33, v33, v225
    v_mul_f32 v34, v34, v226
    v_mul_f32 v35, v35, v227
    v_cvt_pk_bf16_f32 v36, v32, v33
    v_cvt_pk_bf16_f32 v37, v34, v35
    v_lshlrev_b32 v32, 16, v36
    v_and_b32 v33, s44, v36
    v_lshlrev_b32 v34, 16, v37
    v_and_b32 v35, s44, v37
    v_mul_f32 v32, v32, v228
    v_mul_f32 v33, v33, v229
    v_mul_f32 v34, v34, v230
    v_mul_f32 v35, v35, v231
    v_cvt_pk_bf16_f32 v88, v32, v33
    v_cvt_pk_bf16_f32 v89, v34, v35
    v_cvt_pk_bf16_f32 v40, v232, v233
    v_cvt_pk_bf16_f32 v41, v234, v235
    v_lshlrev_b32 v232, 16, v40
    v_and_b32 v233, s44, v40
    v_lshlrev_b32 v234, 16, v41
    v_and_b32 v235, s44, v41
    v_cvt_pk_bf16_f32 v40, v236, v237
    v_cvt_pk_bf16_f32 v41, v238, v239
    v_lshlrev_b32 v236, 16, v40
    v_and_b32 v237, s44, v40
    v_lshlrev_b32 v238, 16, v41
    v_and_b32 v239, s44, v41
    v_mul_f32 v40, v232, v232
    v_mul_f32 v41, v233, v233
    v_mul_f32 v42, v234, v234
    v_mul_f32 v43, v235, v235
    v_fma_f32 v40, v40, s43, v25
    v_fma_f32 v41, v41, s43, v25
    v_fma_f32 v42, v42, s43, v25
    v_fma_f32 v43, v43, s43, v25
    v_mul_f32 v40, v40, v232
    v_mul_f32 v41, v41, v233
    v_mul_f32 v42, v42, v234
    v_mul_f32 v43, v43, v235
    v_exp_f32 v40, v40
    v_exp_f32 v41, v41
    v_exp_f32 v42, v42
    v_exp_f32 v43, v43
    v_add_f32 v40, 1.0, v40
    v_add_f32 v41, 1.0, v41
    v_add_f32 v42, 1.0, v42
    v_add_f32 v43, 1.0, v43
    v_rcp_f32 v40, v40
    v_rcp_f32 v41, v41
    v_rcp_f32 v42, v42
    v_rcp_f32 v43, v43
    v_mul_f32 v40, v40, v232
    v_mul_f32 v41, v41, v233
    v_mul_f32 v42, v42, v234
    v_mul_f32 v43, v43, v235
    v_cvt_pk_bf16_f32 v44, v40, v41
    v_cvt_pk_bf16_f32 v45, v42, v43
    v_lshlrev_b32 v40, 16, v44
    v_and_b32 v41, s44, v44
    v_lshlrev_b32 v42, 16, v45
    v_and_b32 v43, s44, v45
    v_mul_f32 v40, v40, v236
    v_mul_f32 v41, v41, v237
    v_mul_f32 v42, v42, v238
    v_mul_f32 v43, v43, v239
    v_cvt_pk_bf16_f32 v90, v40, v41
    v_cvt_pk_bf16_f32 v91, v42, v43
    buffer_store_dwordx4 v[88:91], v23, s[20:23], s51 offen offset:0 sc0 sc1
    v_cvt_pk_bf16_f32 v32, v240, v241
    v_cvt_pk_bf16_f32 v33, v242, v243
    v_lshlrev_b32 v240, 16, v32
    v_and_b32 v241, s44, v32
    v_lshlrev_b32 v242, 16, v33
    v_and_b32 v243, s44, v33
    v_cvt_pk_bf16_f32 v32, v244, v245
    v_cvt_pk_bf16_f32 v33, v246, v247
    v_lshlrev_b32 v244, 16, v32
    v_and_b32 v245, s44, v32
    v_lshlrev_b32 v246, 16, v33
    v_and_b32 v247, s44, v33
    v_mul_f32 v32, v240, v240
    v_mul_f32 v33, v241, v241
    v_mul_f32 v34, v242, v242
    v_mul_f32 v35, v243, v243
    v_fma_f32 v32, v32, s43, v25
    v_fma_f32 v33, v33, s43, v25
    v_fma_f32 v34, v34, s43, v25
    v_fma_f32 v35, v35, s43, v25
    v_mul_f32 v32, v32, v240
    v_mul_f32 v33, v33, v241
    v_mul_f32 v34, v34, v242
    v_mul_f32 v35, v35, v243
    v_exp_f32 v32, v32
    v_exp_f32 v33, v33
    v_exp_f32 v34, v34
    v_exp_f32 v35, v35
    v_add_f32 v32, 1.0, v32
    v_add_f32 v33, 1.0, v33
    v_add_f32 v34, 1.0, v34
    v_add_f32 v35, 1.0, v35
    v_rcp_f32 v32, v32
    v_rcp_f32 v33, v33
    v_rcp_f32 v34, v34
    v_rcp_f32 v35, v35
    v_mul_f32 v32, v32, v240
    v_mul_f32 v33, v33, v241
    v_mul_f32 v34, v34, v242
    v_mul_f32 v35, v35, v243
    v_cvt_pk_bf16_f32 v36, v32, v33
    v_cvt_pk_bf16_f32 v37, v34, v35
    v_lshlrev_b32 v32, 16, v36
    v_and_b32 v33, s44, v36
    v_lshlrev_b32 v34, 16, v37
    v_and_b32 v35, s44, v37
    v_mul_f32 v32, v32, v244
    v_mul_f32 v33, v33, v245
    v_mul_f32 v34, v34, v246
    v_mul_f32 v35, v35, v247
    v_cvt_pk_bf16_f32 v92, v32, v33
    v_cvt_pk_bf16_f32 v93, v34, v35
    v_cvt_pk_bf16_f32 v40, v248, v249
    v_cvt_pk_bf16_f32 v41, v250, v251
    v_lshlrev_b32 v248, 16, v40
    v_and_b32 v249, s44, v40
    v_lshlrev_b32 v250, 16, v41
    v_and_b32 v251, s44, v41
    v_cvt_pk_bf16_f32 v40, v252, v253
    v_cvt_pk_bf16_f32 v41, v254, v255
    v_lshlrev_b32 v252, 16, v40
    v_and_b32 v253, s44, v40
    v_lshlrev_b32 v254, 16, v41
    v_and_b32 v255, s44, v41
    v_mul_f32 v40, v248, v248
    v_mul_f32 v41, v249, v249
    v_mul_f32 v42, v250, v250
    v_mul_f32 v43, v251, v251
    v_fma_f32 v40, v40, s43, v25
    v_fma_f32 v41, v41, s43, v25
    v_fma_f32 v42, v42, s43, v25
    v_fma_f32 v43, v43, s43, v25
    v_mul_f32 v40, v40, v248
    v_mul_f32 v41, v41, v249
    v_mul_f32 v42, v42, v250
    v_mul_f32 v43, v43, v251
    v_exp_f32 v40, v40
    v_exp_f32 v41, v41
    v_exp_f32 v42, v42
    v_exp_f32 v43, v43
    v_add_f32 v40, 1.0, v40
    v_add_f32 v41, 1.0, v41
    v_add_f32 v42, 1.0, v42
    v_add_f32 v43, 1.0, v43
    v_rcp_f32 v40, v40
    v_rcp_f32 v41, v41
    v_rcp_f32 v42, v42
    v_rcp_f32 v43, v43
    v_mul_f32 v40, v40, v248
    v_mul_f32 v41, v41, v249
    v_mul_f32 v42, v42, v250
    v_mul_f32 v43, v43, v251
    v_cvt_pk_bf16_f32 v44, v40, v41
    v_cvt_pk_bf16_f32 v45, v42, v43
    v_lshlrev_b32 v40, 16, v44
    v_and_b32 v41, s44, v44
    v_lshlrev_b32 v42, 16, v45
    v_and_b32 v43, s44, v45
    v_mul_f32 v40, v40, v252
    v_mul_f32 v41, v41, v253
    v_mul_f32 v42, v42, v254
    v_mul_f32 v43, v43, v255
    v_cvt_pk_bf16_f32 v94, v40, v41
    v_cvt_pk_bf16_f32 v95, v42, v43
    buffer_store_dwordx4 v[92:95], v23, s[20:23], s51 offen offset:1024 sc0 sc1
    s_branch K1_TO_K2
K1_TYPE01:
    s_mov_b32 s30, 0
    s_mov_b32 s45, 0
    s_mov_b32 s46, s41
    s_mov_b32 s70, 0
    v_mov_b32 v26, 0
    s_add_u32 m0, s41, 14336
    s_nop 0
    buffer_load_dwordx4 v10, s[16:19], s30 offen lds
    s_add_u32 m0, s41, 15360
    s_nop 0
    buffer_load_dwordx4 v11, s[16:19], s30 offen lds
    s_add_u32 m0, s41, 16384
    s_nop 0
    buffer_load_dwordx4 v12, s[16:19], s30 offen lds
    s_add_u32 m0, s41, 17408
    s_nop 0
    buffer_load_dwordx4 v13, s[16:19], s30 offen lds
    s_add_u32 m0, s41, 18432
    s_nop 0
    buffer_load_dwordx4 v14, s[16:19], s30 offen lds
    s_add_u32 m0, s41, 19456
    s_nop 0
    buffer_load_dwordx4 v15, s[16:19], s30 offen lds
    s_add_u32 m0, s41, 20480
    s_nop 0
    buffer_load_dwordx4 v16, s[16:19], s30 offen lds
    s_add_u32 s30, s30, 458752
    v_mov_b32 v128, 0
    v_mov_b32 v129, 0
    v_mov_b32 v130, 0
    v_mov_b32 v131, 0
    v_mov_b32 v132, 0
    v_mov_b32 v133, 0
    v_mov_b32 v134, 0
    v_mov_b32 v135, 0
    v_mov_b32 v136, 0
    v_mov_b32 v137, 0
    v_mov_b32 v138, 0
    v_mov_b32 v139, 0
    v_mov_b32 v140, 0
    v_mov_b32 v141, 0
    v_mov_b32 v142, 0
    v_mov_b32 v143, 0
    v_mov_b32 v144, 0
    v_mov_b32 v145, 0
    v_mov_b32 v146, 0
    v_mov_b32 v147, 0
    v_mov_b32 v148, 0
    v_mov_b32 v149, 0
    v_mov_b32 v150, 0
    v_mov_b32 v151, 0
    v_mov_b32 v152, 0
    v_mov_b32 v153, 0
    v_mov_b32 v154, 0
    v_mov_b32 v155, 0
    v_mov_b32 v156, 0
    v_mov_b32 v157, 0
    v_mov_b32 v158, 0
    v_mov_b32 v159, 0
    v_mov_b32 v160, 0
    v_mov_b32 v161, 0
    v_mov_b32 v162, 0
    v_mov_b32 v163, 0
    v_mov_b32 v164, 0
    v_mov_b32 v165, 0
    v_mov_b32 v166, 0
    v_mov_b32 v167, 0
    v_mov_b32 v168, 0
    v_mov_b32 v169, 0
    v_mov_b32 v170, 0
    v_mov_b32 v171, 0
    v_mov_b32 v172, 0
    v_mov_b32 v173, 0
    v_mov_b32 v174, 0
    v_mov_b32 v175, 0
    v_mov_b32 v176, 0
    v_mov_b32 v177, 0
    v_mov_b32 v178, 0
    v_mov_b32 v179, 0
    v_mov_b32 v180, 0
    v_mov_b32 v181, 0
    v_mov_b32 v182, 0
    v_mov_b32 v183, 0
    v_mov_b32 v184, 0
    v_mov_b32 v185, 0
    v_mov_b32 v186, 0
    v_mov_b32 v187, 0
    v_mov_b32 v188, 0
    v_mov_b32 v189, 0
    v_mov_b32 v190, 0
    v_mov_b32 v191, 0
    v_mov_b32 v192, 0
    v_mov_b32 v193, 0
    v_mov_b32 v194, 0
    v_mov_b32 v195, 0
    v_mov_b32 v196, 0
    v_mov_b32 v197, 0
    v_mov_b32 v198, 0
    v_mov_b32 v199, 0
    v_mov_b32 v200, 0
    v_mov_b32 v201, 0
    v_mov_b32 v202, 0
    v_mov_b32 v203, 0
    v_mov_b32 v204, 0
    v_mov_b32 v205, 0
    v_mov_b32 v206, 0
    v_mov_b32 v207, 0
    v_mov_b32 v208, 0
    v_mov_b32 v209, 0
    v_mov_b32 v210, 0
    v_mov_b32 v211, 0
    v_mov_b32 v212, 0
    v_mov_b32 v213, 0
    v_mov_b32 v214, 0
    v_mov_b32 v215, 0
    v_mov_b32 v216, 0
    v_mov_b32 v217, 0
    v_mov_b32 v218, 0
    v_mov_b32 v219, 0
    v_mov_b32 v220, 0
    v_mov_b32 v221, 0
    v_mov_b32 v222, 0
    v_mov_b32 v223, 0
    v_mov_b32 v224, 0
    v_mov_b32 v225, 0
    v_mov_b32 v226, 0
    v_mov_b32 v227, 0
    v_mov_b32 v228, 0
    v_mov_b32 v229, 0
    v_mov_b32 v230, 0
    v_mov_b32 v231, 0
    v_mov_b32 v232, 0
    v_mov_b32 v233, 0
    v_mov_b32 v234, 0
    v_mov_b32 v235, 0
    v_mov_b32 v236, 0
    v_mov_b32 v237, 0
    v_mov_b32 v238, 0
    v_mov_b32 v239, 0
    v_mov_b32 v240, 0
    v_mov_b32 v241, 0
    v_mov_b32 v242, 0
    v_mov_b32 v243, 0
    v_mov_b32 v244, 0
    v_mov_b32 v245, 0
    v_mov_b32 v246, 0
    v_mov_b32 v247, 0
    v_mov_b32 v248, 0
    v_mov_b32 v249, 0
    v_mov_b32 v250, 0
    v_mov_b32 v251, 0
    v_mov_b32 v252, 0
    v_mov_b32 v253, 0
    v_mov_b32 v254, 0
    v_mov_b32 v255, 0
    s_waitcnt vmcnt(63)
    s_barrier
    v_add_u32 v5, s45, v28
    s_nop 0
    s_add_u32 m0, s41, 43008
    s_nop 0
    buffer_load_dwordx4 v10, s[16:19], s30 offen lds
    ds_read_b128 v[32:35], v5 offset:0
    ds_read_b128 v[36:39], v5 offset:2048
    ds_read_b128 v[40:43], v5 offset:4096
    ds_read_b128 v[44:47], v5 offset:6144
    s_add_u32 m0, s41, 44032
    s_nop 0
    buffer_load_dwordx4 v11, s[16:19], s30 offen lds
    ds_read_b64_tr_b16 v[48:49], v7 offset:0
    ds_read_b64_tr_b16 v[50:51], v7 offset:1792
    ds_read_b64_tr_b16 v[52:53], v7 offset:7168
    ds_read_b64_tr_b16 v[54:55], v7 offset:8960
    s_add_u32 m0, s41, 45056
    s_nop 0
    buffer_load_dwordx4 v12, s[16:19], s30 offen lds
    ds_read_b64_tr_b16 v[56:57], v7 offset:32
    ds_read_b64_tr_b16 v[58:59], v7 offset:1824
    ds_read_b64_tr_b16 v[60:61], v7 offset:7200
    ds_read_b64_tr_b16 v[62:63], v7 offset:8992
    s_add_u32 m0, s41, 46080
    s_nop 0
    buffer_load_dwordx4 v13, s[16:19], s30 offen lds
    ds_read_b64_tr_b16 v[64:65], v7 offset:64
    ds_read_b64_tr_b16 v[66:67], v7 offset:1856
    ds_read_b64_tr_b16 v[68:69], v7 offset:7232
    ds_read_b64_tr_b16 v[70:71], v7 offset:9024
    s_mov_b32 m0, 155648
    s_add_u32 s32, s69, 0
    buffer_load_dwordx4 v30, s[12:15], s32 offen lds
    ds_read_b64_tr_b16 v[72:73], v7 offset:96
    ds_read_b64_tr_b16 v[74:75], v7 offset:1888
    ds_read_b64_tr_b16 v[76:77], v7 offset:7264
    ds_read_b64_tr_b16 v[78:79], v7 offset:9056
    s_waitcnt vmcnt(5) lgkmcnt(0)
    s_barrier
    v_add_u32 v6, s45, v29
    s_add_u32 s45, s45, 32768
    s_cmp_eq_u32 s45, 98304
    s_cselect_b32 s45, 0, s45
    s_nop 0
    s_add_u32 m0, s41, 47104
    s_nop 0
    buffer_load_dwordx4 v14, s[16:19], s30 offen lds
    v_mfma_f32_16x16x32_bf16 v[128:131], v[48:51], v[32:35], v[128:131]
    ds_read_b128 v[80:83], v6 offset:0
    v_mfma_f32_16x16x32_bf16 v[132:135], v[52:55], v[32:35], v[132:135]
    ds_read_b128 v[84:87], v6 offset:2048
    v_mfma_f32_16x16x32_bf16 v[136:139], v[56:59], v[32:35], v[136:139]
    v_mfma_f32_16x16x32_bf16 v[140:143], v[60:63], v[32:35], v[140:143]
    ds_read_b128 v[88:91], v6 offset:4096
    v_mfma_f32_16x16x32_bf16 v[144:147], v[64:67], v[32:35], v[144:147]
    ds_read_b128 v[92:95], v6 offset:6144
    v_mfma_f32_16x16x32_bf16 v[148:151], v[68:71], v[32:35], v[148:151]
    ds_read_b64_tr_b16 v[96:97], v7 offset:14336
    v_mfma_f32_16x16x32_bf16 v[152:155], v[72:75], v[32:35], v[152:155]
    v_mfma_f32_16x16x32_bf16 v[156:159], v[76:79], v[32:35], v[156:159]
    s_add_u32 m0, s41, 48128
    s_nop 0
    buffer_load_dwordx4 v15, s[16:19], s30 offen lds
    v_mfma_f32_16x16x32_bf16 v[160:163], v[48:51], v[36:39], v[160:163]
    ds_read_b64_tr_b16 v[98:99], v7 offset:16128
    v_mfma_f32_16x16x32_bf16 v[164:167], v[52:55], v[36:39], v[164:167]
    ds_read_b64_tr_b16 v[100:101], v7 offset:21504
    v_mfma_f32_16x16x32_bf16 v[168:171], v[56:59], v[36:39], v[168:171]
    v_mfma_f32_16x16x32_bf16 v[172:175], v[60:63], v[36:39], v[172:175]
    ds_read_b64_tr_b16 v[102:103], v7 offset:23296
    v_mfma_f32_16x16x32_bf16 v[176:179], v[64:67], v[36:39], v[176:179]
    ds_read_b64_tr_b16 v[104:105], v7 offset:14368
    v_mfma_f32_16x16x32_bf16 v[180:183], v[68:71], v[36:39], v[180:183]
    ds_read_b64_tr_b16 v[106:107], v7 offset:16160
    v_mfma_f32_16x16x32_bf16 v[184:187], v[72:75], v[36:39], v[184:187]
    v_mfma_f32_16x16x32_bf16 v[188:191], v[76:79], v[36:39], v[188:191]
    s_add_u32 m0, s41, 49152
    s_nop 0
    buffer_load_dwordx4 v16, s[16:19], s30 offen lds
    s_add_u32 s30, s30, 458752
    v_mfma_f32_16x16x32_bf16 v[192:195], v[48:51], v[40:43], v[192:195]
    ds_read_b64_tr_b16 v[108:109], v7 offset:21536
    v_mfma_f32_16x16x32_bf16 v[196:199], v[52:55], v[40:43], v[196:199]
    ds_read_b64_tr_b16 v[110:111], v7 offset:23328
    v_mfma_f32_16x16x32_bf16 v[200:203], v[56:59], v[40:43], v[200:203]
    v_mfma_f32_16x16x32_bf16 v[204:207], v[60:63], v[40:43], v[204:207]
    ds_read_b64_tr_b16 v[112:113], v7 offset:14400
    v_mfma_f32_16x16x32_bf16 v[208:211], v[64:67], v[40:43], v[208:211]
    ds_read_b64_tr_b16 v[114:115], v7 offset:16192
    v_mfma_f32_16x16x32_bf16 v[212:215], v[68:71], v[40:43], v[212:215]
    ds_read_b64_tr_b16 v[116:117], v7 offset:21568
    v_mfma_f32_16x16x32_bf16 v[216:219], v[72:75], v[40:43], v[216:219]
    v_mfma_f32_16x16x32_bf16 v[220:223], v[76:79], v[40:43], v[220:223]
    s_mov_b32 m0, 155648
    s_add_u32 s32, s68, 0
    buffer_load_dwordx4 v30, s[64:67], s32 offen lds
    v_mfma_f32_16x16x32_bf16 v[224:227], v[48:51], v[44:47], v[224:227]
    ds_read_b64_tr_b16 v[118:119], v7 offset:23360
    v_mfma_f32_16x16x32_bf16 v[228:231], v[52:55], v[44:47], v[228:231]
    ds_read_b64_tr_b16 v[120:121], v7 offset:14432
    v_mfma_f32_16x16x32_bf16 v[232:235], v[56:59], v[44:47], v[232:235]
    v_mfma_f32_16x16x32_bf16 v[236:239], v[60:63], v[44:47], v[236:239]
    ds_read_b64_tr_b16 v[122:123], v7 offset:16224
    v_mfma_f32_16x16x32_bf16 v[240:243], v[64:67], v[44:47], v[240:243]
    ds_read_b64_tr_b16 v[124:125], v7 offset:21600
    v_mfma_f32_16x16x32_bf16 v[244:247], v[68:71], v[44:47], v[244:247]
    ds_read_b64_tr_b16 v[126:127], v7 offset:23392
    v_mfma_f32_16x16x32_bf16 v[248:251], v[72:75], v[44:47], v[248:251]
    v_mfma_f32_16x16x32_bf16 v[252:255], v[76:79], v[44:47], v[252:255]
    s_waitcnt vmcnt(63) lgkmcnt(0)
    s_barrier
    v_add_u32 v5, s45, v28
    s_nop 0
    s_add_u32 m0, s41, 14336
    s_nop 0
    buffer_load_dwordx4 v10, s[16:19], s30 offen lds
    v_mfma_f32_16x16x32_bf16 v[128:131], v[96:99], v[80:83], v[128:131]
    ds_read_b128 v[32:35], v5 offset:0
    v_mfma_f32_16x16x32_bf16 v[132:135], v[100:103], v[80:83], v[132:135]
    ds_read_b128 v[36:39], v5 offset:2048
    v_mfma_f32_16x16x32_bf16 v[136:139], v[104:107], v[80:83], v[136:139]
    ds_read_b128 v[40:43], v5 offset:4096
    v_mfma_f32_16x16x32_bf16 v[140:143], v[108:111], v[80:83], v[140:143]
    v_mfma_f32_16x16x32_bf16 v[144:147], v[112:115], v[80:83], v[144:147]
    ds_read_b128 v[44:47], v5 offset:6144
    v_mfma_f32_16x16x32_bf16 v[148:151], v[116:119], v[80:83], v[148:151]
    s_add_u32 m0, s41, 15360
    s_nop 0
    buffer_load_dwordx4 v11, s[16:19], s30 offen lds
    v_mfma_f32_16x16x32_bf16 v[152:155], v[120:123], v[80:83], v[152:155]
    ds_read_b64_tr_b16 v[48:49], v7 offset:28672
    v_mfma_f32_16x16x32_bf16 v[156:159], v[124:127], v[80:83], v[156:159]
    ds_read_b64_tr_b16 v[50:51], v7 offset:30464
    v_mfma_f32_16x16x32_bf16 v[160:163], v[96:99], v[84:87], v[160:163]
    v_mfma_f32_16x16x32_bf16 v[164:167], v[100:103], v[84:87], v[164:167]
    ds_read_b64_tr_b16 v[52:53], v7 offset:35840
    v_mfma_f32_16x16x32_bf16 v[168:171], v[104:107], v[84:87], v[168:171]
    ds_read_b64_tr_b16 v[54:55], v7 offset:37632
    v_mfma_f32_16x16x32_bf16 v[172:175], v[108:111], v[84:87], v[172:175]
    s_add_u32 m0, s41, 16384
    s_nop 0
    buffer_load_dwordx4 v12, s[16:19], s30 offen lds
    v_mfma_f32_16x16x32_bf16 v[176:179], v[112:115], v[84:87], v[176:179]
    v_mfma_f32_16x16x32_bf16 v[180:183], v[116:119], v[84:87], v[180:183]
    ds_read_b64_tr_b16 v[56:57], v7 offset:28704
    v_mfma_f32_16x16x32_bf16 v[184:187], v[120:123], v[84:87], v[184:187]
    ds_read_b64_tr_b16 v[58:59], v7 offset:30496
    v_mfma_f32_16x16x32_bf16 v[188:191], v[124:127], v[84:87], v[188:191]
    ds_read_b64_tr_b16 v[60:61], v7 offset:35872
    v_mfma_f32_16x16x32_bf16 v[192:195], v[96:99], v[88:91], v[192:195]
    ds_read_b64_tr_b16 v[62:63], v7 offset:37664
    v_mfma_f32_16x16x32_bf16 v[196:199], v[100:103], v[88:91], v[196:199]
    v_mfma_f32_16x16x32_bf16 v[200:203], v[104:107], v[88:91], v[200:203]
    s_add_u32 m0, s41, 17408
    s_nop 0
    buffer_load_dwordx4 v13, s[16:19], s30 offen lds
    v_mfma_f32_16x16x32_bf16 v[204:207], v[108:111], v[88:91], v[204:207]
    ds_read_b64_tr_b16 v[64:65], v7 offset:28736
    v_mfma_f32_16x16x32_bf16 v[208:211], v[112:115], v[88:91], v[208:211]
    ds_read_b64_tr_b16 v[66:67], v7 offset:30528
    v_mfma_f32_16x16x32_bf16 v[212:215], v[116:119], v[88:91], v[212:215]
    v_mfma_f32_16x16x32_bf16 v[216:219], v[120:123], v[88:91], v[216:219]
    ds_read_b64_tr_b16 v[68:69], v7 offset:35904
    v_mfma_f32_16x16x32_bf16 v[220:223], v[124:127], v[88:91], v[220:223]
    ds_read_b64_tr_b16 v[70:71], v7 offset:37696
    v_mfma_f32_16x16x32_bf16 v[224:227], v[96:99], v[92:95], v[224:227]
    s_mov_b32 m0, 155648
    s_add_u32 s32, s68, 1048576
    buffer_load_dwordx4 v30, s[64:67], s32 offen lds
    v_mfma_f32_16x16x32_bf16 v[228:231], v[100:103], v[92:95], v[228:231]
    ds_read_b64_tr_b16 v[72:73], v7 offset:28768
    v_mfma_f32_16x16x32_bf16 v[232:235], v[104:107], v[92:95], v[232:235]
    v_mfma_f32_16x16x32_bf16 v[236:239], v[108:111], v[92:95], v[236:239]
    ds_read_b64_tr_b16 v[74:75], v7 offset:30560
    v_mfma_f32_16x16x32_bf16 v[240:243], v[112:115], v[92:95], v[240:243]
    ds_read_b64_tr_b16 v[76:77], v7 offset:35936
    v_mfma_f32_16x16x32_bf16 v[244:247], v[116:119], v[92:95], v[244:247]
    ds_read_b64_tr_b16 v[78:79], v7 offset:37728
    v_mfma_f32_16x16x32_bf16 v[248:251], v[120:123], v[92:95], v[248:251]
    v_mfma_f32_16x16x32_bf16 v[252:255], v[124:127], v[92:95], v[252:255]
    s_waitcnt vmcnt(6) lgkmcnt(0)
    s_barrier
    v_add_u32 v6, s45, v29
    s_add_u32 s45, s45, 32768
    s_cmp_eq_u32 s45, 98304
    s_cselect_b32 s45, 0, s45
    s_nop 0
    s_add_u32 m0, s41, 18432
    s_nop 0
    buffer_load_dwordx4 v14, s[16:19], s30 offen lds
    v_mfma_f32_16x16x32_bf16 v[128:131], v[48:51], v[32:35], v[128:131]
    ds_read_b128 v[80:83], v6 offset:0
    v_mfma_f32_16x16x32_bf16 v[132:135], v[52:55], v[32:35], v[132:135]
    ds_read_b128 v[84:87], v6 offset:2048
    v_mfma_f32_16x16x32_bf16 v[136:139], v[56:59], v[32:35], v[136:139]
    v_mfma_f32_16x16x32_bf16 v[140:143], v[60:63], v[32:35], v[140:143]
    ds_read_b128 v[88:91], v6 offset:4096
    v_mfma_f32_16x16x32_bf16 v[144:147], v[64:67], v[32:35], v[144:147]
    ds_read_b128 v[92:95], v6 offset:6144
    v_mfma_f32_16x16x32_bf16 v[148:151], v[68:71], v[32:35], v[148:151]
    ds_read_b64_tr_b16 v[96:97], v7 offset:43008
    v_mfma_f32_16x16x32_bf16 v[152:155], v[72:75], v[32:35], v[152:155]
    v_mfma_f32_16x16x32_bf16 v[156:159], v[76:79], v[32:35], v[156:159]
    s_add_u32 m0, s41, 19456
    s_nop 0
    buffer_load_dwordx4 v15, s[16:19], s30 offen lds
    v_mfma_f32_16x16x32_bf16 v[160:163], v[48:51], v[36:39], v[160:163]
    ds_read_b64_tr_b16 v[98:99], v7 offset:44800
    v_mfma_f32_16x16x32_bf16 v[164:167], v[52:55], v[36:39], v[164:167]
    ds_read_b64_tr_b16 v[100:101], v7 offset:50176
    v_mfma_f32_16x16x32_bf16 v[168:171], v[56:59], v[36:39], v[168:171]
    v_mfma_f32_16x16x32_bf16 v[172:175], v[60:63], v[36:39], v[172:175]
    ds_read_b64_tr_b16 v[102:103], v7 offset:51968
    v_mfma_f32_16x16x32_bf16 v[176:179], v[64:67], v[36:39], v[176:179]
    ds_read_b64_tr_b16 v[104:105], v7 offset:43040
    v_mfma_f32_16x16x32_bf16 v[180:183], v[68:71], v[36:39], v[180:183]
    ds_read_b64_tr_b16 v[106:107], v7 offset:44832
    v_mfma_f32_16x16x32_bf16 v[184:187], v[72:75], v[36:39], v[184:187]
    v_mfma_f32_16x16x32_bf16 v[188:191], v[76:79], v[36:39], v[188:191]
    s_add_u32 m0, s41, 20480
    s_nop 0
    buffer_load_dwordx4 v16, s[16:19], s30 offen lds
    s_add_u32 s30, s30, 458752
    v_mfma_f32_16x16x32_bf16 v[192:195], v[48:51], v[40:43], v[192:195]
    ds_read_b64_tr_b16 v[108:109], v7 offset:50208
    v_mfma_f32_16x16x32_bf16 v[196:199], v[52:55], v[40:43], v[196:199]
    ds_read_b64_tr_b16 v[110:111], v7 offset:52000
    v_mfma_f32_16x16x32_bf16 v[200:203], v[56:59], v[40:43], v[200:203]
    v_mfma_f32_16x16x32_bf16 v[204:207], v[60:63], v[40:43], v[204:207]
    ds_read_b64_tr_b16 v[112:113], v7 offset:43072
    v_mfma_f32_16x16x32_bf16 v[208:211], v[64:67], v[40:43], v[208:211]
    ds_read_b64_tr_b16 v[114:115], v7 offset:44864
    v_mfma_f32_16x16x32_bf16 v[212:215], v[68:71], v[40:43], v[212:215]
    ds_read_b64_tr_b16 v[116:117], v7 offset:50240
    v_mfma_f32_16x16x32_bf16 v[216:219], v[72:75], v[40:43], v[216:219]
    v_mfma_f32_16x16x32_bf16 v[220:223], v[76:79], v[40:43], v[220:223]
    s_mov_b32 m0, 155648
    s_add_u32 s32, s68, 2097152
    buffer_load_dwordx4 v30, s[64:67], s32 offen lds
    v_mfma_f32_16x16x32_bf16 v[224:227], v[48:51], v[44:47], v[224:227]
    ds_read_b64_tr_b16 v[118:119], v7 offset:52032
    v_mfma_f32_16x16x32_bf16 v[228:231], v[52:55], v[44:47], v[228:231]
    ds_read_b64_tr_b16 v[120:121], v7 offset:43104
    v_mfma_f32_16x16x32_bf16 v[232:235], v[56:59], v[44:47], v[232:235]
    v_mfma_f32_16x16x32_bf16 v[236:239], v[60:63], v[44:47], v[236:239]
    ds_read_b64_tr_b16 v[122:123], v7 offset:44896
    v_mfma_f32_16x16x32_bf16 v[240:243], v[64:67], v[44:47], v[240:243]
    ds_read_b64_tr_b16 v[124:125], v7 offset:50272
    v_mfma_f32_16x16x32_bf16 v[244:247], v[68:71], v[44:47], v[244:247]
    ds_read_b64_tr_b16 v[126:127], v7 offset:52064
    v_mfma_f32_16x16x32_bf16 v[248:251], v[72:75], v[44:47], v[248:251]
    v_mfma_f32_16x16x32_bf16 v[252:255], v[76:79], v[44:47], v[252:255]
    s_waitcnt vmcnt(63) lgkmcnt(0)
    s_barrier
    v_add_u32 v5, s45, v28
    s_nop 0
    s_add_u32 m0, s41, 43008
    s_nop 0
    buffer_load_dwordx4 v10, s[16:19], s30 offen lds
    v_mfma_f32_16x16x32_bf16 v[128:131], v[96:99], v[80:83], v[128:131]
    ds_read_b128 v[32:35], v5 offset:0
    v_mfma_f32_16x16x32_bf16 v[132:135], v[100:103], v[80:83], v[132:135]
    ds_read_b128 v[36:39], v5 offset:2048
    v_mfma_f32_16x16x32_bf16 v[136:139], v[104:107], v[80:83], v[136:139]
    ds_read_b128 v[40:43], v5 offset:4096
    v_mfma_f32_16x16x32_bf16 v[140:143], v[108:111], v[80:83], v[140:143]
    v_mfma_f32_16x16x32_bf16 v[144:147], v[112:115], v[80:83], v[144:147]
    ds_read_b128 v[44:47], v5 offset:6144
    v_mfma_f32_16x16x32_bf16 v[148:151], v[116:119], v[80:83], v[148:151]
    s_add_u32 m0, s41, 44032
    s_nop 0
    buffer_load_dwordx4 v11, s[16:19], s30 offen lds
    v_mfma_f32_16x16x32_bf16 v[152:155], v[120:123], v[80:83], v[152:155]
    ds_read_b64_tr_b16 v[48:49], v7 offset:0
    v_mfma_f32_16x16x32_bf16 v[156:159], v[124:127], v[80:83], v[156:159]
    ds_read_b64_tr_b16 v[50:51], v7 offset:1792
    v_mfma_f32_16x16x32_bf16 v[160:163], v[96:99], v[84:87], v[160:163]
    v_mfma_f32_16x16x32_bf16 v[164:167], v[100:103], v[84:87], v[164:167]
    ds_read_b64_tr_b16 v[52:53], v7 offset:7168
    v_mfma_f32_16x16x32_bf16 v[168:171], v[104:107], v[84:87], v[168:171]
    ds_read_b64_tr_b16 v[54:55], v7 offset:8960
    v_mfma_f32_16x16x32_bf16 v[172:175], v[108:111], v[84:87], v[172:175]
    s_add_u32 m0, s41, 45056
    s_nop 0
    buffer_load_dwordx4 v12, s[16:19], s30 offen lds
    v_mfma_f32_16x16x32_bf16 v[176:179], v[112:115], v[84:87], v[176:179]
    v_mfma_f32_16x16x32_bf16 v[180:183], v[116:119], v[84:87], v[180:183]
    ds_read_b64_tr_b16 v[56:57], v7 offset:32
    v_mfma_f32_16x16x32_bf16 v[184:187], v[120:123], v[84:87], v[184:187]
    ds_read_b64_tr_b16 v[58:59], v7 offset:1824
    v_mfma_f32_16x16x32_bf16 v[188:191], v[124:127], v[84:87], v[188:191]
    ds_read_b64_tr_b16 v[60:61], v7 offset:7200
    v_mfma_f32_16x16x32_bf16 v[192:195], v[96:99], v[88:91], v[192:195]
    ds_read_b64_tr_b16 v[62:63], v7 offset:8992
    v_mfma_f32_16x16x32_bf16 v[196:199], v[100:103], v[88:91], v[196:199]
    v_mfma_f32_16x16x32_bf16 v[200:203], v[104:107], v[88:91], v[200:203]
    s_add_u32 m0, s41, 46080
    s_nop 0
    buffer_load_dwordx4 v13, s[16:19], s30 offen lds
    v_mfma_f32_16x16x32_bf16 v[204:207], v[108:111], v[88:91], v[204:207]
    ds_read_b64_tr_b16 v[64:65], v7 offset:64
    v_mfma_f32_16x16x32_bf16 v[208:211], v[112:115], v[88:91], v[208:211]
    ds_read_b64_tr_b16 v[66:67], v7 offset:1856
    v_mfma_f32_16x16x32_bf16 v[212:215], v[116:119], v[88:91], v[212:215]
    v_mfma_f32_16x16x32_bf16 v[216:219], v[120:123], v[88:91], v[216:219]
    ds_read_b64_tr_b16 v[68:69], v7 offset:7232
    v_mfma_f32_16x16x32_bf16 v[220:223], v[124:127], v[88:91], v[220:223]
    ds_read_b64_tr_b16 v[70:71], v7 offset:9024
    v_mfma_f32_16x16x32_bf16 v[224:227], v[96:99], v[92:95], v[224:227]
    s_mov_b32 m0, 155648
    s_add_u32 s32, s69, 1024
    buffer_load_dwordx4 v30, s[12:15], s32 offen lds
    v_mfma_f32_16x16x32_bf16 v[228:231], v[100:103], v[92:95], v[228:231]
    ds_read_b64_tr_b16 v[72:73], v7 offset:96
    v_mfma_f32_16x16x32_bf16 v[232:235], v[104:107], v[92:95], v[232:235]
    v_mfma_f32_16x16x32_bf16 v[236:239], v[108:111], v[92:95], v[236:239]
    ds_read_b64_tr_b16 v[74:75], v7 offset:1888
    v_mfma_f32_16x16x32_bf16 v[240:243], v[112:115], v[92:95], v[240:243]
    ds_read_b64_tr_b16 v[76:77], v7 offset:7264
    v_mfma_f32_16x16x32_bf16 v[244:247], v[116:119], v[92:95], v[244:247]
    ds_read_b64_tr_b16 v[78:79], v7 offset:9056
    v_mfma_f32_16x16x32_bf16 v[248:251], v[120:123], v[92:95], v[248:251]
    v_mfma_f32_16x16x32_bf16 v[252:255], v[124:127], v[92:95], v[252:255]
    s_waitcnt vmcnt(6) lgkmcnt(0)
    s_barrier
    v_add_u32 v6, s45, v29
    s_add_u32 s45, s45, 32768
    s_cmp_eq_u32 s45, 98304
    s_cselect_b32 s45, 0, s45
    s_nop 0
    s_add_u32 m0, s41, 47104
    s_nop 0
    buffer_load_dwordx4 v14, s[16:19], s30 offen lds
    v_mfma_f32_16x16x32_bf16 v[128:131], v[48:51], v[32:35], v[128:131]
    ds_read_b128 v[80:83], v6 offset:0
    v_mfma_f32_16x16x32_bf16 v[132:135], v[52:55], v[32:35], v[132:135]
    ds_read_b128 v[84:87], v6 offset:2048
    v_mfma_f32_16x16x32_bf16 v[136:139], v[56:59], v[32:35], v[136:139]
    v_mfma_f32_16x16x32_bf16 v[140:143], v[60:63], v[32:35], v[140:143]
    ds_read_b128 v[88:91], v6 offset:4096
    v_mfma_f32_16x16x32_bf16 v[144:147], v[64:67], v[32:35], v[144:147]
    ds_read_b128 v[92:95], v6 offset:6144
    v_mfma_f32_16x16x32_bf16 v[148:151], v[68:71], v[32:35], v[148:151]
    ds_read_b64_tr_b16 v[96:97], v7 offset:14336
    v_mfma_f32_16x16x32_bf16 v[152:155], v[72:75], v[32:35], v[152:155]
    v_mfma_f32_16x16x32_bf16 v[156:159], v[76:79], v[32:35], v[156:159]
    s_add_u32 m0, s41, 48128
    s_nop 0
    buffer_load_dwordx4 v15, s[16:19], s30 offen lds
    v_mfma_f32_16x16x32_bf16 v[160:163], v[48:51], v[36:39], v[160:163]
    ds_read_b64_tr_b16 v[98:99], v7 offset:16128
    v_mfma_f32_16x16x32_bf16 v[164:167], v[52:55], v[36:39], v[164:167]
    ds_read_b64_tr_b16 v[100:101], v7 offset:21504
    v_mfma_f32_16x16x32_bf16 v[168:171], v[56:59], v[36:39], v[168:171]
    v_mfma_f32_16x16x32_bf16 v[172:175], v[60:63], v[36:39], v[172:175]
    ds_read_b64_tr_b16 v[102:103], v7 offset:23296
    v_mfma_f32_16x16x32_bf16 v[176:179], v[64:67], v[36:39], v[176:179]
    ds_read_b64_tr_b16 v[104:105], v7 offset:14368
    v_mfma_f32_16x16x32_bf16 v[180:183], v[68:71], v[36:39], v[180:183]
    ds_read_b64_tr_b16 v[106:107], v7 offset:16160
    v_mfma_f32_16x16x32_bf16 v[184:187], v[72:75], v[36:39], v[184:187]
    v_mfma_f32_16x16x32_bf16 v[188:191], v[76:79], v[36:39], v[188:191]
    s_add_u32 m0, s41, 49152
    s_nop 0
    buffer_load_dwordx4 v16, s[16:19], s30 offen lds
    s_add_u32 s30, s30, 458752
    v_mfma_f32_16x16x32_bf16 v[192:195], v[48:51], v[40:43], v[192:195]
    ds_read_b64_tr_b16 v[108:109], v7 offset:21536
    v_mfma_f32_16x16x32_bf16 v[196:199], v[52:55], v[40:43], v[196:199]
    ds_read_b64_tr_b16 v[110:111], v7 offset:23328
    v_mfma_f32_16x16x32_bf16 v[200:203], v[56:59], v[40:43], v[200:203]
    v_mfma_f32_16x16x32_bf16 v[204:207], v[60:63], v[40:43], v[204:207]
    ds_read_b64_tr_b16 v[112:113], v7 offset:14400
    v_mfma_f32_16x16x32_bf16 v[208:211], v[64:67], v[40:43], v[208:211]
    ds_read_b64_tr_b16 v[114:115], v7 offset:16192
    v_mfma_f32_16x16x32_bf16 v[212:215], v[68:71], v[40:43], v[212:215]
    ds_read_b64_tr_b16 v[116:117], v7 offset:21568
    v_mfma_f32_16x16x32_bf16 v[216:219], v[72:75], v[40:43], v[216:219]
    v_mfma_f32_16x16x32_bf16 v[220:223], v[76:79], v[40:43], v[220:223]
    s_mov_b32 m0, 155648
    s_add_u32 s32, s68, 3145728
    buffer_load_dwordx4 v30, s[64:67], s32 offen lds
    v_mfma_f32_16x16x32_bf16 v[224:227], v[48:51], v[44:47], v[224:227]
    ds_read_b64_tr_b16 v[118:119], v7 offset:23360
    v_mfma_f32_16x16x32_bf16 v[228:231], v[52:55], v[44:47], v[228:231]
    ds_read_b64_tr_b16 v[120:121], v7 offset:14432
    v_mfma_f32_16x16x32_bf16 v[232:235], v[56:59], v[44:47], v[232:235]
    v_mfma_f32_16x16x32_bf16 v[236:239], v[60:63], v[44:47], v[236:239]
    ds_read_b64_tr_b16 v[122:123], v7 offset:16224
    v_mfma_f32_16x16x32_bf16 v[240:243], v[64:67], v[44:47], v[240:243]
    ds_read_b64_tr_b16 v[124:125], v7 offset:21600
    v_mfma_f32_16x16x32_bf16 v[244:247], v[68:71], v[44:47], v[244:247]
    ds_read_b64_tr_b16 v[126:127], v7 offset:23392
    v_mfma_f32_16x16x32_bf16 v[248:251], v[72:75], v[44:47], v[248:251]
    v_mfma_f32_16x16x32_bf16 v[252:255], v[76:79], v[44:47], v[252:255]
    s_waitcnt vmcnt(63) lgkmcnt(0)
    s_barrier
    v_add_u32 v5, s45, v28
    s_nop 0
    s_add_u32 m0, s41, 14336
    s_nop 0
    buffer_load_dwordx4 v10, s[16:19], s30 offen lds
    v_mfma_f32_16x16x32_bf16 v[128:131], v[96:99], v[80:83], v[128:131]
    ds_read_b128 v[32:35], v5 offset:0
    v_mfma_f32_16x16x32_bf16 v[132:135], v[100:103], v[80:83], v[132:135]
    ds_read_b128 v[36:39], v5 offset:2048
    v_mfma_f32_16x16x32_bf16 v[136:139], v[104:107], v[80:83], v[136:139]
    ds_read_b128 v[40:43], v5 offset:4096
    v_mfma_f32_16x16x32_bf16 v[140:143], v[108:111], v[80:83], v[140:143]
    v_mfma_f32_16x16x32_bf16 v[144:147], v[112:115], v[80:83], v[144:147]
    ds_read_b128 v[44:47], v5 offset:6144
    v_mfma_f32_16x16x32_bf16 v[148:151], v[116:119], v[80:83], v[148:151]
    s_add_u32 m0, s41, 15360
    s_nop 0
    buffer_load_dwordx4 v11, s[16:19], s30 offen lds
    v_mfma_f32_16x16x32_bf16 v[152:155], v[120:123], v[80:83], v[152:155]
    ds_read_b64_tr_b16 v[48:49], v7 offset:28672
    v_mfma_f32_16x16x32_bf16 v[156:159], v[124:127], v[80:83], v[156:159]
    ds_read_b64_tr_b16 v[50:51], v7 offset:30464
    v_mfma_f32_16x16x32_bf16 v[160:163], v[96:99], v[84:87], v[160:163]
    v_mfma_f32_16x16x32_bf16 v[164:167], v[100:103], v[84:87], v[164:167]
    ds_read_b64_tr_b16 v[52:53], v7 offset:35840
    v_mfma_f32_16x16x32_bf16 v[168:171], v[104:107], v[84:87], v[168:171]
    ds_read_b64_tr_b16 v[54:55], v7 offset:37632
    v_mfma_f32_16x16x32_bf16 v[172:175], v[108:111], v[84:87], v[172:175]
    s_add_u32 m0, s41, 16384
    s_nop 0
    buffer_load_dwordx4 v12, s[16:19], s30 offen lds
    v_mfma_f32_16x16x32_bf16 v[176:179], v[112:115], v[84:87], v[176:179]
    v_mfma_f32_16x16x32_bf16 v[180:183], v[116:119], v[84:87], v[180:183]
    ds_read_b64_tr_b16 v[56:57], v7 offset:28704
    v_mfma_f32_16x16x32_bf16 v[184:187], v[120:123], v[84:87], v[184:187]
    ds_read_b64_tr_b16 v[58:59], v7 offset:30496
    v_mfma_f32_16x16x32_bf16 v[188:191], v[124:127], v[84:87], v[188:191]
    ds_read_b64_tr_b16 v[60:61], v7 offset:35872
    v_mfma_f32_16x16x32_bf16 v[192:195], v[96:99], v[88:91], v[192:195]
    ds_read_b64_tr_b16 v[62:63], v7 offset:37664
    v_mfma_f32_16x16x32_bf16 v[196:199], v[100:103], v[88:91], v[196:199]
    v_mfma_f32_16x16x32_bf16 v[200:203], v[104:107], v[88:91], v[200:203]
    s_add_u32 m0, s41, 17408
    s_nop 0
    buffer_load_dwordx4 v13, s[16:19], s30 offen lds
    v_mfma_f32_16x16x32_bf16 v[204:207], v[108:111], v[88:91], v[204:207]
    ds_read_b64_tr_b16 v[64:65], v7 offset:28736
    v_mfma_f32_16x16x32_bf16 v[208:211], v[112:115], v[88:91], v[208:211]
    ds_read_b64_tr_b16 v[66:67], v7 offset:30528
    v_mfma_f32_16x16x32_bf16 v[212:215], v[116:119], v[88:91], v[212:215]
    v_mfma_f32_16x16x32_bf16 v[216:219], v[120:123], v[88:91], v[216:219]
    ds_read_b64_tr_b16 v[68:69], v7 offset:35904
    v_mfma_f32_16x16x32_bf16 v[220:223], v[124:127], v[88:91], v[220:223]
    ds_read_b64_tr_b16 v[70:71], v7 offset:37696
    v_mfma_f32_16x16x32_bf16 v[224:227], v[96:99], v[92:95], v[224:227]
    s_mov_b32 m0, 155648
    s_add_u32 s32, s68, 4194304
    buffer_load_dwordx4 v30, s[64:67], s32 offen lds
    v_mfma_f32_16x16x32_bf16 v[228:231], v[100:103], v[92:95], v[228:231]
    ds_read_b64_tr_b16 v[72:73], v7 offset:28768
    v_mfma_f32_16x16x32_bf16 v[232:235], v[104:107], v[92:95], v[232:235]
    v_mfma_f32_16x16x32_bf16 v[236:239], v[108:111], v[92:95], v[236:239]
    ds_read_b64_tr_b16 v[74:75], v7 offset:30560
    v_mfma_f32_16x16x32_bf16 v[240:243], v[112:115], v[92:95], v[240:243]
    ds_read_b64_tr_b16 v[76:77], v7 offset:35936
    v_mfma_f32_16x16x32_bf16 v[244:247], v[116:119], v[92:95], v[244:247]
    ds_read_b64_tr_b16 v[78:79], v7 offset:37728
    v_mfma_f32_16x16x32_bf16 v[248:251], v[120:123], v[92:95], v[248:251]
    v_mfma_f32_16x16x32_bf16 v[252:255], v[124:127], v[92:95], v[252:255]
    s_waitcnt vmcnt(6) lgkmcnt(0)
    s_barrier
    v_add_u32 v6, s45, v29
    s_add_u32 s45, s45, 32768
    s_cmp_eq_u32 s45, 98304
    s_cselect_b32 s45, 0, s45
    s_nop 0
    s_add_u32 m0, s41, 18432
    s_nop 0
    buffer_load_dwordx4 v14, s[16:19], s30 offen lds
    v_mfma_f32_16x16x32_bf16 v[128:131], v[48:51], v[32:35], v[128:131]
    ds_read_b128 v[80:83], v6 offset:0
    v_mfma_f32_16x16x32_bf16 v[132:135], v[52:55], v[32:35], v[132:135]
    ds_read_b128 v[84:87], v6 offset:2048
    v_mfma_f32_16x16x32_bf16 v[136:139], v[56:59], v[32:35], v[136:139]
    v_mfma_f32_16x16x32_bf16 v[140:143], v[60:63], v[32:35], v[140:143]
    ds_read_b128 v[88:91], v6 offset:4096
    v_mfma_f32_16x16x32_bf16 v[144:147], v[64:67], v[32:35], v[144:147]
    ds_read_b128 v[92:95], v6 offset:6144
    v_mfma_f32_16x16x32_bf16 v[148:151], v[68:71], v[32:35], v[148:151]
    ds_read_b64_tr_b16 v[96:97], v7 offset:43008
    v_mfma_f32_16x16x32_bf16 v[152:155], v[72:75], v[32:35], v[152:155]
    v_mfma_f32_16x16x32_bf16 v[156:159], v[76:79], v[32:35], v[156:159]
    s_add_u32 m0, s41, 19456
    s_nop 0
    buffer_load_dwordx4 v15, s[16:19], s30 offen lds
    v_mfma_f32_16x16x32_bf16 v[160:163], v[48:51], v[36:39], v[160:163]
    ds_read_b64_tr_b16 v[98:99], v7 offset:44800
    v_mfma_f32_16x16x32_bf16 v[164:167], v[52:55], v[36:39], v[164:167]
    ds_read_b64_tr_b16 v[100:101], v7 offset:50176
    v_mfma_f32_16x16x32_bf16 v[168:171], v[56:59], v[36:39], v[168:171]
    v_mfma_f32_16x16x32_bf16 v[172:175], v[60:63], v[36:39], v[172:175]
    ds_read_b64_tr_b16 v[102:103], v7 offset:51968
    v_mfma_f32_16x16x32_bf16 v[176:179], v[64:67], v[36:39], v[176:179]
    ds_read_b64_tr_b16 v[104:105], v7 offset:43040
    v_mfma_f32_16x16x32_bf16 v[180:183], v[68:71], v[36:39], v[180:183]
    ds_read_b64_tr_b16 v[106:107], v7 offset:44832
    v_mfma_f32_16x16x32_bf16 v[184:187], v[72:75], v[36:39], v[184:187]
    v_mfma_f32_16x16x32_bf16 v[188:191], v[76:79], v[36:39], v[188:191]
    s_add_u32 m0, s41, 20480
    s_nop 0
    buffer_load_dwordx4 v16, s[16:19], s30 offen lds
    s_add_u32 s30, s30, 458752
    v_mfma_f32_16x16x32_bf16 v[192:195], v[48:51], v[40:43], v[192:195]
    ds_read_b64_tr_b16 v[108:109], v7 offset:50208
    v_mfma_f32_16x16x32_bf16 v[196:199], v[52:55], v[40:43], v[196:199]
    ds_read_b64_tr_b16 v[110:111], v7 offset:52000
    v_mfma_f32_16x16x32_bf16 v[200:203], v[56:59], v[40:43], v[200:203]
    v_mfma_f32_16x16x32_bf16 v[204:207], v[60:63], v[40:43], v[204:207]
    ds_read_b64_tr_b16 v[112:113], v7 offset:43072
    v_mfma_f32_16x16x32_bf16 v[208:211], v[64:67], v[40:43], v[208:211]
    ds_read_b64_tr_b16 v[114:115], v7 offset:44864
    v_mfma_f32_16x16x32_bf16 v[212:215], v[68:71], v[40:43], v[212:215]
    ds_read_b64_tr_b16 v[116:117], v7 offset:50240
    v_mfma_f32_16x16x32_bf16 v[216:219], v[72:75], v[40:43], v[216:219]
    v_mfma_f32_16x16x32_bf16 v[220:223], v[76:79], v[40:43], v[220:223]
    s_mov_b32 m0, 155648
    s_add_u32 s32, s68, 5242880
    buffer_load_dwordx4 v30, s[64:67], s32 offen lds
    v_mfma_f32_16x16x32_bf16 v[224:227], v[48:51], v[44:47], v[224:227]
    ds_read_b64_tr_b16 v[118:119], v7 offset:52032
    v_mfma_f32_16x16x32_bf16 v[228:231], v[52:55], v[44:47], v[228:231]
    ds_read_b64_tr_b16 v[120:121], v7 offset:43104
    v_mfma_f32_16x16x32_bf16 v[232:235], v[56:59], v[44:47], v[232:235]
    v_mfma_f32_16x16x32_bf16 v[236:239], v[60:63], v[44:47], v[236:239]
    ds_read_b64_tr_b16 v[122:123], v7 offset:44896
    v_mfma_f32_16x16x32_bf16 v[240:243], v[64:67], v[44:47], v[240:243]
    ds_read_b64_tr_b16 v[124:125], v7 offset:50272
    v_mfma_f32_16x16x32_bf16 v[244:247], v[68:71], v[44:47], v[244:247]
    ds_read_b64_tr_b16 v[126:127], v7 offset:52064
    v_mfma_f32_16x16x32_bf16 v[248:251], v[72:75], v[44:47], v[248:251]
    v_mfma_f32_16x16x32_bf16 v[252:255], v[76:79], v[44:47], v[252:255]
    s_waitcnt vmcnt(63) lgkmcnt(0)
    s_barrier
    v_add_u32 v5, s45, v28
    s_nop 0
    s_add_u32 m0, s41, 43008
    s_nop 0
    buffer_load_dwordx4 v10, s[16:19], s30 offen lds
    v_mfma_f32_16x16x32_bf16 v[128:131], v[96:99], v[80:83], v[128:131]
    ds_read_b128 v[32:35], v5 offset:0
    v_mfma_f32_16x16x32_bf16 v[132:135], v[100:103], v[80:83], v[132:135]
    ds_read_b128 v[36:39], v5 offset:2048
    v_mfma_f32_16x16x32_bf16 v[136:139], v[104:107], v[80:83], v[136:139]
    ds_read_b128 v[40:43], v5 offset:4096
    v_mfma_f32_16x16x32_bf16 v[140:143], v[108:111], v[80:83], v[140:143]
    v_mfma_f32_16x16x32_bf16 v[144:147], v[112:115], v[80:83], v[144:147]
    ds_read_b128 v[44:47], v5 offset:6144
    v_mfma_f32_16x16x32_bf16 v[148:151], v[116:119], v[80:83], v[148:151]
    s_add_u32 m0, s41, 44032
    s_nop 0
    buffer_load_dwordx4 v11, s[16:19], s30 offen lds
    v_mfma_f32_16x16x32_bf16 v[152:155], v[120:123], v[80:83], v[152:155]
    ds_read_b64_tr_b16 v[48:49], v7 offset:0
    v_mfma_f32_16x16x32_bf16 v[156:159], v[124:127], v[80:83], v[156:159]
    ds_read_b64_tr_b16 v[50:51], v7 offset:1792
    v_mfma_f32_16x16x32_bf16 v[160:163], v[96:99], v[84:87], v[160:163]
    v_mfma_f32_16x16x32_bf16 v[164:167], v[100:103], v[84:87], v[164:167]
    ds_read_b64_tr_b16 v[52:53], v7 offset:7168
    v_mfma_f32_16x16x32_bf16 v[168:171], v[104:107], v[84:87], v[168:171]
    ds_read_b64_tr_b16 v[54:55], v7 offset:8960
    v_mfma_f32_16x16x32_bf16 v[172:175], v[108:111], v[84:87], v[172:175]
    s_add_u32 m0, s41, 45056
    s_nop 0
    buffer_load_dwordx4 v12, s[16:19], s30 offen lds
    v_mfma_f32_16x16x32_bf16 v[176:179], v[112:115], v[84:87], v[176:179]
    v_mfma_f32_16x16x32_bf16 v[180:183], v[116:119], v[84:87], v[180:183]
    ds_read_b64_tr_b16 v[56:57], v7 offset:32
    v_mfma_f32_16x16x32_bf16 v[184:187], v[120:123], v[84:87], v[184:187]
    ds_read_b64_tr_b16 v[58:59], v7 offset:1824
    v_mfma_f32_16x16x32_bf16 v[188:191], v[124:127], v[84:87], v[188:191]
    ds_read_b64_tr_b16 v[60:61], v7 offset:7200
    v_mfma_f32_16x16x32_bf16 v[192:195], v[96:99], v[88:91], v[192:195]
    ds_read_b64_tr_b16 v[62:63], v7 offset:8992
    v_mfma_f32_16x16x32_bf16 v[196:199], v[100:103], v[88:91], v[196:199]
    v_mfma_f32_16x16x32_bf16 v[200:203], v[104:107], v[88:91], v[200:203]
    s_add_u32 m0, s41, 46080
    s_nop 0
    buffer_load_dwordx4 v13, s[16:19], s30 offen lds
    v_mfma_f32_16x16x32_bf16 v[204:207], v[108:111], v[88:91], v[204:207]
    ds_read_b64_tr_b16 v[64:65], v7 offset:64
    v_mfma_f32_16x16x32_bf16 v[208:211], v[112:115], v[88:91], v[208:211]
    ds_read_b64_tr_b16 v[66:67], v7 offset:1856
    v_mfma_f32_16x16x32_bf16 v[212:215], v[116:119], v[88:91], v[212:215]
    v_mfma_f32_16x16x32_bf16 v[216:219], v[120:123], v[88:91], v[216:219]
    ds_read_b64_tr_b16 v[68:69], v7 offset:7232
    v_mfma_f32_16x16x32_bf16 v[220:223], v[124:127], v[88:91], v[220:223]
    ds_read_b64_tr_b16 v[70:71], v7 offset:9024
    v_mfma_f32_16x16x32_bf16 v[224:227], v[96:99], v[92:95], v[224:227]
    s_mov_b32 m0, 155648
    s_add_u32 s32, s68, 6291456
    buffer_load_dwordx4 v30, s[64:67], s32 offen lds
    v_mfma_f32_16x16x32_bf16 v[228:231], v[100:103], v[92:95], v[228:231]
    ds_read_b64_tr_b16 v[72:73], v7 offset:96
    v_mfma_f32_16x16x32_bf16 v[232:235], v[104:107], v[92:95], v[232:235]
    v_mfma_f32_16x16x32_bf16 v[236:239], v[108:111], v[92:95], v[236:239]
    ds_read_b64_tr_b16 v[74:75], v7 offset:1888
    v_mfma_f32_16x16x32_bf16 v[240:243], v[112:115], v[92:95], v[240:243]
    ds_read_b64_tr_b16 v[76:77], v7 offset:7264
    v_mfma_f32_16x16x32_bf16 v[244:247], v[116:119], v[92:95], v[244:247]
    ds_read_b64_tr_b16 v[78:79], v7 offset:9056
    v_mfma_f32_16x16x32_bf16 v[248:251], v[120:123], v[92:95], v[248:251]
    v_mfma_f32_16x16x32_bf16 v[252:255], v[124:127], v[92:95], v[252:255]
    s_waitcnt vmcnt(6) lgkmcnt(0)
    s_barrier
    v_add_u32 v6, s45, v29
    s_add_u32 s45, s45, 32768
    s_cmp_eq_u32 s45, 98304
    s_cselect_b32 s45, 0, s45
    s_nop 0
    s_add_u32 m0, s41, 47104
    s_nop 0
    buffer_load_dwordx4 v14, s[16:19], s30 offen lds
    v_mfma_f32_16x16x32_bf16 v[128:131], v[48:51], v[32:35], v[128:131]
    ds_read_b128 v[80:83], v6 offset:0
    v_mfma_f32_16x16x32_bf16 v[132:135], v[52:55], v[32:35], v[132:135]
    ds_read_b128 v[84:87], v6 offset:2048
    v_mfma_f32_16x16x32_bf16 v[136:139], v[56:59], v[32:35], v[136:139]
    v_mfma_f32_16x16x32_bf16 v[140:143], v[60:63], v[32:35], v[140:143]
    ds_read_b128 v[88:91], v6 offset:4096
    v_mfma_f32_16x16x32_bf16 v[144:147], v[64:67], v[32:35], v[144:147]
    ds_read_b128 v[92:95], v6 offset:6144
    v_mfma_f32_16x16x32_bf16 v[148:151], v[68:71], v[32:35], v[148:151]
    ds_read_b64_tr_b16 v[96:97], v7 offset:14336
    v_mfma_f32_16x16x32_bf16 v[152:155], v[72:75], v[32:35], v[152:155]
    v_mfma_f32_16x16x32_bf16 v[156:159], v[76:79], v[32:35], v[156:159]
    ds_read_b64_tr_b16 v[98:99], v7 offset:16128
    v_mfma_f32_16x16x32_bf16 v[160:163], v[48:51], v[36:39], v[160:163]
    ds_read_b64_tr_b16 v[100:101], v7 offset:21504
    v_mfma_f32_16x16x32_bf16 v[164:167], v[52:55], v[36:39], v[164:167]
    v_mfma_f32_16x16x32_bf16 v[168:171], v[56:59], v[36:39], v[168:171]
    s_add_u32 m0, s41, 48128
    s_nop 0
    buffer_load_dwordx4 v15, s[16:19], s30 offen lds
    v_mfma_f32_16x16x32_bf16 v[172:175], v[60:63], v[36:39], v[172:175]
    ds_read_b64_tr_b16 v[102:103], v7 offset:23296
    v_mfma_f32_16x16x32_bf16 v[176:179], v[64:67], v[36:39], v[176:179]
    ds_read_b64_tr_b16 v[104:105], v7 offset:14368
    v_mfma_f32_16x16x32_bf16 v[180:183], v[68:71], v[36:39], v[180:183]
    v_mfma_f32_16x16x32_bf16 v[184:187], v[72:75], v[36:39], v[184:187]
    ds_read_b64_tr_b16 v[106:107], v7 offset:16160
    v_mfma_f32_16x16x32_bf16 v[188:191], v[76:79], v[36:39], v[188:191]
    ds_read_b64_tr_b16 v[108:109], v7 offset:21536
    v_mfma_f32_16x16x32_bf16 v[192:195], v[48:51], v[40:43], v[192:195]
    v_mfma_f32_16x16x32_bf16 v[196:199], v[52:55], v[40:43], v[196:199]
    ds_read_b64_tr_b16 v[110:111], v7 offset:23328
    v_mfma_f32_16x16x32_bf16 v[200:203], v[56:59], v[40:43], v[200:203]
    ds_read_b64_tr_b16 v[112:113], v7 offset:14400
    v_mfma_f32_16x16x32_bf16 v[204:207], v[60:63], v[40:43], v[204:207]
    ds_read_b64_tr_b16 v[114:115], v7 offset:16192
    v_mfma_f32_16x16x32_bf16 v[208:211], v[64:67], v[40:43], v[208:211]
    v_mfma_f32_16x16x32_bf16 v[212:215], v[68:71], v[40:43], v[212:215]
    s_add_u32 m0, s41, 49152
    s_nop 0
    buffer_load_dwordx4 v16, s[16:19], s30 offen lds
    s_add_u32 s30, s30, 458752
    v_mfma_f32_16x16x32_bf16 v[216:219], v[72:75], v[40:43], v[216:219]
    ds_read_b64_tr_b16 v[116:117], v7 offset:21568
    v_mfma_f32_16x16x32_bf16 v[220:223], v[76:79], v[40:43], v[220:223]
    v_mfma_f32_16x16x32_bf16 v[224:227], v[48:51], v[44:47], v[224:227]
    ds_read_b64_tr_b16 v[118:119], v7 offset:23360
    v_mfma_f32_16x16x32_bf16 v[228:231], v[52:55], v[44:47], v[228:231]
    ds_read_b64_tr_b16 v[120:121], v7 offset:14432
    v_mfma_f32_16x16x32_bf16 v[232:235], v[56:59], v[44:47], v[232:235]
    ds_read_b64_tr_b16 v[122:123], v7 offset:16224
    v_mfma_f32_16x16x32_bf16 v[236:239], v[60:63], v[44:47], v[236:239]
    v_mfma_f32_16x16x32_bf16 v[240:243], v[64:67], v[44:47], v[240:243]
    ds_read_b64_tr_b16 v[124:125], v7 offset:21600
    v_mfma_f32_16x16x32_bf16 v[244:247], v[68:71], v[44:47], v[244:247]
    ds_read_b64_tr_b16 v[126:127], v7 offset:23392
    v_mfma_f32_16x16x32_bf16 v[248:251], v[72:75], v[44:47], v[248:251]
    v_mfma_f32_16x16x32_bf16 v[252:255], v[76:79], v[44:47], v[252:255]
    s_waitcnt vmcnt(63) lgkmcnt(0)
    s_barrier
    v_add_u32 v5, s45, v28
    s_nop 0
    s_add_u32 m0, s41, 14336
    s_nop 0
    buffer_load_dwordx4 v10, s[16:19], s30 offen lds
    v_mfma_f32_16x16x32_bf16 v[128:131], v[96:99], v[80:83], v[128:131]
    ds_read_b128 v[32:35], v5 offset:0
    v_mfma_f32_16x16x32_bf16 v[132:135], v[100:103], v[80:83], v[132:135]
    ds_read_b128 v[36:39], v5 offset:2048
    v_mfma_f32_16x16x32_bf16 v[136:139], v[104:107], v[80:83], v[136:139]
    v_mfma_f32_16x16x32_bf16 v[140:143], v[108:111], v[80:83], v[140:143]
    ds_read_b128 v[40:43], v5 offset:4096
    v_mfma_f32_16x16x32_bf16 v[144:147], v[112:115], v[80:83], v[144:147]
    ds_read_b128 v[44:47], v5 offset:6144
    v_mfma_f32_16x16x32_bf16 v[148:151], v[116:119], v[80:83], v[148:151]
    ds_read_b64_tr_b16 v[48:49], v7 offset:28672
    v_mfma_f32_16x16x32_bf16 v[152:155], v[120:123], v[80:83], v[152:155]
    v_mfma_f32_16x16x32_bf16 v[156:159], v[124:127], v[80:83], v[156:159]
    s_add_u32 m0, s41, 15360
    s_nop 0
    buffer_load_dwordx4 v11, s[16:19], s30 offen lds
    v_mfma_f32_16x16x32_bf16 v[160:163], v[96:99], v[84:87], v[160:163]
    ds_read_b64_tr_b16 v[50:51], v7 offset:30464
    v_mfma_f32_16x16x32_bf16 v[164:167], v[100:103], v[84:87], v[164:167]
    ds_read_b64_tr_b16 v[52:53], v7 offset:35840
    v_mfma_f32_16x16x32_bf16 v[168:171], v[104:107], v[84:87], v[168:171]
    v_mfma_f32_16x16x32_bf16 v[172:175], v[108:111], v[84:87], v[172:175]
    ds_read_b64_tr_b16 v[54:55], v7 offset:37632
    v_mfma_f32_16x16x32_bf16 v[176:179], v[112:115], v[84:87], v[176:179]
    ds_read_b64_tr_b16 v[56:57], v7 offset:28704
    v_mfma_f32_16x16x32_bf16 v[180:183], v[116:119], v[84:87], v[180:183]
    ds_read_b64_tr_b16 v[58:59], v7 offset:30496
    v_mfma_f32_16x16x32_bf16 v[184:187], v[120:123], v[84:87], v[184:187]
    v_mfma_f32_16x16x32_bf16 v[188:191], v[124:127], v[84:87], v[188:191]
    s_add_u32 m0, s41, 16384
    s_nop 0
    buffer_load_dwordx4 v12, s[16:19], s30 offen lds
    v_mfma_f32_16x16x32_bf16 v[192:195], v[96:99], v[88:91], v[192:195]
    ds_read_b64_tr_b16 v[60:61], v7 offset:35872
    v_mfma_f32_16x16x32_bf16 v[196:199], v[100:103], v[88:91], v[196:199]
    ds_read_b64_tr_b16 v[62:63], v7 offset:37664
    v_mfma_f32_16x16x32_bf16 v[200:203], v[104:107], v[88:91], v[200:203]
    v_mfma_f32_16x16x32_bf16 v[204:207], v[108:111], v[88:91], v[204:207]
    ds_read_b64_tr_b16 v[64:65], v7 offset:28736
    v_mfma_f32_16x16x32_bf16 v[208:211], v[112:115], v[88:91], v[208:211]
    ds_read_b64_tr_b16 v[66:67], v7 offset:30528
    v_mfma_f32_16x16x32_bf16 v[212:215], v[116:119], v[88:91], v[212:215]
    ds_read_b64_tr_b16 v[68:69], v7 offset:35904
    v_mfma_f32_16x16x32_bf16 v[216:219], v[120:123], v[88:91], v[216:219]
    v_mfma_f32_16x16x32_bf16 v[220:223], v[124:127], v[88:91], v[220:223]
    s_add_u32 m0, s41, 17408
    s_nop 0
    buffer_load_dwordx4 v13, s[16:19], s30 offen lds
    v_mfma_f32_16x16x32_bf16 v[224:227], v[96:99], v[92:95], v[224:227]
    ds_read_b64_tr_b16 v[70:71], v7 offset:37696
    v_mfma_f32_16x16x32_bf16 v[228:231], v[100:103], v[92:95], v[228:231]
    ds_read_b64_tr_b16 v[72:73], v7 offset:28768
    v_mfma_f32_16x16x32_bf16 v[232:235], v[104:107], v[92:95], v[232:235]
    v_mfma_f32_16x16x32_bf16 v[236:239], v[108:111], v[92:95], v[236:239]
    ds_read_b64_tr_b16 v[74:75], v7 offset:30560
    v_mfma_f32_16x16x32_bf16 v[240:243], v[112:115], v[92:95], v[240:243]
    ds_read_b64_tr_b16 v[76:77], v7 offset:35936
    v_mfma_f32_16x16x32_bf16 v[244:247], v[116:119], v[92:95], v[244:247]
    ds_read_b64_tr_b16 v[78:79], v7 offset:37728
    v_mfma_f32_16x16x32_bf16 v[248:251], v[120:123], v[92:95], v[248:251]
    v_mfma_f32_16x16x32_bf16 v[252:255], v[124:127], v[92:95], v[252:255]
    s_waitcnt vmcnt(4) lgkmcnt(0)
    s_barrier
    v_add_u32 v6, s45, v29
    s_add_u32 s45, s45, 32768
    s_cmp_eq_u32 s45, 98304
    s_cselect_b32 s45, 0, s45
    s_nop 0
    s_add_u32 m0, s41, 18432
    s_nop 0
    buffer_load_dwordx4 v14, s[16:19], s30 offen lds
    v_mfma_f32_16x16x32_bf16 v[128:131], v[48:51], v[32:35], v[128:131]
    ds_read_b128 v[80:83], v6 offset:0
    v_mfma_f32_16x16x32_bf16 v[132:135], v[52:55], v[32:35], v[132:135]
    ds_read_b128 v[84:87], v6 offset:2048
    v_mfma_f32_16x16x32_bf16 v[136:139], v[56:59], v[32:35], v[136:139]
    v_mfma_f32_16x16x32_bf16 v[140:143], v[60:63], v[32:35], v[140:143]
    ds_read_b128 v[88:91], v6 offset:4096
    v_mfma_f32_16x16x32_bf16 v[144:147], v[64:67], v[32:35], v[144:147]
    ds_read_b128 v[92:95], v6 offset:6144
    v_mfma_f32_16x16x32_bf16 v[148:151], v[68:71], v[32:35], v[148:151]
    ds_read_b64_tr_b16 v[96:97], v7 offset:43008
    v_mfma_f32_16x16x32_bf16 v[152:155], v[72:75], v[32:35], v[152:155]
    v_mfma_f32_16x16x32_bf16 v[156:159], v[76:79], v[32:35], v[156:159]
    ds_read_b64_tr_b16 v[98:99], v7 offset:44800
    v_mfma_f32_16x16x32_bf16 v[160:163], v[48:51], v[36:39], v[160:163]
    ds_read_b64_tr_b16 v[100:101], v7 offset:50176
    v_mfma_f32_16x16x32_bf16 v[164:167], v[52:55], v[36:39], v[164:167]
    v_mfma_f32_16x16x32_bf16 v[168:171], v[56:59], v[36:39], v[168:171]
    s_add_u32 m0, s41, 19456
    s_nop 0
    buffer_load_dwordx4 v15, s[16:19], s30 offen lds
    v_mfma_f32_16x16x32_bf16 v[172:175], v[60:63], v[36:39], v[172:175]
    ds_read_b64_tr_b16 v[102:103], v7 offset:51968
    v_mfma_f32_16x16x32_bf16 v[176:179], v[64:67], v[36:39], v[176:179]
    ds_read_b64_tr_b16 v[104:105], v7 offset:43040
    v_mfma_f32_16x16x32_bf16 v[180:183], v[68:71], v[36:39], v[180:183]
    v_mfma_f32_16x16x32_bf16 v[184:187], v[72:75], v[36:39], v[184:187]
    ds_read_b64_tr_b16 v[106:107], v7 offset:44832
    v_mfma_f32_16x16x32_bf16 v[188:191], v[76:79], v[36:39], v[188:191]
    ds_read_b64_tr_b16 v[108:109], v7 offset:50208
    v_mfma_f32_16x16x32_bf16 v[192:195], v[48:51], v[40:43], v[192:195]
    v_mfma_f32_16x16x32_bf16 v[196:199], v[52:55], v[40:43], v[196:199]
    ds_read_b64_tr_b16 v[110:111], v7 offset:52000
    v_mfma_f32_16x16x32_bf16 v[200:203], v[56:59], v[40:43], v[200:203]
    ds_read_b64_tr_b16 v[112:113], v7 offset:43072
    v_mfma_f32_16x16x32_bf16 v[204:207], v[60:63], v[40:43], v[204:207]
    ds_read_b64_tr_b16 v[114:115], v7 offset:44864
    v_mfma_f32_16x16x32_bf16 v[208:211], v[64:67], v[40:43], v[208:211]
    v_mfma_f32_16x16x32_bf16 v[212:215], v[68:71], v[40:43], v[212:215]
    s_add_u32 m0, s41, 20480
    s_nop 0
    buffer_load_dwordx4 v16, s[16:19], s30 offen lds
    s_add_u32 s30, s30, 458752
    v_mfma_f32_16x16x32_bf16 v[216:219], v[72:75], v[40:43], v[216:219]
    ds_read_b64_tr_b16 v[116:117], v7 offset:50240
    v_mfma_f32_16x16x32_bf16 v[220:223], v[76:79], v[40:43], v[220:223]
    v_mfma_f32_16x16x32_bf16 v[224:227], v[48:51], v[44:47], v[224:227]
    ds_read_b64_tr_b16 v[118:119], v7 offset:52032
    v_mfma_f32_16x16x32_bf16 v[228:231], v[52:55], v[44:47], v[228:231]
    ds_read_b64_tr_b16 v[120:121], v7 offset:43104
    v_mfma_f32_16x16x32_bf16 v[232:235], v[56:59], v[44:47], v[232:235]
    ds_read_b64_tr_b16 v[122:123], v7 offset:44896
    v_mfma_f32_16x16x32_bf16 v[236:239], v[60:63], v[44:47], v[236:239]
    v_mfma_f32_16x16x32_bf16 v[240:243], v[64:67], v[44:47], v[240:243]
    ds_read_b64_tr_b16 v[124:125], v7 offset:50272
    v_mfma_f32_16x16x32_bf16 v[244:247], v[68:71], v[44:47], v[244:247]
    ds_read_b64_tr_b16 v[126:127], v7 offset:52064
    v_mfma_f32_16x16x32_bf16 v[248:251], v[72:75], v[44:47], v[248:251]
    v_mfma_f32_16x16x32_bf16 v[252:255], v[76:79], v[44:47], v[252:255]
    s_waitcnt vmcnt(63) lgkmcnt(0)
    s_barrier
    v_add_u32 v5, s45, v28
    s_nop 0
    s_add_u32 m0, s41, 43008
    s_nop 0
    buffer_load_dwordx4 v10, s[16:19], s30 offen lds
    v_mfma_f32_16x16x32_bf16 v[128:131], v[96:99], v[80:83], v[128:131]
    ds_read_b128 v[32:35], v5 offset:0
    v_mfma_f32_16x16x32_bf16 v[132:135], v[100:103], v[80:83], v[132:135]
    ds_read_b128 v[36:39], v5 offset:2048
    v_mfma_f32_16x16x32_bf16 v[136:139], v[104:107], v[80:83], v[136:139]
    v_mfma_f32_16x16x32_bf16 v[140:143], v[108:111], v[80:83], v[140:143]
    ds_read_b128 v[40:43], v5 offset:4096
    v_mfma_f32_16x16x32_bf16 v[144:147], v[112:115], v[80:83], v[144:147]
    ds_read_b128 v[44:47], v5 offset:6144
    v_mfma_f32_16x16x32_bf16 v[148:151], v[116:119], v[80:83], v[148:151]
    ds_read_b64_tr_b16 v[48:49], v7 offset:0
    v_mfma_f32_16x16x32_bf16 v[152:155], v[120:123], v[80:83], v[152:155]
    v_mfma_f32_16x16x32_bf16 v[156:159], v[124:127], v[80:83], v[156:159]
    s_add_u32 m0, s41, 44032
    s_nop 0
    buffer_load_dwordx4 v11, s[16:19], s30 offen lds
    v_mfma_f32_16x16x32_bf16 v[160:163], v[96:99], v[84:87], v[160:163]
    ds_read_b64_tr_b16 v[50:51], v7 offset:1792
    v_mfma_f32_16x16x32_bf16 v[164:167], v[100:103], v[84:87], v[164:167]
    ds_read_b64_tr_b16 v[52:53], v7 offset:7168
    v_mfma_f32_16x16x32_bf16 v[168:171], v[104:107], v[84:87], v[168:171]
    v_mfma_f32_16x16x32_bf16 v[172:175], v[108:111], v[84:87], v[172:175]
    ds_read_b64_tr_b16 v[54:55], v7 offset:8960
    v_mfma_f32_16x16x32_bf16 v[176:179], v[112:115], v[84:87], v[176:179]
    ds_read_b64_tr_b16 v[56:57], v7 offset:32
    v_mfma_f32_16x16x32_bf16 v[180:183], v[116:119], v[84:87], v[180:183]
    ds_read_b64_tr_b16 v[58:59], v7 offset:1824
    v_mfma_f32_16x16x32_bf16 v[184:187], v[120:123], v[84:87], v[184:187]
    v_mfma_f32_16x16x32_bf16 v[188:191], v[124:127], v[84:87], v[188:191]
    s_add_u32 m0, s41, 45056
    s_nop 0
    buffer_load_dwordx4 v12, s[16:19], s30 offen lds
    v_mfma_f32_16x16x32_bf16 v[192:195], v[96:99], v[88:91], v[192:195]
    ds_read_b64_tr_b16 v[60:61], v7 offset:7200
    v_mfma_f32_16x16x32_bf16 v[196:199], v[100:103], v[88:91], v[196:199]
    ds_read_b64_tr_b16 v[62:63], v7 offset:8992
    v_mfma_f32_16x16x32_bf16 v[200:203], v[104:107], v[88:91], v[200:203]
    v_mfma_f32_16x16x32_bf16 v[204:207], v[108:111], v[88:91], v[204:207]
    ds_read_b64_tr_b16 v[64:65], v7 offset:64
    v_mfma_f32_16x16x32_bf16 v[208:211], v[112:115], v[88:91], v[208:211]
    ds_read_b64_tr_b16 v[66:67], v7 offset:1856
    v_mfma_f32_16x16x32_bf16 v[212:215], v[116:119], v[88:91], v[212:215]
    ds_read_b64_tr_b16 v[68:69], v7 offset:7232
    v_mfma_f32_16x16x32_bf16 v[216:219], v[120:123], v[88:91], v[216:219]
    v_mfma_f32_16x16x32_bf16 v[220:223], v[124:127], v[88:91], v[220:223]
    s_add_u32 m0, s41, 46080
    s_nop 0
    buffer_load_dwordx4 v13, s[16:19], s30 offen lds
    v_mfma_f32_16x16x32_bf16 v[224:227], v[96:99], v[92:95], v[224:227]
    ds_read_b64_tr_b16 v[70:71], v7 offset:9024
    v_mfma_f32_16x16x32_bf16 v[228:231], v[100:103], v[92:95], v[228:231]
    ds_read_b64_tr_b16 v[72:73], v7 offset:96
    v_mfma_f32_16x16x32_bf16 v[232:235], v[104:107], v[92:95], v[232:235]
    v_mfma_f32_16x16x32_bf16 v[236:239], v[108:111], v[92:95], v[236:239]
    ds_read_b64_tr_b16 v[74:75], v7 offset:1888
    v_mfma_f32_16x16x32_bf16 v[240:243], v[112:115], v[92:95], v[240:243]
    ds_read_b64_tr_b16 v[76:77], v7 offset:7264
    v_mfma_f32_16x16x32_bf16 v[244:247], v[116:119], v[92:95], v[244:247]
    ds_read_b64_tr_b16 v[78:79], v7 offset:9056
    v_mfma_f32_16x16x32_bf16 v[248:251], v[120:123], v[92:95], v[248:251]
    v_mfma_f32_16x16x32_bf16 v[252:255], v[124:127], v[92:95], v[252:255]
    s_waitcnt vmcnt(4) lgkmcnt(0)
    s_barrier
    s_mov_b32 s29, 3
K1T01_LOOP:
    v_add_u32 v6, s45, v29
    s_add_u32 s45, s45, 32768
    s_cmp_eq_u32 s45, 98304
    s_cselect_b32 s45, 0, s45
    s_nop 0
    s_add_u32 m0, s41, 47104
    s_nop 0
    buffer_load_dwordx4 v14, s[16:19], s30 offen lds
    v_mfma_f32_16x16x32_bf16 v[128:131], v[48:51], v[32:35], v[128:131]
    ds_read_b128 v[80:83], v6 offset:0
    v_mfma_f32_16x16x32_bf16 v[132:135], v[52:55], v[32:35], v[132:135]
    ds_read_b128 v[84:87], v6 offset:2048
    v_mfma_f32_16x16x32_bf16 v[136:139], v[56:59], v[32:35], v[136:139]
    v_mfma_f32_16x16x32_bf16 v[140:143], v[60:63], v[32:35], v[140:143]
    ds_read_b128 v[88:91], v6 offset:4096
    v_mfma_f32_16x16x32_bf16 v[144:147], v[64:67], v[32:35], v[144:147]
    ds_read_b128 v[92:95], v6 offset:6144
    v_mfma_f32_16x16x32_bf16 v[148:151], v[68:71], v[32:35], v[148:151]
    ds_read_b64_tr_b16 v[96:97], v7 offset:14336
    v_mfma_f32_16x16x32_bf16 v[152:155], v[72:75], v[32:35], v[152:155]
    v_mfma_f32_16x16x32_bf16 v[156:159], v[76:79], v[32:35], v[156:159]
    ds_read_b64_tr_b16 v[98:99], v7 offset:16128
    v_mfma_f32_16x16x32_bf16 v[160:163], v[48:51], v[36:39], v[160:163]
    ds_read_b64_tr_b16 v[100:101], v7 offset:21504
    v_mfma_f32_16x16x32_bf16 v[164:167], v[52:55], v[36:39], v[164:167]
    v_mfma_f32_16x16x32_bf16 v[168:171], v[56:59], v[36:39], v[168:171]
    s_add_u32 m0, s41, 48128
    s_nop 0
    buffer_load_dwordx4 v15, s[16:19], s30 offen lds
    v_mfma_f32_16x16x32_bf16 v[172:175], v[60:63], v[36:39], v[172:175]
    ds_read_b64_tr_b16 v[102:103], v7 offset:23296
    v_mfma_f32_16x16x32_bf16 v[176:179], v[64:67], v[36:39], v[176:179]
    ds_read_b64_tr_b16 v[104:105], v7 offset:14368
    v_mfma_f32_16x16x32_bf16 v[180:183], v[68:71], v[36:39], v[180:183]
    v_mfma_f32_16x16x32_bf16 v[184:187], v[72:75], v[36:39], v[184:187]
    ds_read_b64_tr_b16 v[106:107], v7 offset:16160
    v_mfma_f32_16x16x32_bf16 v[188:191], v[76:79], v[36:39], v[188:191]
    ds_read_b64_tr_b16 v[108:109], v7 offset:21536
    v_mfma_f32_16x16x32_bf16 v[192:195], v[48:51], v[40:43], v[192:195]
    v_mfma_f32_16x16x32_bf16 v[196:199], v[52:55], v[40:43], v[196:199]
    ds_read_b64_tr_b16 v[110:111], v7 offset:23328
    v_mfma_f32_16x16x32_bf16 v[200:203], v[56:59], v[40:43], v[200:203]
    ds_read_b64_tr_b16 v[112:113], v7 offset:14400
    v_mfma_f32_16x16x32_bf16 v[204:207], v[60:63], v[40:43], v[204:207]
    ds_read_b64_tr_b16 v[114:115], v7 offset:16192
    v_mfma_f32_16x16x32_bf16 v[208:211], v[64:67], v[40:43], v[208:211]
    v_mfma_f32_16x16x32_bf16 v[212:215], v[68:71], v[40:43], v[212:215]
    s_add_u32 m0, s41, 49152
    s_nop 0
    buffer_load_dwordx4 v16, s[16:19], s30 offen lds
    s_add_u32 s30, s30, 458752
    v_mfma_f32_16x16x32_bf16 v[216:219], v[72:75], v[40:43], v[216:219]
    ds_read_b64_tr_b16 v[116:117], v7 offset:21568
    v_mfma_f32_16x16x32_bf16 v[220:223], v[76:79], v[40:43], v[220:223]
    v_mfma_f32_16x16x32_bf16 v[224:227], v[48:51], v[44:47], v[224:227]
    ds_read_b64_tr_b16 v[118:119], v7 offset:23360
    v_mfma_f32_16x16x32_bf16 v[228:231], v[52:55], v[44:47], v[228:231]
    ds_read_b64_tr_b16 v[120:121], v7 offset:14432
    v_mfma_f32_16x16x32_bf16 v[232:235], v[56:59], v[44:47], v[232:235]
    ds_read_b64_tr_b16 v[122:123], v7 offset:16224
    v_mfma_f32_16x16x32_bf16 v[236:239], v[60:63], v[44:47], v[236:239]
    v_mfma_f32_16x16x32_bf16 v[240:243], v[64:67], v[44:47], v[240:243]
    ds_read_b64_tr_b16 v[124:125], v7 offset:21600
    v_mfma_f32_16x16x32_bf16 v[244:247], v[68:71], v[44:47], v[244:247]
    ds_read_b64_tr_b16 v[126:127], v7 offset:23392
    v_mfma_f32_16x16x32_bf16 v[248:251], v[72:75], v[44:47], v[248:251]
    v_mfma_f32_16x16x32_bf16 v[252:255], v[76:79], v[44:47], v[252:255]
    s_waitcnt vmcnt(63) lgkmcnt(0)
    s_barrier
    v_add_u32 v5, s45, v28
    s_nop 0
    s_add_u32 m0, s41, 14336
    s_nop 0
    buffer_load_dwordx4 v10, s[16:19], s30 offen lds
    v_mfma_f32_16x16x32_bf16 v[128:131], v[96:99], v[80:83], v[128:131]
    ds_read_b128 v[32:35], v5 offset:0
    v_mfma_f32_16x16x32_bf16 v[132:135], v[100:103], v[80:83], v[132:135]
    ds_read_b128 v[36:39], v5 offset:2048
    v_mfma_f32_16x16x32_bf16 v[136:139], v[104:107], v[80:83], v[136:139]
    v_mfma_f32_16x16x32_bf16 v[140:143], v[108:111], v[80:83], v[140:143]
    ds_read_b128 v[40:43], v5 offset:4096
    v_mfma_f32_16x16x32_bf16 v[144:147], v[112:115], v[80:83], v[144:147]
    ds_read_b128 v[44:47], v5 offset:6144
    v_mfma_f32_16x16x32_bf16 v[148:151], v[116:119], v[80:83], v[148:151]
    ds_read_b64_tr_b16 v[48:49], v7 offset:28672
    v_mfma_f32_16x16x32_bf16 v[152:155], v[120:123], v[80:83], v[152:155]
    v_mfma_f32_16x16x32_bf16 v[156:159], v[124:127], v[80:83], v[156:159]
    s_add_u32 m0, s41, 15360
    s_nop 0
    buffer_load_dwordx4 v11, s[16:19], s30 offen lds
    v_mfma_f32_16x16x32_bf16 v[160:163], v[96:99], v[84:87], v[160:163]
    ds_read_b64_tr_b16 v[50:51], v7 offset:30464
    v_mfma_f32_16x16x32_bf16 v[164:167], v[100:103], v[84:87], v[164:167]
    ds_read_b64_tr_b16 v[52:53], v7 offset:35840
    v_mfma_f32_16x16x32_bf16 v[168:171], v[104:107], v[84:87], v[168:171]
    v_mfma_f32_16x16x32_bf16 v[172:175], v[108:111], v[84:87], v[172:175]
    ds_read_b64_tr_b16 v[54:55], v7 offset:37632
    v_mfma_f32_16x16x32_bf16 v[176:179], v[112:115], v[84:87], v[176:179]
    ds_read_b64_tr_b16 v[56:57], v7 offset:28704
    v_mfma_f32_16x16x32_bf16 v[180:183], v[116:119], v[84:87], v[180:183]
    ds_read_b64_tr_b16 v[58:59], v7 offset:30496
    v_mfma_f32_16x16x32_bf16 v[184:187], v[120:123], v[84:87], v[184:187]
    v_mfma_f32_16x16x32_bf16 v[188:191], v[124:127], v[84:87], v[188:191]
    s_add_u32 m0, s41, 16384
    s_nop 0
    buffer_load_dwordx4 v12, s[16:19], s30 offen lds
    v_mfma_f32_16x16x32_bf16 v[192:195], v[96:99], v[88:91], v[192:195]
    ds_read_b64_tr_b16 v[60:61], v7 offset:35872
    v_mfma_f32_16x16x32_bf16 v[196:199], v[100:103], v[88:91], v[196:199]
    ds_read_b64_tr_b16 v[62:63], v7 offset:37664
    v_mfma_f32_16x16x32_bf16 v[200:203], v[104:107], v[88:91], v[200:203]
    v_mfma_f32_16x16x32_bf16 v[204:207], v[108:111], v[88:91], v[204:207]
    ds_read_b64_tr_b16 v[64:65], v7 offset:28736
    v_mfma_f32_16x16x32_bf16 v[208:211], v[112:115], v[88:91], v[208:211]
    ds_read_b64_tr_b16 v[66:67], v7 offset:30528
    v_mfma_f32_16x16x32_bf16 v[212:215], v[116:119], v[88:91], v[212:215]
    ds_read_b64_tr_b16 v[68:69], v7 offset:35904
    v_mfma_f32_16x16x32_bf16 v[216:219], v[120:123], v[88:91], v[216:219]
    v_mfma_f32_16x16x32_bf16 v[220:223], v[124:127], v[88:91], v[220:223]
    s_add_u32 m0, s41, 17408
    s_nop 0
    buffer_load_dwordx4 v13, s[16:19], s30 offen lds
    v_mfma_f32_16x16x32_bf16 v[224:227], v[96:99], v[92:95], v[224:227]
    ds_read_b64_tr_b16 v[70:71], v7 offset:37696
    v_mfma_f32_16x16x32_bf16 v[228:231], v[100:103], v[92:95], v[228:231]
    ds_read_b64_tr_b16 v[72:73], v7 offset:28768
    v_mfma_f32_16x16x32_bf16 v[232:235], v[104:107], v[92:95], v[232:235]
    v_mfma_f32_16x16x32_bf16 v[236:239], v[108:111], v[92:95], v[236:239]
    ds_read_b64_tr_b16 v[74:75], v7 offset:30560
    v_mfma_f32_16x16x32_bf16 v[240:243], v[112:115], v[92:95], v[240:243]
    ds_read_b64_tr_b16 v[76:77], v7 offset:35936
    v_mfma_f32_16x16x32_bf16 v[244:247], v[116:119], v[92:95], v[244:247]
    ds_read_b64_tr_b16 v[78:79], v7 offset:37728
    v_mfma_f32_16x16x32_bf16 v[248:251], v[120:123], v[92:95], v[248:251]
    v_mfma_f32_16x16x32_bf16 v[252:255], v[124:127], v[92:95], v[252:255]
    s_waitcnt vmcnt(4) lgkmcnt(0)
    s_barrier
    v_add_u32 v6, s45, v29
    s_add_u32 s45, s45, 32768
    s_cmp_eq_u32 s45, 98304
    s_cselect_b32 s45, 0, s45
    s_nop 0
    s_add_u32 m0, s41, 18432
    s_nop 0
    buffer_load_dwordx4 v14, s[16:19], s30 offen lds
    v_mfma_f32_16x16x32_bf16 v[128:131], v[48:51], v[32:35], v[128:131]
    ds_read_b128 v[80:83], v6 offset:0
    v_mfma_f32_16x16x32_bf16 v[132:135], v[52:55], v[32:35], v[132:135]
    ds_read_b128 v[84:87], v6 offset:2048
    v_mfma_f32_16x16x32_bf16 v[136:139], v[56:59], v[32:35], v[136:139]
    v_mfma_f32_16x16x32_bf16 v[140:143], v[60:63], v[32:35], v[140:143]
    ds_read_b128 v[88:91], v6 offset:4096
    v_mfma_f32_16x16x32_bf16 v[144:147], v[64:67], v[32:35], v[144:147]
    ds_read_b128 v[92:95], v6 offset:6144
    v_mfma_f32_16x16x32_bf16 v[148:151], v[68:71], v[32:35], v[148:151]
    ds_read_b64_tr_b16 v[96:97], v7 offset:43008
    v_mfma_f32_16x16x32_bf16 v[152:155], v[72:75], v[32:35], v[152:155]
    v_mfma_f32_16x16x32_bf16 v[156:159], v[76:79], v[32:35], v[156:159]
    ds_read_b64_tr_b16 v[98:99], v7 offset:44800
    v_mfma_f32_16x16x32_bf16 v[160:163], v[48:51], v[36:39], v[160:163]
    ds_read_b64_tr_b16 v[100:101], v7 offset:50176
    v_mfma_f32_16x16x32_bf16 v[164:167], v[52:55], v[36:39], v[164:167]
    v_mfma_f32_16x16x32_bf16 v[168:171], v[56:59], v[36:39], v[168:171]
    s_add_u32 m0, s41, 19456
    s_nop 0
    buffer_load_dwordx4 v15, s[16:19], s30 offen lds
    v_mfma_f32_16x16x32_bf16 v[172:175], v[60:63], v[36:39], v[172:175]
    ds_read_b64_tr_b16 v[102:103], v7 offset:51968
    v_mfma_f32_16x16x32_bf16 v[176:179], v[64:67], v[36:39], v[176:179]
    ds_read_b64_tr_b16 v[104:105], v7 offset:43040
    v_mfma_f32_16x16x32_bf16 v[180:183], v[68:71], v[36:39], v[180:183]
    v_mfma_f32_16x16x32_bf16 v[184:187], v[72:75], v[36:39], v[184:187]
    ds_read_b64_tr_b16 v[106:107], v7 offset:44832
    v_mfma_f32_16x16x32_bf16 v[188:191], v[76:79], v[36:39], v[188:191]
    ds_read_b64_tr_b16 v[108:109], v7 offset:50208
    v_mfma_f32_16x16x32_bf16 v[192:195], v[48:51], v[40:43], v[192:195]
    v_mfma_f32_16x16x32_bf16 v[196:199], v[52:55], v[40:43], v[196:199]
    ds_read_b64_tr_b16 v[110:111], v7 offset:52000
    v_mfma_f32_16x16x32_bf16 v[200:203], v[56:59], v[40:43], v[200:203]
    ds_read_b64_tr_b16 v[112:113], v7 offset:43072
    v_mfma_f32_16x16x32_bf16 v[204:207], v[60:63], v[40:43], v[204:207]
    ds_read_b64_tr_b16 v[114:115], v7 offset:44864
    v_mfma_f32_16x16x32_bf16 v[208:211], v[64:67], v[40:43], v[208:211]
    v_mfma_f32_16x16x32_bf16 v[212:215], v[68:71], v[40:43], v[212:215]
    s_add_u32 m0, s41, 20480
    s_nop 0
    buffer_load_dwordx4 v16, s[16:19], s30 offen lds
    s_add_u32 s30, s30, 458752
    v_mfma_f32_16x16x32_bf16 v[216:219], v[72:75], v[40:43], v[216:219]
    ds_read_b64_tr_b16 v[116:117], v7 offset:50240
    v_mfma_f32_16x16x32_bf16 v[220:223], v[76:79], v[40:43], v[220:223]
    v_mfma_f32_16x16x32_bf16 v[224:227], v[48:51], v[44:47], v[224:227]
    ds_read_b64_tr_b16 v[118:119], v7 offset:52032
    v_mfma_f32_16x16x32_bf16 v[228:231], v[52:55], v[44:47], v[228:231]
    ds_read_b64_tr_b16 v[120:121], v7 offset:43104
    v_mfma_f32_16x16x32_bf16 v[232:235], v[56:59], v[44:47], v[232:235]
    ds_read_b64_tr_b16 v[122:123], v7 offset:44896
    v_mfma_f32_16x16x32_bf16 v[236:239], v[60:63], v[44:47], v[236:239]
    v_mfma_f32_16x16x32_bf16 v[240:243], v[64:67], v[44:47], v[240:243]
    ds_read_b64_tr_b16 v[124:125], v7 offset:50272
    v_mfma_f32_16x16x32_bf16 v[244:247], v[68:71], v[44:47], v[244:247]
    ds_read_b64_tr_b16 v[126:127], v7 offset:52064
    v_mfma_f32_16x16x32_bf16 v[248:251], v[72:75], v[44:47], v[248:251]
    v_mfma_f32_16x16x32_bf16 v[252:255], v[76:79], v[44:47], v[252:255]
    s_waitcnt vmcnt(63) lgkmcnt(0)
    s_barrier
    v_add_u32 v5, s45, v28
    s_nop 0
    s_add_u32 m0, s41, 43008
    s_nop 0
    buffer_load_dwordx4 v10, s[16:19], s30 offen lds
    v_mfma_f32_16x16x32_bf16 v[128:131], v[96:99], v[80:83], v[128:131]
    ds_read_b128 v[32:35], v5 offset:0
    v_mfma_f32_16x16x32_bf16 v[132:135], v[100:103], v[80:83], v[132:135]
    ds_read_b128 v[36:39], v5 offset:2048
    v_mfma_f32_16x16x32_bf16 v[136:139], v[104:107], v[80:83], v[136:139]
    v_mfma_f32_16x16x32_bf16 v[140:143], v[108:111], v[80:83], v[140:143]
    ds_read_b128 v[40:43], v5 offset:4096
    v_mfma_f32_16x16x32_bf16 v[144:147], v[112:115], v[80:83], v[144:147]
    ds_read_b128 v[44:47], v5 offset:6144
    v_mfma_f32_16x16x32_bf16 v[148:151], v[116:119], v[80:83], v[148:151]
    ds_read_b64_tr_b16 v[48:49], v7 offset:0
    v_mfma_f32_16x16x32_bf16 v[152:155], v[120:123], v[80:83], v[152:155]
    v_mfma_f32_16x16x32_bf16 v[156:159], v[124:127], v[80:83], v[156:159]
    s_add_u32 m0, s41, 44032
    s_nop 0
    buffer_load_dwordx4 v11, s[16:19], s30 offen lds
    v_mfma_f32_16x16x32_bf16 v[160:163], v[96:99], v[84:87], v[160:163]
    ds_read_b64_tr_b16 v[50:51], v7 offset:1792
    v_mfma_f32_16x16x32_bf16 v[164:167], v[100:103], v[84:87], v[164:167]
    ds_read_b64_tr_b16 v[52:53], v7 offset:7168
    v_mfma_f32_16x16x32_bf16 v[168:171], v[104:107], v[84:87], v[168:171]
    v_mfma_f32_16x16x32_bf16 v[172:175], v[108:111], v[84:87], v[172:175]
    ds_read_b64_tr_b16 v[54:55], v7 offset:8960
    v_mfma_f32_16x16x32_bf16 v[176:179], v[112:115], v[84:87], v[176:179]
    ds_read_b64_tr_b16 v[56:57], v7 offset:32
    v_mfma_f32_16x16x32_bf16 v[180:183], v[116:119], v[84:87], v[180:183]
    ds_read_b64_tr_b16 v[58:59], v7 offset:1824
    v_mfma_f32_16x16x32_bf16 v[184:187], v[120:123], v[84:87], v[184:187]
    v_mfma_f32_16x16x32_bf16 v[188:191], v[124:127], v[84:87], v[188:191]
    s_add_u32 m0, s41, 45056
    s_nop 0
    buffer_load_dwordx4 v12, s[16:19], s30 offen lds
    v_mfma_f32_16x16x32_bf16 v[192:195], v[96:99], v[88:91], v[192:195]
    ds_read_b64_tr_b16 v[60:61], v7 offset:7200
    v_mfma_f32_16x16x32_bf16 v[196:199], v[100:103], v[88:91], v[196:199]
    ds_read_b64_tr_b16 v[62:63], v7 offset:8992
    v_mfma_f32_16x16x32_bf16 v[200:203], v[104:107], v[88:91], v[200:203]
    v_mfma_f32_16x16x32_bf16 v[204:207], v[108:111], v[88:91], v[204:207]
    ds_read_b64_tr_b16 v[64:65], v7 offset:64
    v_mfma_f32_16x16x32_bf16 v[208:211], v[112:115], v[88:91], v[208:211]
    ds_read_b64_tr_b16 v[66:67], v7 offset:1856
    v_mfma_f32_16x16x32_bf16 v[212:215], v[116:119], v[88:91], v[212:215]
    ds_read_b64_tr_b16 v[68:69], v7 offset:7232
    v_mfma_f32_16x16x32_bf16 v[216:219], v[120:123], v[88:91], v[216:219]
    v_mfma_f32_16x16x32_bf16 v[220:223], v[124:127], v[88:91], v[220:223]
    s_add_u32 m0, s41, 46080
    s_nop 0
    buffer_load_dwordx4 v13, s[16:19], s30 offen lds
    v_mfma_f32_16x16x32_bf16 v[224:227], v[96:99], v[92:95], v[224:227]
    ds_read_b64_tr_b16 v[70:71], v7 offset:9024
    v_mfma_f32_16x16x32_bf16 v[228:231], v[100:103], v[92:95], v[228:231]
    ds_read_b64_tr_b16 v[72:73], v7 offset:96
    v_mfma_f32_16x16x32_bf16 v[232:235], v[104:107], v[92:95], v[232:235]
    v_mfma_f32_16x16x32_bf16 v[236:239], v[108:111], v[92:95], v[236:239]
    ds_read_b64_tr_b16 v[74:75], v7 offset:1888
    v_mfma_f32_16x16x32_bf16 v[240:243], v[112:115], v[92:95], v[240:243]
    ds_read_b64_tr_b16 v[76:77], v7 offset:7264
    v_mfma_f32_16x16x32_bf16 v[244:247], v[116:119], v[92:95], v[244:247]
    ds_read_b64_tr_b16 v[78:79], v7 offset:9056
    v_mfma_f32_16x16x32_bf16 v[248:251], v[120:123], v[92:95], v[248:251]
    v_mfma_f32_16x16x32_bf16 v[252:255], v[124:127], v[92:95], v[252:255]
    s_waitcnt vmcnt(4) lgkmcnt(0)
    s_barrier
    s_sub_u32 s29, s29, 1
    s_cmp_lg_u32 s29, 0
    s_cbranch_scc1 K1T01_LOOP
    v_add_u32 v6, s45, v29
    s_add_u32 s45, s45, 32768
    s_cmp_eq_u32 s45, 98304
    s_cselect_b32 s45, 0, s45
    s_nop 0
    s_add_u32 m0, s41, 47104
    s_nop 0
    buffer_load_dwordx4 v14, s[16:19], s30 offen lds
    v_mfma_f32_16x16x32_bf16 v[128:131], v[48:51], v[32:35], v[128:131]
    ds_read_b128 v[80:83], v6 offset:0
    v_mfma_f32_16x16x32_bf16 v[132:135], v[52:55], v[32:35], v[132:135]
    ds_read_b128 v[84:87], v6 offset:2048
    v_mfma_f32_16x16x32_bf16 v[136:139], v[56:59], v[32:35], v[136:139]
    v_mfma_f32_16x16x32_bf16 v[140:143], v[60:63], v[32:35], v[140:143]
    ds_read_b128 v[88:91], v6 offset:4096
    v_mfma_f32_16x16x32_bf16 v[144:147], v[64:67], v[32:35], v[144:147]
    ds_read_b128 v[92:95], v6 offset:6144
    v_mfma_f32_16x16x32_bf16 v[148:151], v[68:71], v[32:35], v[148:151]
    ds_read_b64_tr_b16 v[96:97], v7 offset:14336
    v_mfma_f32_16x16x32_bf16 v[152:155], v[72:75], v[32:35], v[152:155]
    v_mfma_f32_16x16x32_bf16 v[156:159], v[76:79], v[32:35], v[156:159]
    ds_read_b64_tr_b16 v[98:99], v7 offset:16128
    v_mfma_f32_16x16x32_bf16 v[160:163], v[48:51], v[36:39], v[160:163]
    ds_read_b64_tr_b16 v[100:101], v7 offset:21504
    v_mfma_f32_16x16x32_bf16 v[164:167], v[52:55], v[36:39], v[164:167]
    v_mfma_f32_16x16x32_bf16 v[168:171], v[56:59], v[36:39], v[168:171]
    s_add_u32 m0, s41, 48128
    s_nop 0
    buffer_load_dwordx4 v15, s[16:19], s30 offen lds
    v_mfma_f32_16x16x32_bf16 v[172:175], v[60:63], v[36:39], v[172:175]
    ds_read_b64_tr_b16 v[102:103], v7 offset:23296
    v_mfma_f32_16x16x32_bf16 v[176:179], v[64:67], v[36:39], v[176:179]
    ds_read_b64_tr_b16 v[104:105], v7 offset:14368
    v_mfma_f32_16x16x32_bf16 v[180:183], v[68:71], v[36:39], v[180:183]
    v_mfma_f32_16x16x32_bf16 v[184:187], v[72:75], v[36:39], v[184:187]
    ds_read_b64_tr_b16 v[106:107], v7 offset:16160
    v_mfma_f32_16x16x32_bf16 v[188:191], v[76:79], v[36:39], v[188:191]
    ds_read_b64_tr_b16 v[108:109], v7 offset:21536
    v_mfma_f32_16x16x32_bf16 v[192:195], v[48:51], v[40:43], v[192:195]
    v_mfma_f32_16x16x32_bf16 v[196:199], v[52:55], v[40:43], v[196:199]
    ds_read_b64_tr_b16 v[110:111], v7 offset:23328
    v_mfma_f32_16x16x32_bf16 v[200:203], v[56:59], v[40:43], v[200:203]
    ds_read_b64_tr_b16 v[112:113], v7 offset:14400
    v_mfma_f32_16x16x32_bf16 v[204:207], v[60:63], v[40:43], v[204:207]
    ds_read_b64_tr_b16 v[114:115], v7 offset:16192
    v_mfma_f32_16x16x32_bf16 v[208:211], v[64:67], v[40:43], v[208:211]
    v_mfma_f32_16x16x32_bf16 v[212:215], v[68:71], v[40:43], v[212:215]
    s_add_u32 m0, s41, 49152
    s_nop 0
    buffer_load_dwordx4 v16, s[16:19], s30 offen lds
    s_add_u32 s30, s30, 458752
    v_mfma_f32_16x16x32_bf16 v[216:219], v[72:75], v[40:43], v[216:219]
    ds_read_b64_tr_b16 v[116:117], v7 offset:21568
    v_mfma_f32_16x16x32_bf16 v[220:223], v[76:79], v[40:43], v[220:223]
    v_mfma_f32_16x16x32_bf16 v[224:227], v[48:51], v[44:47], v[224:227]
    ds_read_b64_tr_b16 v[118:119], v7 offset:23360
    v_mfma_f32_16x16x32_bf16 v[228:231], v[52:55], v[44:47], v[228:231]
    ds_read_b64_tr_b16 v[120:121], v7 offset:14432
    v_mfma_f32_16x16x32_bf16 v[232:235], v[56:59], v[44:47], v[232:235]
    ds_read_b64_tr_b16 v[122:123], v7 offset:16224
    v_mfma_f32_16x16x32_bf16 v[236:239], v[60:63], v[44:47], v[236:239]
    v_mfma_f32_16x16x32_bf16 v[240:243], v[64:67], v[44:47], v[240:243]
    ds_read_b64_tr_b16 v[124:125], v7 offset:21600
    v_mfma_f32_16x16x32_bf16 v[244:247], v[68:71], v[44:47], v[244:247]
    ds_read_b64_tr_b16 v[126:127], v7 offset:23392
    v_mfma_f32_16x16x32_bf16 v[248:251], v[72:75], v[44:47], v[248:251]
    v_mfma_f32_16x16x32_bf16 v[252:255], v[76:79], v[44:47], v[252:255]
    s_waitcnt vmcnt(63) lgkmcnt(0)
    s_barrier
    v_add_u32 v5, s45, v28
    s_nop 0
    s_add_u32 m0, s41, 14336
    s_nop 0
    buffer_load_dwordx4 v10, s[16:19], s30 offen lds
    v_mfma_f32_16x16x32_bf16 v[128:131], v[96:99], v[80:83], v[128:131]
    ds_read_b128 v[32:35], v5 offset:0
    v_mfma_f32_16x16x32_bf16 v[132:135], v[100:103], v[80:83], v[132:135]
    ds_read_b128 v[36:39], v5 offset:2048
    v_mfma_f32_16x16x32_bf16 v[136:139], v[104:107], v[80:83], v[136:139]
    v_mfma_f32_16x16x32_bf16 v[140:143], v[108:111], v[80:83], v[140:143]
    ds_read_b128 v[40:43], v5 offset:4096
    v_mfma_f32_16x16x32_bf16 v[144:147], v[112:115], v[80:83], v[144:147]
    ds_read_b128 v[44:47], v5 offset:6144
    v_mfma_f32_16x16x32_bf16 v[148:151], v[116:119], v[80:83], v[148:151]
    ds_read_b64_tr_b16 v[48:49], v7 offset:28672
    v_mfma_f32_16x16x32_bf16 v[152:155], v[120:123], v[80:83], v[152:155]
    v_mfma_f32_16x16x32_bf16 v[156:159], v[124:127], v[80:83], v[156:159]
    s_add_u32 m0, s41, 15360
    s_nop 0
    buffer_load_dwordx4 v11, s[16:19], s30 offen lds
    v_mfma_f32_16x16x32_bf16 v[160:163], v[96:99], v[84:87], v[160:163]
    ds_read_b64_tr_b16 v[50:51], v7 offset:30464
    v_mfma_f32_16x16x32_bf16 v[164:167], v[100:103], v[84:87], v[164:167]
    ds_read_b64_tr_b16 v[52:53], v7 offset:35840
    v_mfma_f32_16x16x32_bf16 v[168:171], v[104:107], v[84:87], v[168:171]
    v_mfma_f32_16x16x32_bf16 v[172:175], v[108:111], v[84:87], v[172:175]
    ds_read_b64_tr_b16 v[54:55], v7 offset:37632
    v_mfma_f32_16x16x32_bf16 v[176:179], v[112:115], v[84:87], v[176:179]
    ds_read_b64_tr_b16 v[56:57], v7 offset:28704
    v_mfma_f32_16x16x32_bf16 v[180:183], v[116:119], v[84:87], v[180:183]
    ds_read_b64_tr_b16 v[58:59], v7 offset:30496
    v_mfma_f32_16x16x32_bf16 v[184:187], v[120:123], v[84:87], v[184:187]
    v_mfma_f32_16x16x32_bf16 v[188:191], v[124:127], v[84:87], v[188:191]
    s_add_u32 m0, s41, 16384
    s_nop 0
    buffer_load_dwordx4 v12, s[16:19], s30 offen lds
    v_mfma_f32_16x16x32_bf16 v[192:195], v[96:99], v[88:91], v[192:195]
    ds_read_b64_tr_b16 v[60:61], v7 offset:35872
    v_mfma_f32_16x16x32_bf16 v[196:199], v[100:103], v[88:91], v[196:199]
    ds_read_b64_tr_b16 v[62:63], v7 offset:37664
    v_mfma_f32_16x16x32_bf16 v[200:203], v[104:107], v[88:91], v[200:203]
    v_mfma_f32_16x16x32_bf16 v[204:207], v[108:111], v[88:91], v[204:207]
    ds_read_b64_tr_b16 v[64:65], v7 offset:28736
    v_mfma_f32_16x16x32_bf16 v[208:211], v[112:115], v[88:91], v[208:211]
    ds_read_b64_tr_b16 v[66:67], v7 offset:30528
    v_mfma_f32_16x16x32_bf16 v[212:215], v[116:119], v[88:91], v[212:215]
    ds_read_b64_tr_b16 v[68:69], v7 offset:35904
    v_mfma_f32_16x16x32_bf16 v[216:219], v[120:123], v[88:91], v[216:219]
    v_mfma_f32_16x16x32_bf16 v[220:223], v[124:127], v[88:91], v[220:223]
    s_add_u32 m0, s41, 17408
    s_nop 0
    buffer_load_dwordx4 v13, s[16:19], s30 offen lds
    v_mfma_f32_16x16x32_bf16 v[224:227], v[96:99], v[92:95], v[224:227]
    ds_read_b64_tr_b16 v[70:71], v7 offset:37696
    v_mfma_f32_16x16x32_bf16 v[228:231], v[100:103], v[92:95], v[228:231]
    ds_read_b64_tr_b16 v[72:73], v7 offset:28768
    v_mfma_f32_16x16x32_bf16 v[232:235], v[104:107], v[92:95], v[232:235]
    v_mfma_f32_16x16x32_bf16 v[236:239], v[108:111], v[92:95], v[236:239]
    ds_read_b64_tr_b16 v[74:75], v7 offset:30560
    v_mfma_f32_16x16x32_bf16 v[240:243], v[112:115], v[92:95], v[240:243]
    ds_read_b64_tr_b16 v[76:77], v7 offset:35936
    v_mfma_f32_16x16x32_bf16 v[244:247], v[116:119], v[92:95], v[244:247]
    ds_read_b64_tr_b16 v[78:79], v7 offset:37728
    v_mfma_f32_16x16x32_bf16 v[248:251], v[120:123], v[92:95], v[248:251]
    v_mfma_f32_16x16x32_bf16 v[252:255], v[124:127], v[92:95], v[252:255]
    s_waitcnt vmcnt(4) lgkmcnt(0)
    s_barrier
    v_add_u32 v6, s45, v29
    s_add_u32 s45, s45, 32768
    s_cmp_eq_u32 s45, 98304
    s_cselect_b32 s45, 0, s45
    s_nop 0
    s_add_u32 m0, s41, 18432
    s_nop 0
    buffer_load_dwordx4 v14, s[16:19], s30 offen lds
    v_mfma_f32_16x16x32_bf16 v[128:131], v[48:51], v[32:35], v[128:131]
    ds_read_b128 v[80:83], v6 offset:0
    v_mfma_f32_16x16x32_bf16 v[132:135], v[52:55], v[32:35], v[132:135]
    ds_read_b128 v[84:87], v6 offset:2048
    v_mfma_f32_16x16x32_bf16 v[136:139], v[56:59], v[32:35], v[136:139]
    v_mfma_f32_16x16x32_bf16 v[140:143], v[60:63], v[32:35], v[140:143]
    ds_read_b128 v[88:91], v6 offset:4096
    v_mfma_f32_16x16x32_bf16 v[144:147], v[64:67], v[32:35], v[144:147]
    ds_read_b128 v[92:95], v6 offset:6144
    v_mfma_f32_16x16x32_bf16 v[148:151], v[68:71], v[32:35], v[148:151]
    ds_read_b64_tr_b16 v[96:97], v7 offset:43008
    v_mfma_f32_16x16x32_bf16 v[152:155], v[72:75], v[32:35], v[152:155]
    v_mfma_f32_16x16x32_bf16 v[156:159], v[76:79], v[32:35], v[156:159]
    ds_read_b64_tr_b16 v[98:99], v7 offset:44800
    v_mfma_f32_16x16x32_bf16 v[160:163], v[48:51], v[36:39], v[160:163]
    ds_read_b64_tr_b16 v[100:101], v7 offset:50176
    v_mfma_f32_16x16x32_bf16 v[164:167], v[52:55], v[36:39], v[164:167]
    v_mfma_f32_16x16x32_bf16 v[168:171], v[56:59], v[36:39], v[168:171]
    s_add_u32 m0, s41, 19456
    s_nop 0
    buffer_load_dwordx4 v15, s[16:19], s30 offen lds
    v_mfma_f32_16x16x32_bf16 v[172:175], v[60:63], v[36:39], v[172:175]
    ds_read_b64_tr_b16 v[102:103], v7 offset:51968
    v_mfma_f32_16x16x32_bf16 v[176:179], v[64:67], v[36:39], v[176:179]
    ds_read_b64_tr_b16 v[104:105], v7 offset:43040
    v_mfma_f32_16x16x32_bf16 v[180:183], v[68:71], v[36:39], v[180:183]
    v_mfma_f32_16x16x32_bf16 v[184:187], v[72:75], v[36:39], v[184:187]
    ds_read_b64_tr_b16 v[106:107], v7 offset:44832
    v_mfma_f32_16x16x32_bf16 v[188:191], v[76:79], v[36:39], v[188:191]
    ds_read_b64_tr_b16 v[108:109], v7 offset:50208
    v_mfma_f32_16x16x32_bf16 v[192:195], v[48:51], v[40:43], v[192:195]
    v_mfma_f32_16x16x32_bf16 v[196:199], v[52:55], v[40:43], v[196:199]
    ds_read_b64_tr_b16 v[110:111], v7 offset:52000
    v_mfma_f32_16x16x32_bf16 v[200:203], v[56:59], v[40:43], v[200:203]
    ds_read_b64_tr_b16 v[112:113], v7 offset:43072
    v_mfma_f32_16x16x32_bf16 v[204:207], v[60:63], v[40:43], v[204:207]
    ds_read_b64_tr_b16 v[114:115], v7 offset:44864
    v_mfma_f32_16x16x32_bf16 v[208:211], v[64:67], v[40:43], v[208:211]
    v_mfma_f32_16x16x32_bf16 v[212:215], v[68:71], v[40:43], v[212:215]
    s_add_u32 m0, s41, 20480
    s_nop 0
    buffer_load_dwordx4 v16, s[16:19], s30 offen lds
    s_add_u32 s30, s30, 458752
    v_mfma_f32_16x16x32_bf16 v[216:219], v[72:75], v[40:43], v[216:219]
    ds_read_b64_tr_b16 v[116:117], v7 offset:50240
    v_mfma_f32_16x16x32_bf16 v[220:223], v[76:79], v[40:43], v[220:223]
    v_mfma_f32_16x16x32_bf16 v[224:227], v[48:51], v[44:47], v[224:227]
    ds_read_b64_tr_b16 v[118:119], v7 offset:52032
    v_mfma_f32_16x16x32_bf16 v[228:231], v[52:55], v[44:47], v[228:231]
    ds_read_b64_tr_b16 v[120:121], v7 offset:43104
    v_mfma_f32_16x16x32_bf16 v[232:235], v[56:59], v[44:47], v[232:235]
    ds_read_b64_tr_b16 v[122:123], v7 offset:44896
    v_mfma_f32_16x16x32_bf16 v[236:239], v[60:63], v[44:47], v[236:239]
    v_mfma_f32_16x16x32_bf16 v[240:243], v[64:67], v[44:47], v[240:243]
    ds_read_b64_tr_b16 v[124:125], v7 offset:50272
    v_mfma_f32_16x16x32_bf16 v[244:247], v[68:71], v[44:47], v[244:247]
    ds_read_b64_tr_b16 v[126:127], v7 offset:52064
    v_mfma_f32_16x16x32_bf16 v[248:251], v[72:75], v[44:47], v[248:251]
    v_mfma_f32_16x16x32_bf16 v[252:255], v[76:79], v[44:47], v[252:255]
    s_waitcnt vmcnt(63) lgkmcnt(0)
    s_barrier
    v_add_u32 v5, s45, v28
    s_nop 0
    s_add_u32 m0, s41, 43008
    s_nop 0
    buffer_load_dwordx4 v10, s[16:19], s30 offen lds
    v_mfma_f32_16x16x32_bf16 v[128:131], v[96:99], v[80:83], v[128:131]
    ds_read_b128 v[32:35], v5 offset:0
    v_mfma_f32_16x16x32_bf16 v[132:135], v[100:103], v[80:83], v[132:135]
    ds_read_b128 v[36:39], v5 offset:2048
    v_mfma_f32_16x16x32_bf16 v[136:139], v[104:107], v[80:83], v[136:139]
    v_mfma_f32_16x16x32_bf16 v[140:143], v[108:111], v[80:83], v[140:143]
    ds_read_b128 v[40:43], v5 offset:4096
    v_mfma_f32_16x16x32_bf16 v[144:147], v[112:115], v[80:83], v[144:147]
    ds_read_b128 v[44:47], v5 offset:6144
    v_mfma_f32_16x16x32_bf16 v[148:151], v[116:119], v[80:83], v[148:151]
    ds_read_b64_tr_b16 v[48:49], v7 offset:0
    v_mfma_f32_16x16x32_bf16 v[152:155], v[120:123], v[80:83], v[152:155]
    v_mfma_f32_16x16x32_bf16 v[156:159], v[124:127], v[80:83], v[156:159]
    s_add_u32 m0, s41, 44032
    s_nop 0
    buffer_load_dwordx4 v11, s[16:19], s30 offen lds
    v_mfma_f32_16x16x32_bf16 v[160:163], v[96:99], v[84:87], v[160:163]
    ds_read_b64_tr_b16 v[50:51], v7 offset:1792
    v_mfma_f32_16x16x32_bf16 v[164:167], v[100:103], v[84:87], v[164:167]
    ds_read_b64_tr_b16 v[52:53], v7 offset:7168
    v_mfma_f32_16x16x32_bf16 v[168:171], v[104:107], v[84:87], v[168:171]
    v_mfma_f32_16x16x32_bf16 v[172:175], v[108:111], v[84:87], v[172:175]
    ds_read_b64_tr_b16 v[54:55], v7 offset:8960
    v_mfma_f32_16x16x32_bf16 v[176:179], v[112:115], v[84:87], v[176:179]
    ds_read_b64_tr_b16 v[56:57], v7 offset:32
    v_mfma_f32_16x16x32_bf16 v[180:183], v[116:119], v[84:87], v[180:183]
    ds_read_b64_tr_b16 v[58:59], v7 offset:1824
    v_mfma_f32_16x16x32_bf16 v[184:187], v[120:123], v[84:87], v[184:187]
    v_mfma_f32_16x16x32_bf16 v[188:191], v[124:127], v[84:87], v[188:191]
    s_add_u32 m0, s41, 45056
    s_nop 0
    buffer_load_dwordx4 v12, s[16:19], s30 offen lds
    v_mfma_f32_16x16x32_bf16 v[192:195], v[96:99], v[88:91], v[192:195]
    ds_read_b64_tr_b16 v[60:61], v7 offset:7200
    v_mfma_f32_16x16x32_bf16 v[196:199], v[100:103], v[88:91], v[196:199]
    ds_read_b64_tr_b16 v[62:63], v7 offset:8992
    v_mfma_f32_16x16x32_bf16 v[200:203], v[104:107], v[88:91], v[200:203]
    v_mfma_f32_16x16x32_bf16 v[204:207], v[108:111], v[88:91], v[204:207]
    ds_read_b64_tr_b16 v[64:65], v7 offset:64
    v_mfma_f32_16x16x32_bf16 v[208:211], v[112:115], v[88:91], v[208:211]
    ds_read_b64_tr_b16 v[66:67], v7 offset:1856
    v_mfma_f32_16x16x32_bf16 v[212:215], v[116:119], v[88:91], v[212:215]
    ds_read_b64_tr_b16 v[68:69], v7 offset:7232
    v_mfma_f32_16x16x32_bf16 v[216:219], v[120:123], v[88:91], v[216:219]
    v_mfma_f32_16x16x32_bf16 v[220:223], v[124:127], v[88:91], v[220:223]
    s_add_u32 m0, s41, 46080
    s_nop 0
    buffer_load_dwordx4 v13, s[16:19], s30 offen lds
    v_mfma_f32_16x16x32_bf16 v[224:227], v[96:99], v[92:95], v[224:227]
    ds_read_b64_tr_b16 v[70:71], v7 offset:9024
    v_mfma_f32_16x16x32_bf16 v[228:231], v[100:103], v[92:95], v[228:231]
    ds_read_b64_tr_b16 v[72:73], v7 offset:96
    v_mfma_f32_16x16x32_bf16 v[232:235], v[104:107], v[92:95], v[232:235]
    v_mfma_f32_16x16x32_bf16 v[236:239], v[108:111], v[92:95], v[236:239]
    ds_read_b64_tr_b16 v[74:75], v7 offset:1888
    v_mfma_f32_16x16x32_bf16 v[240:243], v[112:115], v[92:95], v[240:243]
    ds_read_b64_tr_b16 v[76:77], v7 offset:7264
    v_mfma_f32_16x16x32_bf16 v[244:247], v[116:119], v[92:95], v[244:247]
    ds_read_b64_tr_b16 v[78:79], v7 offset:9056
    v_mfma_f32_16x16x32_bf16 v[248:251], v[120:123], v[92:95], v[248:251]
    v_mfma_f32_16x16x32_bf16 v[252:255], v[124:127], v[92:95], v[252:255]
    s_waitcnt vmcnt(4) lgkmcnt(0)
    s_barrier
    v_add_u32 v6, s45, v29
    s_add_u32 s45, s45, 32768
    s_cmp_eq_u32 s45, 98304
    s_cselect_b32 s45, 0, s45
    s_nop 0
    s_add_u32 m0, s41, 47104
    s_nop 0
    buffer_load_dwordx4 v14, s[16:19], s30 offen lds
    v_mfma_f32_16x16x32_bf16 v[128:131], v[48:51], v[32:35], v[128:131]
    ds_read_b128 v[80:83], v6 offset:0
    v_mfma_f32_16x16x32_bf16 v[132:135], v[52:55], v[32:35], v[132:135]
    ds_read_b128 v[84:87], v6 offset:2048
    v_mfma_f32_16x16x32_bf16 v[136:139], v[56:59], v[32:35], v[136:139]
    v_mfma_f32_16x16x32_bf16 v[140:143], v[60:63], v[32:35], v[140:143]
    ds_read_b128 v[88:91], v6 offset:4096
    v_mfma_f32_16x16x32_bf16 v[144:147], v[64:67], v[32:35], v[144:147]
    ds_read_b128 v[92:95], v6 offset:6144
    v_mfma_f32_16x16x32_bf16 v[148:151], v[68:71], v[32:35], v[148:151]
    ds_read_b64_tr_b16 v[96:97], v7 offset:14336
    v_mfma_f32_16x16x32_bf16 v[152:155], v[72:75], v[32:35], v[152:155]
    v_mfma_f32_16x16x32_bf16 v[156:159], v[76:79], v[32:35], v[156:159]
    ds_read_b64_tr_b16 v[98:99], v7 offset:16128
    v_mfma_f32_16x16x32_bf16 v[160:163], v[48:51], v[36:39], v[160:163]
    ds_read_b64_tr_b16 v[100:101], v7 offset:21504
    v_mfma_f32_16x16x32_bf16 v[164:167], v[52:55], v[36:39], v[164:167]
    v_mfma_f32_16x16x32_bf16 v[168:171], v[56:59], v[36:39], v[168:171]
    s_add_u32 m0, s41, 48128
    s_nop 0
    buffer_load_dwordx4 v15, s[16:19], s30 offen lds
    v_mfma_f32_16x16x32_bf16 v[172:175], v[60:63], v[36:39], v[172:175]
    ds_read_b64_tr_b16 v[102:103], v7 offset:23296
    v_mfma_f32_16x16x32_bf16 v[176:179], v[64:67], v[36:39], v[176:179]
    ds_read_b64_tr_b16 v[104:105], v7 offset:14368
    v_mfma_f32_16x16x32_bf16 v[180:183], v[68:71], v[36:39], v[180:183]
    v_mfma_f32_16x16x32_bf16 v[184:187], v[72:75], v[36:39], v[184:187]
    ds_read_b64_tr_b16 v[106:107], v7 offset:16160
    v_mfma_f32_16x16x32_bf16 v[188:191], v[76:79], v[36:39], v[188:191]
    ds_read_b64_tr_b16 v[108:109], v7 offset:21536
    v_mfma_f32_16x16x32_bf16 v[192:195], v[48:51], v[40:43], v[192:195]
    v_mfma_f32_16x16x32_bf16 v[196:199], v[52:55], v[40:43], v[196:199]
    ds_read_b64_tr_b16 v[110:111], v7 offset:23328
    v_mfma_f32_16x16x32_bf16 v[200:203], v[56:59], v[40:43], v[200:203]
    ds_read_b64_tr_b16 v[112:113], v7 offset:14400
    v_mfma_f32_16x16x32_bf16 v[204:207], v[60:63], v[40:43], v[204:207]
    ds_read_b64_tr_b16 v[114:115], v7 offset:16192
    v_mfma_f32_16x16x32_bf16 v[208:211], v[64:67], v[40:43], v[208:211]
    v_mfma_f32_16x16x32_bf16 v[212:215], v[68:71], v[40:43], v[212:215]
    s_add_u32 m0, s41, 49152
    s_nop 0
    buffer_load_dwordx4 v16, s[16:19], s30 offen lds
    s_add_u32 s30, s30, 458752
    v_mfma_f32_16x16x32_bf16 v[216:219], v[72:75], v[40:43], v[216:219]
    ds_read_b64_tr_b16 v[116:117], v7 offset:21568
    v_mfma_f32_16x16x32_bf16 v[220:223], v[76:79], v[40:43], v[220:223]
    v_mfma_f32_16x16x32_bf16 v[224:227], v[48:51], v[44:47], v[224:227]
    ds_read_b64_tr_b16 v[118:119], v7 offset:23360
    v_mfma_f32_16x16x32_bf16 v[228:231], v[52:55], v[44:47], v[228:231]
    ds_read_b64_tr_b16 v[120:121], v7 offset:14432
    v_mfma_f32_16x16x32_bf16 v[232:235], v[56:59], v[44:47], v[232:235]
    ds_read_b64_tr_b16 v[122:123], v7 offset:16224
    v_mfma_f32_16x16x32_bf16 v[236:239], v[60:63], v[44:47], v[236:239]
    v_mfma_f32_16x16x32_bf16 v[240:243], v[64:67], v[44:47], v[240:243]
    ds_read_b64_tr_b16 v[124:125], v7 offset:21600
    v_mfma_f32_16x16x32_bf16 v[244:247], v[68:71], v[44:47], v[244:247]
    ds_read_b64_tr_b16 v[126:127], v7 offset:23392
    v_mfma_f32_16x16x32_bf16 v[248:251], v[72:75], v[44:47], v[248:251]
    v_mfma_f32_16x16x32_bf16 v[252:255], v[76:79], v[44:47], v[252:255]
    s_waitcnt vmcnt(63) lgkmcnt(0)
    s_barrier
    v_add_u32 v5, s45, v28
    s_nop 0
    ds_read_b128 v[32:35], v5 offset:0
    v_mfma_f32_16x16x32_bf16 v[128:131], v[96:99], v[80:83], v[128:131]
    ds_read_b128 v[36:39], v5 offset:2048
    v_mfma_f32_16x16x32_bf16 v[132:135], v[100:103], v[80:83], v[132:135]
    v_mfma_f32_16x16x32_bf16 v[136:139], v[104:107], v[80:83], v[136:139]
    ds_read_b128 v[40:43], v5 offset:4096
    v_mfma_f32_16x16x32_bf16 v[140:143], v[108:111], v[80:83], v[140:143]
    ds_read_b128 v[44:47], v5 offset:6144
    v_mfma_f32_16x16x32_bf16 v[144:147], v[112:115], v[80:83], v[144:147]
    v_mfma_f32_16x16x32_bf16 v[148:151], v[116:119], v[80:83], v[148:151]
    ds_read_b64_tr_b16 v[48:49], v7 offset:28672
    v_mfma_f32_16x16x32_bf16 v[152:155], v[120:123], v[80:83], v[152:155]
    v_mfma_f32_16x16x32_bf16 v[156:159], v[124:127], v[80:83], v[156:159]
    ds_read_b64_tr_b16 v[50:51], v7 offset:30464
    v_mfma_f32_16x16x32_bf16 v[160:163], v[96:99], v[84:87], v[160:163]
    ds_read_b64_tr_b16 v[52:53], v7 offset:35840
    v_mfma_f32_16x16x32_bf16 v[164:167], v[100:103], v[84:87], v[164:167]
    v_mfma_f32_16x16x32_bf16 v[168:171], v[104:107], v[84:87], v[168:171]
    ds_read_b64_tr_b16 v[54:55], v7 offset:37632
    v_mfma_f32_16x16x32_bf16 v[172:175], v[108:111], v[84:87], v[172:175]
    ds_read_b64_tr_b16 v[56:57], v7 offset:28704
    v_mfma_f32_16x16x32_bf16 v[176:179], v[112:115], v[84:87], v[176:179]
    v_mfma_f32_16x16x32_bf16 v[180:183], v[116:119], v[84:87], v[180:183]
    ds_read_b64_tr_b16 v[58:59], v7 offset:30496
    v_mfma_f32_16x16x32_bf16 v[184:187], v[120:123], v[84:87], v[184:187]
    v_mfma_f32_16x16x32_bf16 v[188:191], v[124:127], v[84:87], v[188:191]
    ds_read_b64_tr_b16 v[60:61], v7 offset:35872
    v_mfma_f32_16x16x32_bf16 v[192:195], v[96:99], v[88:91], v[192:195]
    ds_read_b64_tr_b16 v[62:63], v7 offset:37664
    v_mfma_f32_16x16x32_bf16 v[196:199], v[100:103], v[88:91], v[196:199]
    v_mfma_f32_16x16x32_bf16 v[200:203], v[104:107], v[88:91], v[200:203]
    ds_read_b64_tr_b16 v[64:65], v7 offset:28736
    v_mfma_f32_16x16x32_bf16 v[204:207], v[108:111], v[88:91], v[204:207]
    ds_read_b64_tr_b16 v[66:67], v7 offset:30528
    v_mfma_f32_16x16x32_bf16 v[208:211], v[112:115], v[88:91], v[208:211]
    v_mfma_f32_16x16x32_bf16 v[212:215], v[116:119], v[88:91], v[212:215]
    ds_read_b64_tr_b16 v[68:69], v7 offset:35904
    v_mfma_f32_16x16x32_bf16 v[216:219], v[120:123], v[88:91], v[216:219]
    v_mfma_f32_16x16x32_bf16 v[220:223], v[124:127], v[88:91], v[220:223]
    ds_read_b64_tr_b16 v[70:71], v7 offset:37696
    v_mfma_f32_16x16x32_bf16 v[224:227], v[96:99], v[92:95], v[224:227]
    ds_read_b64_tr_b16 v[72:73], v7 offset:28768
    v_mfma_f32_16x16x32_bf16 v[228:231], v[100:103], v[92:95], v[228:231]
    v_mfma_f32_16x16x32_bf16 v[232:235], v[104:107], v[92:95], v[232:235]
    ds_read_b64_tr_b16 v[74:75], v7 offset:30560
    v_mfma_f32_16x16x32_bf16 v[236:239], v[108:111], v[92:95], v[236:239]
    ds_read_b64_tr_b16 v[76:77], v7 offset:35936
    v_mfma_f32_16x16x32_bf16 v[240:243], v[112:115], v[92:95], v[240:243]
    v_mfma_f32_16x16x32_bf16 v[244:247], v[116:119], v[92:95], v[244:247]
    ds_read_b64_tr_b16 v[78:79], v7 offset:37728
    v_mfma_f32_16x16x32_bf16 v[248:251], v[120:123], v[92:95], v[248:251]
    v_mfma_f32_16x16x32_bf16 v[252:255], v[124:127], v[92:95], v[252:255]
    s_waitcnt vmcnt(0) lgkmcnt(0)
    s_barrier
    v_add_u32 v6, s45, v29
    s_add_u32 s45, s45, 32768
    s_cmp_eq_u32 s45, 98304
    s_cselect_b32 s45, 0, s45
    s_nop 0
    ds_read_b128 v[80:83], v6 offset:0
    v_mfma_f32_16x16x32_bf16 v[128:131], v[48:51], v[32:35], v[128:131]
    ds_read_b128 v[84:87], v6 offset:2048
    v_mfma_f32_16x16x32_bf16 v[132:135], v[52:55], v[32:35], v[132:135]
    v_mfma_f32_16x16x32_bf16 v[136:139], v[56:59], v[32:35], v[136:139]
    ds_read_b128 v[88:91], v6 offset:4096
    v_mfma_f32_16x16x32_bf16 v[140:143], v[60:63], v[32:35], v[140:143]
    ds_read_b128 v[92:95], v6 offset:6144
    v_mfma_f32_16x16x32_bf16 v[144:147], v[64:67], v[32:35], v[144:147]
    v_mfma_f32_16x16x32_bf16 v[148:151], v[68:71], v[32:35], v[148:151]
    ds_read_b64_tr_b16 v[96:97], v7 offset:43008
    v_mfma_f32_16x16x32_bf16 v[152:155], v[72:75], v[32:35], v[152:155]
    v_mfma_f32_16x16x32_bf16 v[156:159], v[76:79], v[32:35], v[156:159]
    ds_read_b64_tr_b16 v[98:99], v7 offset:44800
    v_mfma_f32_16x16x32_bf16 v[160:163], v[48:51], v[36:39], v[160:163]
    ds_read_b64_tr_b16 v[100:101], v7 offset:50176
    v_mfma_f32_16x16x32_bf16 v[164:167], v[52:55], v[36:39], v[164:167]
    v_mfma_f32_16x16x32_bf16 v[168:171], v[56:59], v[36:39], v[168:171]
    ds_read_b64_tr_b16 v[102:103], v7 offset:51968
    v_mfma_f32_16x16x32_bf16 v[172:175], v[60:63], v[36:39], v[172:175]
    ds_read_b64_tr_b16 v[104:105], v7 offset:43040
    v_mfma_f32_16x16x32_bf16 v[176:179], v[64:67], v[36:39], v[176:179]
    v_mfma_f32_16x16x32_bf16 v[180:183], v[68:71], v[36:39], v[180:183]
    ds_read_b64_tr_b16 v[106:107], v7 offset:44832
    v_mfma_f32_16x16x32_bf16 v[184:187], v[72:75], v[36:39], v[184:187]
    v_mfma_f32_16x16x32_bf16 v[188:191], v[76:79], v[36:39], v[188:191]
    ds_read_b64_tr_b16 v[108:109], v7 offset:50208
    v_mfma_f32_16x16x32_bf16 v[192:195], v[48:51], v[40:43], v[192:195]
    ds_read_b64_tr_b16 v[110:111], v7 offset:52000
    v_mfma_f32_16x16x32_bf16 v[196:199], v[52:55], v[40:43], v[196:199]
    v_mfma_f32_16x16x32_bf16 v[200:203], v[56:59], v[40:43], v[200:203]
    ds_read_b64_tr_b16 v[112:113], v7 offset:43072
    v_mfma_f32_16x16x32_bf16 v[204:207], v[60:63], v[40:43], v[204:207]
    ds_read_b64_tr_b16 v[114:115], v7 offset:44864
    v_mfma_f32_16x16x32_bf16 v[208:211], v[64:67], v[40:43], v[208:211]
    v_mfma_f32_16x16x32_bf16 v[212:215], v[68:71], v[40:43], v[212:215]
    ds_read_b64_tr_b16 v[116:117], v7 offset:50240
    v_mfma_f32_16x16x32_bf16 v[216:219], v[72:75], v[40:43], v[216:219]
    v_mfma_f32_16x16x32_bf16 v[220:223], v[76:79], v[40:43], v[220:223]
    ds_read_b64_tr_b16 v[118:119], v7 offset:52032
    v_mfma_f32_16x16x32_bf16 v[224:227], v[48:51], v[44:47], v[224:227]
    ds_read_b64_tr_b16 v[120:121], v7 offset:43104
    v_mfma_f32_16x16x32_bf16 v[228:231], v[52:55], v[44:47], v[228:231]
    v_mfma_f32_16x16x32_bf16 v[232:235], v[56:59], v[44:47], v[232:235]
    ds_read_b64_tr_b16 v[122:123], v7 offset:44896
    v_mfma_f32_16x16x32_bf16 v[236:239], v[60:63], v[44:47], v[236:239]
    ds_read_b64_tr_b16 v[124:125], v7 offset:50272
    v_mfma_f32_16x16x32_bf16 v[240:243], v[64:67], v[44:47], v[240:243]
    v_mfma_f32_16x16x32_bf16 v[244:247], v[68:71], v[44:47], v[244:247]
    ds_read_b64_tr_b16 v[126:127], v7 offset:52064
    v_mfma_f32_16x16x32_bf16 v[248:251], v[72:75], v[44:47], v[248:251]
    v_mfma_f32_16x16x32_bf16 v[252:255], v[76:79], v[44:47], v[252:255]
    s_waitcnt vmcnt(63) lgkmcnt(0)
    v_mfma_f32_16x16x32_bf16 v[128:131], v[96:99], v[80:83], v[128:131]
    v_mfma_f32_16x16x32_bf16 v[132:135], v[100:103], v[80:83], v[132:135]
    v_mfma_f32_16x16x32_bf16 v[136:139], v[104:107], v[80:83], v[136:139]
    v_mfma_f32_16x16x32_bf16 v[140:143], v[108:111], v[80:83], v[140:143]
    v_mfma_f32_16x16x32_bf16 v[144:147], v[112:115], v[80:83], v[144:147]
    v_mfma_f32_16x16x32_bf16 v[148:151], v[116:119], v[80:83], v[148:151]
    v_mfma_f32_16x16x32_bf16 v[152:155], v[120:123], v[80:83], v[152:155]
    v_mfma_f32_16x16x32_bf16 v[156:159], v[124:127], v[80:83], v[156:159]
    v_mfma_f32_16x16x32_bf16 v[160:163], v[96:99], v[84:87], v[160:163]
    v_mfma_f32_16x16x32_bf16 v[164:167], v[100:103], v[84:87], v[164:167]
    v_mfma_f32_16x16x32_bf16 v[168:171], v[104:107], v[84:87], v[168:171]
    v_mfma_f32_16x16x32_bf16 v[172:175], v[108:111], v[84:87], v[172:175]
    v_mfma_f32_16x16x32_bf16 v[176:179], v[112:115], v[84:87], v[176:179]
    v_mfma_f32_16x16x32_bf16 v[180:183], v[116:119], v[84:87], v[180:183]
    v_mfma_f32_16x16x32_bf16 v[184:187], v[120:123], v[84:87], v[184:187]
    v_mfma_f32_16x16x32_bf16 v[188:191], v[124:127], v[84:87], v[188:191]
    v_mfma_f32_16x16x32_bf16 v[192:195], v[96:99], v[88:91], v[192:195]
    v_mfma_f32_16x16x32_bf16 v[196:199], v[100:103], v[88:91], v[196:199]
    v_mfma_f32_16x16x32_bf16 v[200:203], v[104:107], v[88:91], v[200:203]
    v_mfma_f32_16x16x32_bf16 v[204:207], v[108:111], v[88:91], v[204:207]
    v_mfma_f32_16x16x32_bf16 v[208:211], v[112:115], v[88:91], v[208:211]
    v_mfma_f32_16x16x32_bf16 v[212:215], v[116:119], v[88:91], v[212:215]
    v_mfma_f32_16x16x32_bf16 v[216:219], v[120:123], v[88:91], v[216:219]
    v_mfma_f32_16x16x32_bf16 v[220:223], v[124:127], v[88:91], v[220:223]
    v_mfma_f32_16x16x32_bf16 v[224:227], v[96:99], v[92:95], v[224:227]
    v_mfma_f32_16x16x32_bf16 v[228:231], v[100:103], v[92:95], v[228:231]
    v_mfma_f32_16x16x32_bf16 v[232:235], v[104:107], v[92:95], v[232:235]
    v_mfma_f32_16x16x32_bf16 v[236:239], v[108:111], v[92:95], v[236:239]
    v_mfma_f32_16x16x32_bf16 v[240:243], v[112:115], v[92:95], v[240:243]
    v_mfma_f32_16x16x32_bf16 v[244:247], v[116:119], v[92:95], v[244:247]
    v_mfma_f32_16x16x32_bf16 v[248:251], v[120:123], v[92:95], v[248:251]
    v_mfma_f32_16x16x32_bf16 v[252:255], v[124:127], v[92:95], v[252:255]
    s_nop 7
    s_nop 7

    s_and_b32 s57, s57, 0xffff
    s_mov_b32 s58, 7340032
    s_mov_b32 s59, 0x20000
    s_mul_i32 s32, s2, 28672
    s_lshl_b32 s40, s24, 12
    s_add_u32 s32, s32, s40
    v_lshlrev_b32 v27, 4, v2

    s_cmp_eq_u32 s24, 7
    s_cbranch_scc1 K1T01_NOPF
    buffer_load_dwordx4 v[96:99], v27, s[56:59], s32 offen offset:0
    buffer_load_dwordx4 v[100:103], v27, s[56:59], s32 offen offset:1024
    buffer_load_dwordx4 v[104:107], v27, s[56:59], s32 offen offset:2048
    buffer_load_dwordx4 v[108:111], v27, s[56:59], s32 offen offset:3072
K1T01_NOPF:
    s_branch K1_EPI0
K1_TYPE1:
    s_mov_b32 s30, 0
    s_mov_b32 s45, 0
    s_mov_b32 s46, s41
    s_mov_b32 s70, 0
    v_mov_b32 v26, 0
    s_add_u32 m0, s46, 0
    s_add_u32 s32, s30, 0
    buffer_load_dwordx4 v22, s[12:15], s32 offen lds
    s_add_u32 m0, s46, 1024
    s_add_u32 s32, s30, 16384
    buffer_load_dwordx4 v22, s[12:15], s32 offen lds
    s_add_u32 m0, s46, 2048
    s_add_u32 s32, s30, 32768
    buffer_load_dwordx4 v22, s[12:15], s32 offen lds
    s_add_u32 m0, s46, 3072
    s_add_u32 s32, s30, 49152
    buffer_load_dwordx4 v22, s[12:15], s32 offen lds
    s_add_u32 m0, s46, 4096
    s_add_u32 s32, s30, 65536
    buffer_load_dwordx4 v22, s[12:15], s32 offen lds
    s_add_u32 m0, s46, 5120
    s_add_u32 s32, s30, 81920
    buffer_load_dwordx4 v22, s[12:15], s32 offen lds
    s_add_u32 m0, s46, 6144
    s_add_u32 s32, s30, 98304
    buffer_load_dwordx4 v22, s[12:15], s32 offen lds
    s_add_u32 m0, s46, 7168
    s_add_u32 s32, s30, 114688
    buffer_load_dwordx4 v22, s[12:15], s32 offen lds
    s_add_u32 s30, s30, 128
    s_add_u32 s46, s46, 32768
    s_add_u32 s32, s41, 98304
    s_cmp_eq_u32 s46, s32
    s_cselect_b32 s46, s41, s46
    s_add_u32 m0, s46, 0
    s_add_u32 s32, s30, 0
    buffer_load_dwordx4 v22, s[12:15], s32 offen lds
    s_add_u32 m0, s46, 1024
    s_add_u32 s32, s30, 16384
    buffer_load_dwordx4 v22, s[12:15], s32 offen lds
    s_add_u32 m0, s46, 2048
    s_add_u32 s32, s30, 32768
    buffer_load_dwordx4 v22, s[12:15], s32 offen lds
    s_add_u32 m0, s46, 3072
    s_add_u32 s32, s30, 49152
    buffer_load_dwordx4 v22, s[12:15], s32 offen lds
    s_add_u32 m0, s46, 4096
    s_add_u32 s32, s30, 65536
    buffer_load_dwordx4 v22, s[12:15], s32 offen lds
    s_add_u32 m0, s46, 5120
    s_add_u32 s32, s30, 81920
    buffer_load_dwordx4 v22, s[12:15], s32 offen lds
    s_add_u32 m0, s46, 6144
    s_add_u32 s32, s30, 98304
    buffer_load_dwordx4 v22, s[12:15], s32 offen lds
    s_add_u32 m0, s46, 7168
    s_add_u32 s32, s30, 114688
    buffer_load_dwordx4 v22, s[12:15], s32 offen lds
    s_add_u32 s30, s30, 128
    s_add_u32 s46, s46, 32768
    s_add_u32 s32, s41, 98304
    s_cmp_eq_u32 s46, s32
    s_cselect_b32 s46, s41, s46
    v_mov_b32 v128, 0
    v_mov_b32 v129, 0
    v_mov_b32 v130, 0
    v_mov_b32 v131, 0
    v_mov_b32 v132, 0
    v_mov_b32 v133, 0
    v_mov_b32 v134, 0
    v_mov_b32 v135, 0
    v_mov_b32 v136, 0
    v_mov_b32 v137, 0
    v_mov_b32 v138, 0
    v_mov_b32 v139, 0
    v_mov_b32 v140, 0
    v_mov_b32 v141, 0
    v_mov_b32 v142, 0
    v_mov_b32 v143, 0
    v_mov_b32 v144, 0
    v_mov_b32 v145, 0
    v_mov_b32 v146, 0
    v_mov_b32 v147, 0
    v_mov_b32 v148, 0
    v_mov_b32 v149, 0
    v_mov_b32 v150, 0
    v_mov_b32 v151, 0
    v_mov_b32 v152, 0
    v_mov_b32 v153, 0
    v_mov_b32 v154, 0
    v_mov_b32 v155, 0
    v_mov_b32 v156, 0
    v_mov_b32 v157, 0
    v_mov_b32 v158, 0
    v_mov_b32 v159, 0
    v_mov_b32 v160, 0
    v_mov_b32 v161, 0
    v_mov_b32 v162, 0
    v_mov_b32 v163, 0
    v_mov_b32 v164, 0
    v_mov_b32 v165, 0
    v_mov_b32 v166, 0
    v_mov_b32 v167, 0
    v_mov_b32 v168, 0
    v_mov_b32 v169, 0
    v_mov_b32 v170, 0
    v_mov_b32 v171, 0
    v_mov_b32 v172, 0
    v_mov_b32 v173, 0
    v_mov_b32 v174, 0
    v_mov_b32 v175, 0
    v_mov_b32 v176, 0
    v_mov_b32 v177, 0
    v_mov_b32 v178, 0
    v_mov_b32 v179, 0
    v_mov_b32 v180, 0
    v_mov_b32 v181, 0
    v_mov_b32 v182, 0
    v_mov_b32 v183, 0
    v_mov_b32 v184, 0
    v_mov_b32 v185, 0
    v_mov_b32 v186, 0
    v_mov_b32 v187, 0
    v_mov_b32 v188, 0
    v_mov_b32 v189, 0
    v_mov_b32 v190, 0
    v_mov_b32 v191, 0
    v_mov_b32 v192, 0
    v_mov_b32 v193, 0
    v_mov_b32 v194, 0
    v_mov_b32 v195, 0
    v_mov_b32 v196, 0
    v_mov_b32 v197, 0
    v_mov_b32 v198, 0
    v_mov_b32 v199, 0
    v_mov_b32 v200, 0
    v_mov_b32 v201, 0
    v_mov_b32 v202, 0
    v_mov_b32 v203, 0
    v_mov_b32 v204, 0
    v_mov_b32 v205, 0
    v_mov_b32 v206, 0
    v_mov_b32 v207, 0
    v_mov_b32 v208, 0
    v_mov_b32 v209, 0
    v_mov_b32 v210, 0
    v_mov_b32 v211, 0
    v_mov_b32 v212, 0
    v_mov_b32 v213, 0
    v_mov_b32 v214, 0
    v_mov_b32 v215, 0
    v_mov_b32 v216, 0
    v_mov_b32 v217, 0
    v_mov_b32 v218, 0
    v_mov_b32 v219, 0
    v_mov_b32 v220, 0
    v_mov_b32 v221, 0
    v_mov_b32 v222, 0
    v_mov_b32 v223, 0
    s_waitcnt vmcnt(8)
    s_barrier
    v_add_u32 v5, s45, v28
    s_nop 0
    s_add_u32 m0, s46, 0
    s_add_u32 s32, s30, 0
    buffer_load_dwordx4 v22, s[12:15], s32 offen lds
    ds_read_b128 v[32:35], v5 offset:0
    ds_read_b128 v[36:39], v5 offset:2048
    ds_read_b128 v[40:43], v5 offset:4096
    ds_read_b128 v[44:47], v5 offset:6144
    s_add_u32 m0, s46, 1024
    s_add_u32 s32, s30, 16384
    buffer_load_dwordx4 v22, s[12:15], s32 offen lds
    ds_read_b64_tr_b16 v[48:49], v7 offset:0
    ds_read_b64_tr_b16 v[50:51], v7 offset:1792
    ds_read_b64_tr_b16 v[52:53], v7 offset:7168
    s_add_u32 m0, s46, 2048
    s_add_u32 s32, s30, 32768
    buffer_load_dwordx4 v22, s[12:15], s32 offen lds
    ds_read_b64_tr_b16 v[54:55], v7 offset:8960
    ds_read_b64_tr_b16 v[56:57], v7 offset:32
    ds_read_b64_tr_b16 v[58:59], v7 offset:1824
    s_add_u32 m0, s46, 3072
    s_add_u32 s32, s30, 49152
    buffer_load_dwordx4 v22, s[12:15], s32 offen lds
    ds_read_b64_tr_b16 v[60:61], v7 offset:7200
    ds_read_b64_tr_b16 v[62:63], v7 offset:8992
    ds_read_b64_tr_b16 v[64:65], v8 offset:0
    s_mov_b32 m0, 155648
    s_add_u32 s32, s69, 0
    buffer_load_dwordx4 v30, s[12:15], s32 offen lds
    ds_read_b64_tr_b16 v[66:67], v8 offset:1792
    ds_read_b64_tr_b16 v[68:69], v8 offset:7168
    ds_read_b64_tr_b16 v[70:71], v8 offset:8960
    s_waitcnt vmcnt(13) lgkmcnt(0)
    s_barrier
    v_add_u32 v6, s45, v29
    s_add_u32 s45, s45, 32768
    s_cmp_eq_u32 s45, 98304
    s_cselect_b32 s45, 0, s45
    s_nop 0
    s_add_u32 m0, s46, 4096
    s_add_u32 s32, s30, 65536
    buffer_load_dwordx4 v22, s[12:15], s32 offen lds
    v_mfma_f32_16x16x32_bf16 v[128:131], v[48:51], v[32:35], v[128:131]
    ds_read_b128 v[80:83], v6 offset:0
    v_mfma_f32_16x16x32_bf16 v[132:135], v[52:55], v[32:35], v[132:135]
    ds_read_b128 v[84:87], v6 offset:2048
    v_mfma_f32_16x16x32_bf16 v[136:139], v[56:59], v[32:35], v[136:139]
    ds_read_b128 v[88:91], v6 offset:4096
    v_mfma_f32_16x16x32_bf16 v[140:143], v[60:63], v[32:35], v[140:143]
    ds_read_b128 v[92:95], v6 offset:6144
    v_mfma_f32_16x16x32_bf16 v[144:147], v[64:67], v[32:35], v[144:147]
    s_add_u32 m0, s46, 5120
    s_add_u32 s32, s30, 81920
    buffer_load_dwordx4 v22, s[12:15], s32 offen lds
    v_mfma_f32_16x16x32_bf16 v[148:151], v[68:71], v[32:35], v[148:151]
    ds_read_b64_tr_b16 v[96:97], v7 offset:14336
    v_mfma_f32_16x16x32_bf16 v[152:155], v[48:51], v[36:39], v[152:155]
    v_mfma_f32_16x16x32_bf16 v[156:159], v[52:55], v[36:39], v[156:159]
    ds_read_b64_tr_b16 v[98:99], v7 offset:16128
    v_mfma_f32_16x16x32_bf16 v[160:163], v[56:59], v[36:39], v[160:163]
    ds_read_b64_tr_b16 v[100:101], v7 offset:21504
    v_mfma_f32_16x16x32_bf16 v[164:167], v[60:63], v[36:39], v[164:167]
    s_add_u32 m0, s46, 6144
    s_add_u32 s32, s30, 98304
    buffer_load_dwordx4 v22, s[12:15], s32 offen lds
    v_mfma_f32_16x16x32_bf16 v[168:171], v[64:67], v[36:39], v[168:171]
    ds_read_b64_tr_b16 v[102:103], v7 offset:23296
    v_mfma_f32_16x16x32_bf16 v[172:175], v[68:71], v[36:39], v[172:175]
    ds_read_b64_tr_b16 v[104:105], v7 offset:14368
    v_mfma_f32_16x16x32_bf16 v[176:179], v[48:51], v[40:43], v[176:179]
    ds_read_b64_tr_b16 v[106:107], v7 offset:16160
    v_mfma_f32_16x16x32_bf16 v[180:183], v[52:55], v[40:43], v[180:183]
    s_add_u32 m0, s46, 7168
    s_add_u32 s32, s30, 114688
    buffer_load_dwordx4 v22, s[12:15], s32 offen lds
    s_add_u32 s30, s30, 128
    s_add_u32 s46, s46, 32768
    s_add_u32 s32, s41, 98304
    s_cmp_eq_u32 s46, s32
    s_cselect_b32 s46, s41, s46
    v_mfma_f32_16x16x32_bf16 v[184:187], v[56:59], v[40:43], v[184:187]
    v_mfma_f32_16x16x32_bf16 v[188:191], v[60:63], v[40:43], v[188:191]
    ds_read_b64_tr_b16 v[108:109], v7 offset:21536
    v_mfma_f32_16x16x32_bf16 v[192:195], v[64:67], v[40:43], v[192:195]
    ds_read_b64_tr_b16 v[110:111], v7 offset:23328
    v_mfma_f32_16x16x32_bf16 v[196:199], v[68:71], v[40:43], v[196:199]
    ds_read_b64_tr_b16 v[112:113], v8 offset:14336
    v_mfma_f32_16x16x32_bf16 v[200:203], v[48:51], v[44:47], v[200:203]
    s_mov_b32 m0, 155648
    s_add_u32 s32, s68, 0
    buffer_load_dwordx4 v30, s[64:67], s32 offen lds
    v_mfma_f32_16x16x32_bf16 v[204:207], v[52:55], v[44:47], v[204:207]
    ds_read_b64_tr_b16 v[114:115], v8 offset:16128
    v_mfma_f32_16x16x32_bf16 v[208:211], v[56:59], v[44:47], v[208:211]
    ds_read_b64_tr_b16 v[116:117], v8 offset:21504
    v_mfma_f32_16x16x32_bf16 v[212:215], v[60:63], v[44:47], v[212:215]
    ds_read_b64_tr_b16 v[118:119], v8 offset:23296
    v_mfma_f32_16x16x32_bf16 v[216:219], v[64:67], v[44:47], v[216:219]
    v_mfma_f32_16x16x32_bf16 v[220:223], v[68:71], v[44:47], v[220:223]
    s_waitcnt vmcnt(10) lgkmcnt(0)
    s_barrier
    v_add_u32 v5, s45, v28
    s_nop 0
    s_add_u32 m0, s46, 0
    s_add_u32 s32, s30, 0
    buffer_load_dwordx4 v22, s[12:15], s32 offen lds
    v_mfma_f32_16x16x32_bf16 v[128:131], v[96:99], v[80:83], v[128:131]
    ds_read_b128 v[32:35], v5 offset:0
    v_mfma_f32_16x16x32_bf16 v[132:135], v[100:103], v[80:83], v[132:135]
    ds_read_b128 v[36:39], v5 offset:2048
    v_mfma_f32_16x16x32_bf16 v[136:139], v[104:107], v[80:83], v[136:139]
    ds_read_b128 v[40:43], v5 offset:4096
    v_mfma_f32_16x16x32_bf16 v[140:143], v[108:111], v[80:83], v[140:143]
    ds_read_b128 v[44:47], v5 offset:6144
    v_mfma_f32_16x16x32_bf16 v[144:147], v[112:115], v[80:83], v[144:147]
    s_add_u32 m0, s46, 1024
    s_add_u32 s32, s30, 16384
    buffer_load_dwordx4 v22, s[12:15], s32 offen lds
    v_mfma_f32_16x16x32_bf16 v[148:151], v[116:119], v[80:83], v[148:151]
    ds_read_b64_tr_b16 v[48:49], v7 offset:28672
    v_mfma_f32_16x16x32_bf16 v[152:155], v[96:99], v[84:87], v[152:155]
    v_mfma_f32_16x16x32_bf16 v[156:159], v[100:103], v[84:87], v[156:159]
    ds_read_b64_tr_b16 v[50:51], v7 offset:30464
    v_mfma_f32_16x16x32_bf16 v[160:163], v[104:107], v[84:87], v[160:163]
    ds_read_b64_tr_b16 v[52:53], v7 offset:35840
    v_mfma_f32_16x16x32_bf16 v[164:167], v[108:111], v[84:87], v[164:167]
    s_add_u32 m0, s46, 2048
    s_add_u32 s32, s30, 32768
    buffer_load_dwordx4 v22, s[12:15], s32 offen lds
    v_mfma_f32_16x16x32_bf16 v[168:171], v[112:115], v[84:87], v[168:171]
    ds_read_b64_tr_b16 v[54:55], v7 offset:37632
    v_mfma_f32_16x16x32_bf16 v[172:175], v[116:119], v[84:87], v[172:175]
    ds_read_b64_tr_b16 v[56:57], v7 offset:28704
    v_mfma_f32_16x16x32_bf16 v[176:179], v[96:99], v[88:91], v[176:179]
    ds_read_b64_tr_b16 v[58:59], v7 offset:30496
    v_mfma_f32_16x16x32_bf16 v[180:183], v[100:103], v[88:91], v[180:183]
    s_add_u32 m0, s46, 3072
    s_add_u32 s32, s30, 49152
    buffer_load_dwordx4 v22, s[12:15], s32 offen lds
    v_mfma_f32_16x16x32_bf16 v[184:187], v[104:107], v[88:91], v[184:187]
    v_mfma_f32_16x16x32_bf16 v[188:191], v[108:111], v[88:91], v[188:191]
    ds_read_b64_tr_b16 v[60:61], v7 offset:35872
    v_mfma_f32_16x16x32_bf16 v[192:195], v[112:115], v[88:91], v[192:195]
    ds_read_b64_tr_b16 v[62:63], v7 offset:37664
    v_mfma_f32_16x16x32_bf16 v[196:199], v[116:119], v[88:91], v[196:199]
    ds_read_b64_tr_b16 v[64:65], v8 offset:28672
    v_mfma_f32_16x16x32_bf16 v[200:203], v[96:99], v[92:95], v[200:203]
    s_mov_b32 m0, 155648
    s_add_u32 s32, s68, 1048576
    buffer_load_dwordx4 v30, s[64:67], s32 offen lds
    v_mfma_f32_16x16x32_bf16 v[204:207], v[100:103], v[92:95], v[204:207]
    ds_read_b64_tr_b16 v[66:67], v8 offset:30464
    v_mfma_f32_16x16x32_bf16 v[208:211], v[104:107], v[92:95], v[208:211]
    ds_read_b64_tr_b16 v[68:69], v8 offset:35840
    v_mfma_f32_16x16x32_bf16 v[212:215], v[108:111], v[92:95], v[212:215]
    ds_read_b64_tr_b16 v[70:71], v8 offset:37632
    v_mfma_f32_16x16x32_bf16 v[216:219], v[112:115], v[92:95], v[216:219]
    v_mfma_f32_16x16x32_bf16 v[220:223], v[116:119], v[92:95], v[220:223]
    s_waitcnt vmcnt(15) lgkmcnt(0)
    s_barrier
    v_add_u32 v6, s45, v29
    s_add_u32 s45, s45, 32768
    s_cmp_eq_u32 s45, 98304
    s_cselect_b32 s45, 0, s45
    s_nop 0
    s_add_u32 m0, s46, 4096
    s_add_u32 s32, s30, 65536
    buffer_load_dwordx4 v22, s[12:15], s32 offen lds
    v_mfma_f32_16x16x32_bf16 v[128:131], v[48:51], v[32:35], v[128:131]
    ds_read_b128 v[80:83], v6 offset:0
    v_mfma_f32_16x16x32_bf16 v[132:135], v[52:55], v[32:35], v[132:135]
    ds_read_b128 v[84:87], v6 offset:2048
    v_mfma_f32_16x16x32_bf16 v[136:139], v[56:59], v[32:35], v[136:139]
    ds_read_b128 v[88:91], v6 offset:4096
    v_mfma_f32_16x16x32_bf16 v[140:143], v[60:63], v[32:35], v[140:143]
    ds_read_b128 v[92:95], v6 offset:6144
    v_mfma_f32_16x16x32_bf16 v[144:147], v[64:67], v[32:35], v[144:147]
    s_add_u32 m0, s46, 5120
    s_add_u32 s32, s30, 81920
    buffer_load_dwordx4 v22, s[12:15], s32 offen lds
    v_mfma_f32_16x16x32_bf16 v[148:151], v[68:71], v[32:35], v[148:151]
    ds_read_b64_tr_b16 v[96:97], v7 offset:43008
    v_mfma_f32_16x16x32_bf16 v[152:155], v[48:51], v[36:39], v[152:155]
    v_mfma_f32_16x16x32_bf16 v[156:159], v[52:55], v[36:39], v[156:159]
    ds_read_b64_tr_b16 v[98:99], v7 offset:44800
    v_mfma_f32_16x16x32_bf16 v[160:163], v[56:59], v[36:39], v[160:163]
    ds_read_b64_tr_b16 v[100:101], v7 offset:50176
    v_mfma_f32_16x16x32_bf16 v[164:167], v[60:63], v[36:39], v[164:167]
    s_add_u32 m0, s46, 6144
    s_add_u32 s32, s30, 98304
    buffer_load_dwordx4 v22, s[12:15], s32 offen lds
    v_mfma_f32_16x16x32_bf16 v[168:171], v[64:67], v[36:39], v[168:171]
    ds_read_b64_tr_b16 v[102:103], v7 offset:51968
    v_mfma_f32_16x16x32_bf16 v[172:175], v[68:71], v[36:39], v[172:175]
    ds_read_b64_tr_b16 v[104:105], v7 offset:43040
    v_mfma_f32_16x16x32_bf16 v[176:179], v[48:51], v[40:43], v[176:179]
    ds_read_b64_tr_b16 v[106:107], v7 offset:44832
    v_mfma_f32_16x16x32_bf16 v[180:183], v[52:55], v[40:43], v[180:183]
    s_add_u32 m0, s46, 7168
    s_add_u32 s32, s30, 114688
    buffer_load_dwordx4 v22, s[12:15], s32 offen lds
    s_add_u32 s30, s30, 128
    s_add_u32 s46, s46, 32768
    s_add_u32 s32, s41, 98304
    s_cmp_eq_u32 s46, s32
    s_cselect_b32 s46, s41, s46
    v_mfma_f32_16x16x32_bf16 v[184:187], v[56:59], v[40:43], v[184:187]
    v_mfma_f32_16x16x32_bf16 v[188:191], v[60:63], v[40:43], v[188:191]
    ds_read_b64_tr_b16 v[108:109], v7 offset:50208
    v_mfma_f32_16x16x32_bf16 v[192:195], v[64:67], v[40:43], v[192:195]
    ds_read_b64_tr_b16 v[110:111], v7 offset:52000
    v_mfma_f32_16x16x32_bf16 v[196:199], v[68:71], v[40:43], v[196:199]
    ds_read_b64_tr_b16 v[112:113], v8 offset:43008
    v_mfma_f32_16x16x32_bf16 v[200:203], v[48:51], v[44:47], v[200:203]
    s_mov_b32 m0, 155648
    s_add_u32 s32, s68, 2097152
    buffer_load_dwordx4 v30, s[64:67], s32 offen lds
    v_mfma_f32_16x16x32_bf16 v[204:207], v[52:55], v[44:47], v[204:207]
    ds_read_b64_tr_b16 v[114:115], v8 offset:44800
    v_mfma_f32_16x16x32_bf16 v[208:211], v[56:59], v[44:47], v[208:211]
    ds_read_b64_tr_b16 v[116:117], v8 offset:50176
    v_mfma_f32_16x16x32_bf16 v[212:215], v[60:63], v[44:47], v[212:215]
    ds_read_b64_tr_b16 v[118:119], v8 offset:51968
    v_mfma_f32_16x16x32_bf16 v[216:219], v[64:67], v[44:47], v[216:219]
    v_mfma_f32_16x16x32_bf16 v[220:223], v[68:71], v[44:47], v[220:223]
    s_waitcnt vmcnt(11) lgkmcnt(0)
    s_barrier
    v_add_u32 v5, s45, v28
    s_nop 0
    s_add_u32 m0, s46, 0
    s_add_u32 s32, s30, 0
    buffer_load_dwordx4 v22, s[12:15], s32 offen lds
    v_mfma_f32_16x16x32_bf16 v[128:131], v[96:99], v[80:83], v[128:131]
    ds_read_b128 v[32:35], v5 offset:0
    v_mfma_f32_16x16x32_bf16 v[132:135], v[100:103], v[80:83], v[132:135]
    ds_read_b128 v[36:39], v5 offset:2048
    v_mfma_f32_16x16x32_bf16 v[136:139], v[104:107], v[80:83], v[136:139]
    ds_read_b128 v[40:43], v5 offset:4096
    v_mfma_f32_16x16x32_bf16 v[140:143], v[108:111], v[80:83], v[140:143]
    ds_read_b128 v[44:47], v5 offset:6144
    v_mfma_f32_16x16x32_bf16 v[144:147], v[112:115], v[80:83], v[144:147]
    s_add_u32 m0, s46, 1024
    s_add_u32 s32, s30, 16384
    buffer_load_dwordx4 v22, s[12:15], s32 offen lds
    v_mfma_f32_16x16x32_bf16 v[148:151], v[116:119], v[80:83], v[148:151]
    ds_read_b64_tr_b16 v[48:49], v7 offset:0
    v_mfma_f32_16x16x32_bf16 v[152:155], v[96:99], v[84:87], v[152:155]
    v_mfma_f32_16x16x32_bf16 v[156:159], v[100:103], v[84:87], v[156:159]
    ds_read_b64_tr_b16 v[50:51], v7 offset:1792
    v_mfma_f32_16x16x32_bf16 v[160:163], v[104:107], v[84:87], v[160:163]
    ds_read_b64_tr_b16 v[52:53], v7 offset:7168
    v_mfma_f32_16x16x32_bf16 v[164:167], v[108:111], v[84:87], v[164:167]
    s_add_u32 m0, s46, 2048
    s_add_u32 s32, s30, 32768
    buffer_load_dwordx4 v22, s[12:15], s32 offen lds
    v_mfma_f32_16x16x32_bf16 v[168:171], v[112:115], v[84:87], v[168:171]
    ds_read_b64_tr_b16 v[54:55], v7 offset:8960
    v_mfma_f32_16x16x32_bf16 v[172:175], v[116:119], v[84:87], v[172:175]
    ds_read_b64_tr_b16 v[56:57], v7 offset:32
    v_mfma_f32_16x16x32_bf16 v[176:179], v[96:99], v[88:91], v[176:179]
    ds_read_b64_tr_b16 v[58:59], v7 offset:1824
    v_mfma_f32_16x16x32_bf16 v[180:183], v[100:103], v[88:91], v[180:183]
    s_add_u32 m0, s46, 3072
    s_add_u32 s32, s30, 49152
    buffer_load_dwordx4 v22, s[12:15], s32 offen lds
    v_mfma_f32_16x16x32_bf16 v[184:187], v[104:107], v[88:91], v[184:187]
    v_mfma_f32_16x16x32_bf16 v[188:191], v[108:111], v[88:91], v[188:191]
    ds_read_b64_tr_b16 v[60:61], v7 offset:7200
    v_mfma_f32_16x16x32_bf16 v[192:195], v[112:115], v[88:91], v[192:195]
    ds_read_b64_tr_b16 v[62:63], v7 offset:8992
    v_mfma_f32_16x16x32_bf16 v[196:199], v[116:119], v[88:91], v[196:199]
    ds_read_b64_tr_b16 v[64:65], v8 offset:0
    v_mfma_f32_16x16x32_bf16 v[200:203], v[96:99], v[92:95], v[200:203]
    s_mov_b32 m0, 155648
    s_add_u32 s32, s69, 1024
    buffer_load_dwordx4 v30, s[12:15], s32 offen lds
    v_mfma_f32_16x16x32_bf16 v[204:207], v[100:103], v[92:95], v[204:207]
    ds_read_b64_tr_b16 v[66:67], v8 offset:1792
    v_mfma_f32_16x16x32_bf16 v[208:211], v[104:107], v[92:95], v[208:211]
    ds_read_b64_tr_b16 v[68:69], v8 offset:7168
    v_mfma_f32_16x16x32_bf16 v[212:215], v[108:111], v[92:95], v[212:215]
    ds_read_b64_tr_b16 v[70:71], v8 offset:8960
    v_mfma_f32_16x16x32_bf16 v[216:219], v[112:115], v[92:95], v[216:219]
    v_mfma_f32_16x16x32_bf16 v[220:223], v[116:119], v[92:95], v[220:223]
    s_waitcnt vmcnt(16) lgkmcnt(0)
    s_barrier
    v_add_u32 v6, s45, v29
    s_add_u32 s45, s45, 32768
    s_cmp_eq_u32 s45, 98304
    s_cselect_b32 s45, 0, s45
    s_nop 0
    s_add_u32 m0, s46, 4096
    s_add_u32 s32, s30, 65536
    buffer_load_dwordx4 v22, s[12:15], s32 offen lds
    v_mfma_f32_16x16x32_bf16 v[128:131], v[48:51], v[32:35], v[128:131]
    ds_read_b128 v[80:83], v6 offset:0
    v_mfma_f32_16x16x32_bf16 v[132:135], v[52:55], v[32:35], v[132:135]
    ds_read_b128 v[84:87], v6 offset:2048
    v_mfma_f32_16x16x32_bf16 v[136:139], v[56:59], v[32:35], v[136:139]
    ds_read_b128 v[88:91], v6 offset:4096
    v_mfma_f32_16x16x32_bf16 v[140:143], v[60:63], v[32:35], v[140:143]
    ds_read_b128 v[92:95], v6 offset:6144
    v_mfma_f32_16x16x32_bf16 v[144:147], v[64:67], v[32:35], v[144:147]
    s_add_u32 m0, s46, 5120
    s_add_u32 s32, s30, 81920
    buffer_load_dwordx4 v22, s[12:15], s32 offen lds
    v_mfma_f32_16x16x32_bf16 v[148:151], v[68:71], v[32:35], v[148:151]
    ds_read_b64_tr_b16 v[96:97], v7 offset:14336
    v_mfma_f32_16x16x32_bf16 v[152:155], v[48:51], v[36:39], v[152:155]
    v_mfma_f32_16x16x32_bf16 v[156:159], v[52:55], v[36:39], v[156:159]
    ds_read_b64_tr_b16 v[98:99], v7 offset:16128
    v_mfma_f32_16x16x32_bf16 v[160:163], v[56:59], v[36:39], v[160:163]
    ds_read_b64_tr_b16 v[100:101], v7 offset:21504
    v_mfma_f32_16x16x32_bf16 v[164:167], v[60:63], v[36:39], v[164:167]
    s_add_u32 m0, s46, 6144
    s_add_u32 s32, s30, 98304
    buffer_load_dwordx4 v22, s[12:15], s32 offen lds
    v_mfma_f32_16x16x32_bf16 v[168:171], v[64:67], v[36:39], v[168:171]
    ds_read_b64_tr_b16 v[102:103], v7 offset:23296
    v_mfma_f32_16x16x32_bf16 v[172:175], v[68:71], v[36:39], v[172:175]
    ds_read_b64_tr_b16 v[104:105], v7 offset:14368
    v_mfma_f32_16x16x32_bf16 v[176:179], v[48:51], v[40:43], v[176:179]
    ds_read_b64_tr_b16 v[106:107], v7 offset:16160
    v_mfma_f32_16x16x32_bf16 v[180:183], v[52:55], v[40:43], v[180:183]
    s_add_u32 m0, s46, 7168
    s_add_u32 s32, s30, 114688
    buffer_load_dwordx4 v22, s[12:15], s32 offen lds
    s_add_u32 s30, s30, 128
    s_add_u32 s46, s46, 32768
    s_add_u32 s32, s41, 98304
    s_cmp_eq_u32 s46, s32
    s_cselect_b32 s46, s41, s46
    v_mfma_f32_16x16x32_bf16 v[184:187], v[56:59], v[40:43], v[184:187]
    v_mfma_f32_16x16x32_bf16 v[188:191], v[60:63], v[40:43], v[188:191]
    ds_read_b64_tr_b16 v[108:109], v7 offset:21536
    v_mfma_f32_16x16x32_bf16 v[192:195], v[64:67], v[40:43], v[192:195]
    ds_read_b64_tr_b16 v[110:111], v7 offset:23328
    v_mfma_f32_16x16x32_bf16 v[196:199], v[68:71], v[40:43], v[196:199]
    ds_read_b64_tr_b16 v[112:113], v8 offset:14336
    v_mfma_f32_16x16x32_bf16 v[200:203], v[48:51], v[44:47], v[200:203]
    s_mov_b32 m0, 155648
    s_add_u32 s32, s68, 3145728
    buffer_load_dwordx4 v30, s[64:67], s32 offen lds
    v_mfma_f32_16x16x32_bf16 v[204:207], v[52:55], v[44:47], v[204:207]
    ds_read_b64_tr_b16 v[114:115], v8 offset:16128
    v_mfma_f32_16x16x32_bf16 v[208:211], v[56:59], v[44:47], v[208:211]
    ds_read_b64_tr_b16 v[116:117], v8 offset:21504
    v_mfma_f32_16x16x32_bf16 v[212:215], v[60:63], v[44:47], v[212:215]
    ds_read_b64_tr_b16 v[118:119], v8 offset:23296
    v_mfma_f32_16x16x32_bf16 v[216:219], v[64:67], v[44:47], v[216:219]
    v_mfma_f32_16x16x32_bf16 v[220:223], v[68:71], v[44:47], v[220:223]
    s_waitcnt vmcnt(11) lgkmcnt(0)
    s_barrier
    v_add_u32 v5, s45, v28
    s_nop 0
    s_add_u32 m0, s46, 0
    s_add_u32 s32, s30, 0
    buffer_load_dwordx4 v22, s[12:15], s32 offen lds
    v_mfma_f32_16x16x32_bf16 v[128:131], v[96:99], v[80:83], v[128:131]
    ds_read_b128 v[32:35], v5 offset:0
    v_mfma_f32_16x16x32_bf16 v[132:135], v[100:103], v[80:83], v[132:135]
    ds_read_b128 v[36:39], v5 offset:2048
    v_mfma_f32_16x16x32_bf16 v[136:139], v[104:107], v[80:83], v[136:139]
    ds_read_b128 v[40:43], v5 offset:4096
    v_mfma_f32_16x16x32_bf16 v[140:143], v[108:111], v[80:83], v[140:143]
    ds_read_b128 v[44:47], v5 offset:6144
    v_mfma_f32_16x16x32_bf16 v[144:147], v[112:115], v[80:83], v[144:147]
    s_add_u32 m0, s46, 1024
    s_add_u32 s32, s30, 16384
    buffer_load_dwordx4 v22, s[12:15], s32 offen lds
    v_mfma_f32_16x16x32_bf16 v[148:151], v[116:119], v[80:83], v[148:151]
    ds_read_b64_tr_b16 v[48:49], v7 offset:28672
    v_mfma_f32_16x16x32_bf16 v[152:155], v[96:99], v[84:87], v[152:155]
    v_mfma_f32_16x16x32_bf16 v[156:159], v[100:103], v[84:87], v[156:159]
    ds_read_b64_tr_b16 v[50:51], v7 offset:30464
    v_mfma_f32_16x16x32_bf16 v[160:163], v[104:107], v[84:87], v[160:163]
    ds_read_b64_tr_b16 v[52:53], v7 offset:35840
    v_mfma_f32_16x16x32_bf16 v[164:167], v[108:111], v[84:87], v[164:167]
    s_add_u32 m0, s46, 2048
    s_add_u32 s32, s30, 32768
    buffer_load_dwordx4 v22, s[12:15], s32 offen lds
    v_mfma_f32_16x16x32_bf16 v[168:171], v[112:115], v[84:87], v[168:171]
    ds_read_b64_tr_b16 v[54:55], v7 offset:37632
    v_mfma_f32_16x16x32_bf16 v[172:175], v[116:119], v[84:87], v[172:175]
    ds_read_b64_tr_b16 v[56:57], v7 offset:28704
    v_mfma_f32_16x16x32_bf16 v[176:179], v[96:99], v[88:91], v[176:179]
    ds_read_b64_tr_b16 v[58:59], v7 offset:30496
    v_mfma_f32_16x16x32_bf16 v[180:183], v[100:103], v[88:91], v[180:183]
    s_add_u32 m0, s46, 3072
    s_add_u32 s32, s30, 49152
    buffer_load_dwordx4 v22, s[12:15], s32 offen lds
    v_mfma_f32_16x16x32_bf16 v[184:187], v[104:107], v[88:91], v[184:187]
    v_mfma_f32_16x16x32_bf16 v[188:191], v[108:111], v[88:91], v[188:191]
    ds_read_b64_tr_b16 v[60:61], v7 offset:35872
    v_mfma_f32_16x16x32_bf16 v[192:195], v[112:115], v[88:91], v[192:195]
    ds_read_b64_tr_b16 v[62:63], v7 offset:37664
    v_mfma_f32_16x16x32_bf16 v[196:199], v[116:119], v[88:91], v[196:199]
    ds_read_b64_tr_b16 v[64:65], v8 offset:28672
    v_mfma_f32_16x16x32_bf16 v[200:203], v[96:99], v[92:95], v[200:203]
    s_mov_b32 m0, 155648
    s_add_u32 s32, s68, 4194304
    buffer_load_dwordx4 v30, s[64:67], s32 offen lds
    v_mfma_f32_16x16x32_bf16 v[204:207], v[100:103], v[92:95], v[204:207]
    ds_read_b64_tr_b16 v[66:67], v8 offset:30464
    v_mfma_f32_16x16x32_bf16 v[208:211], v[104:107], v[92:95], v[208:211]
    ds_read_b64_tr_b16 v[68:69], v8 offset:35840
    v_mfma_f32_16x16x32_bf16 v[212:215], v[108:111], v[92:95], v[212:215]
    ds_read_b64_tr_b16 v[70:71], v8 offset:37632
    v_mfma_f32_16x16x32_bf16 v[216:219], v[112:115], v[92:95], v[216:219]
    v_mfma_f32_16x16x32_bf16 v[220:223], v[116:119], v[92:95], v[220:223]
    s_waitcnt vmcnt(16) lgkmcnt(0)
    s_barrier
    v_add_u32 v6, s45, v29
    s_add_u32 s45, s45, 32768
    s_cmp_eq_u32 s45, 98304
    s_cselect_b32 s45, 0, s45
    s_nop 0
    s_add_u32 m0, s46, 4096
    s_add_u32 s32, s30, 65536
    buffer_load_dwordx4 v22, s[12:15], s32 offen lds
    v_mfma_f32_16x16x32_bf16 v[128:131], v[48:51], v[32:35], v[128:131]
    ds_read_b128 v[80:83], v6 offset:0
    v_mfma_f32_16x16x32_bf16 v[132:135], v[52:55], v[32:35], v[132:135]
    ds_read_b128 v[84:87], v6 offset:2048
    v_mfma_f32_16x16x32_bf16 v[136:139], v[56:59], v[32:35], v[136:139]
    ds_read_b128 v[88:91], v6 offset:4096
    v_mfma_f32_16x16x32_bf16 v[140:143], v[60:63], v[32:35], v[140:143]
    ds_read_b128 v[92:95], v6 offset:6144
    v_mfma_f32_16x16x32_bf16 v[144:147], v[64:67], v[32:35], v[144:147]
    s_add_u32 m0, s46, 5120
    s_add_u32 s32, s30, 81920
    buffer_load_dwordx4 v22, s[12:15], s32 offen lds
    v_mfma_f32_16x16x32_bf16 v[148:151], v[68:71], v[32:35], v[148:151]
    ds_read_b64_tr_b16 v[96:97], v7 offset:43008
    v_mfma_f32_16x16x32_bf16 v[152:155], v[48:51], v[36:39], v[152:155]
    v_mfma_f32_16x16x32_bf16 v[156:159], v[52:55], v[36:39], v[156:159]
    ds_read_b64_tr_b16 v[98:99], v7 offset:44800
    v_mfma_f32_16x16x32_bf16 v[160:163], v[56:59], v[36:39], v[160:163]
    ds_read_b64_tr_b16 v[100:101], v7 offset:50176
    v_mfma_f32_16x16x32_bf16 v[164:167], v[60:63], v[36:39], v[164:167]
    s_add_u32 m0, s46, 6144
    s_add_u32 s32, s30, 98304
    buffer_load_dwordx4 v22, s[12:15], s32 offen lds
    v_mfma_f32_16x16x32_bf16 v[168:171], v[64:67], v[36:39], v[168:171]
    ds_read_b64_tr_b16 v[102:103], v7 offset:51968
    v_mfma_f32_16x16x32_bf16 v[172:175], v[68:71], v[36:39], v[172:175]
    ds_read_b64_tr_b16 v[104:105], v7 offset:43040
    v_mfma_f32_16x16x32_bf16 v[176:179], v[48:51], v[40:43], v[176:179]
    ds_read_b64_tr_b16 v[106:107], v7 offset:44832
    v_mfma_f32_16x16x32_bf16 v[180:183], v[52:55], v[40:43], v[180:183]
    s_add_u32 m0, s46, 7168
    s_add_u32 s32, s30, 114688
    buffer_load_dwordx4 v22, s[12:15], s32 offen lds
    s_add_u32 s30, s30, 128
    s_add_u32 s46, s46, 32768
    s_add_u32 s32, s41, 98304
    s_cmp_eq_u32 s46, s32
    s_cselect_b32 s46, s41, s46
    v_mfma_f32_16x16x32_bf16 v[184:187], v[56:59], v[40:43], v[184:187]
    v_mfma_f32_16x16x32_bf16 v[188:191], v[60:63], v[40:43], v[188:191]
    ds_read_b64_tr_b16 v[108:109], v7 offset:50208
    v_mfma_f32_16x16x32_bf16 v[192:195], v[64:67], v[40:43], v[192:195]
    ds_read_b64_tr_b16 v[110:111], v7 offset:52000
    v_mfma_f32_16x16x32_bf16 v[196:199], v[68:71], v[40:43], v[196:199]
    ds_read_b64_tr_b16 v[112:113], v8 offset:43008
    v_mfma_f32_16x16x32_bf16 v[200:203], v[48:51], v[44:47], v[200:203]
    s_mov_b32 m0, 155648
    s_add_u32 s32, s68, 5242880
    buffer_load_dwordx4 v30, s[64:67], s32 offen lds
    v_mfma_f32_16x16x32_bf16 v[204:207], v[52:55], v[44:47], v[204:207]
    ds_read_b64_tr_b16 v[114:115], v8 offset:44800
    v_mfma_f32_16x16x32_bf16 v[208:211], v[56:59], v[44:47], v[208:211]
    ds_read_b64_tr_b16 v[116:117], v8 offset:50176
    v_mfma_f32_16x16x32_bf16 v[212:215], v[60:63], v[44:47], v[212:215]
    ds_read_b64_tr_b16 v[118:119], v8 offset:51968
    v_mfma_f32_16x16x32_bf16 v[216:219], v[64:67], v[44:47], v[216:219]
    v_mfma_f32_16x16x32_bf16 v[220:223], v[68:71], v[44:47], v[220:223]
    s_waitcnt vmcnt(11) lgkmcnt(0)
    s_barrier
    v_add_u32 v5, s45, v28
    s_nop 0
    s_add_u32 m0, s46, 0
    s_add_u32 s32, s30, 0
    buffer_load_dwordx4 v22, s[12:15], s32 offen lds
    v_mfma_f32_16x16x32_bf16 v[128:131], v[96:99], v[80:83], v[128:131]
    ds_read_b128 v[32:35], v5 offset:0
    v_mfma_f32_16x16x32_bf16 v[132:135], v[100:103], v[80:83], v[132:135]
    ds_read_b128 v[36:39], v5 offset:2048
    v_mfma_f32_16x16x32_bf16 v[136:139], v[104:107], v[80:83], v[136:139]
    ds_read_b128 v[40:43], v5 offset:4096
    v_mfma_f32_16x16x32_bf16 v[140:143], v[108:111], v[80:83], v[140:143]
    ds_read_b128 v[44:47], v5 offset:6144
    v_mfma_f32_16x16x32_bf16 v[144:147], v[112:115], v[80:83], v[144:147]
    s_add_u32 m0, s46, 1024
    s_add_u32 s32, s30, 16384
    buffer_load_dwordx4 v22, s[12:15], s32 offen lds
    v_mfma_f32_16x16x32_bf16 v[148:151], v[116:119], v[80:83], v[148:151]
    ds_read_b64_tr_b16 v[48:49], v7 offset:0
    v_mfma_f32_16x16x32_bf16 v[152:155], v[96:99], v[84:87], v[152:155]
    v_mfma_f32_16x16x32_bf16 v[156:159], v[100:103], v[84:87], v[156:159]
    ds_read_b64_tr_b16 v[50:51], v7 offset:1792
    v_mfma_f32_16x16x32_bf16 v[160:163], v[104:107], v[84:87], v[160:163]
    ds_read_b64_tr_b16 v[52:53], v7 offset:7168
    v_mfma_f32_16x16x32_bf16 v[164:167], v[108:111], v[84:87], v[164:167]
    s_add_u32 m0, s46, 2048
    s_add_u32 s32, s30, 32768
    buffer_load_dwordx4 v22, s[12:15], s32 offen lds
    v_mfma_f32_16x16x32_bf16 v[168:171], v[112:115], v[84:87], v[168:171]
    ds_read_b64_tr_b16 v[54:55], v7 offset:8960
    v_mfma_f32_16x16x32_bf16 v[172:175], v[116:119], v[84:87], v[172:175]
    ds_read_b64_tr_b16 v[56:57], v7 offset:32
    v_mfma_f32_16x16x32_bf16 v[176:179], v[96:99], v[88:91], v[176:179]
    ds_read_b64_tr_b16 v[58:59], v7 offset:1824
    v_mfma_f32_16x16x32_bf16 v[180:183], v[100:103], v[88:91], v[180:183]
    s_add_u32 m0, s46, 3072
    s_add_u32 s32, s30, 49152
    buffer_load_dwordx4 v22, s[12:15], s32 offen lds
    v_mfma_f32_16x16x32_bf16 v[184:187], v[104:107], v[88:91], v[184:187]
    v_mfma_f32_16x16x32_bf16 v[188:191], v[108:111], v[88:91], v[188:191]
    ds_read_b64_tr_b16 v[60:61], v7 offset:7200
    v_mfma_f32_16x16x32_bf16 v[192:195], v[112:115], v[88:91], v[192:195]
    ds_read_b64_tr_b16 v[62:63], v7 offset:8992
    v_mfma_f32_16x16x32_bf16 v[196:199], v[116:119], v[88:91], v[196:199]
    ds_read_b64_tr_b16 v[64:65], v8 offset:0
    v_mfma_f32_16x16x32_bf16 v[200:203], v[96:99], v[92:95], v[200:203]
    s_mov_b32 m0, 155648
    s_add_u32 s32, s68, 6291456
    buffer_load_dwordx4 v30, s[64:67], s32 offen lds
    v_mfma_f32_16x16x32_bf16 v[204:207], v[100:103], v[92:95], v[204:207]
    ds_read_b64_tr_b16 v[66:67], v8 offset:1792
    v_mfma_f32_16x16x32_bf16 v[208:211], v[104:107], v[92:95], v[208:211]
    ds_read_b64_tr_b16 v[68:69], v8 offset:7168
    v_mfma_f32_16x16x32_bf16 v[212:215], v[108:111], v[92:95], v[212:215]
    ds_read_b64_tr_b16 v[70:71], v8 offset:8960
    v_mfma_f32_16x16x32_bf16 v[216:219], v[112:115], v[92:95], v[216:219]
    v_mfma_f32_16x16x32_bf16 v[220:223], v[116:119], v[92:95], v[220:223]
    s_waitcnt vmcnt(16) lgkmcnt(0)
    s_barrier
    v_add_u32 v6, s45, v29
    s_add_u32 s45, s45, 32768
    s_cmp_eq_u32 s45, 98304
    s_cselect_b32 s45, 0, s45
    s_nop 0
    s_add_u32 m0, s46, 4096
    s_add_u32 s32, s30, 65536
    buffer_load_dwordx4 v22, s[12:15], s32 offen lds
    v_mfma_f32_16x16x32_bf16 v[128:131], v[48:51], v[32:35], v[128:131]
    ds_read_b128 v[80:83], v6 offset:0
    v_mfma_f32_16x16x32_bf16 v[132:135], v[52:55], v[32:35], v[132:135]
    ds_read_b128 v[84:87], v6 offset:2048
    v_mfma_f32_16x16x32_bf16 v[136:139], v[56:59], v[32:35], v[136:139]
    ds_read_b128 v[88:91], v6 offset:4096
    v_mfma_f32_16x16x32_bf16 v[140:143], v[60:63], v[32:35], v[140:143]
    ds_read_b128 v[92:95], v6 offset:6144
    v_mfma_f32_16x16x32_bf16 v[144:147], v[64:67], v[32:35], v[144:147]
    v_mfma_f32_16x16x32_bf16 v[148:151], v[68:71], v[32:35], v[148:151]
    s_add_u32 m0, s46, 5120
    s_add_u32 s32, s30, 81920
    buffer_load_dwordx4 v22, s[12:15], s32 offen lds
    v_mfma_f32_16x16x32_bf16 v[152:155], v[48:51], v[36:39], v[152:155]
    ds_read_b64_tr_b16 v[96:97], v7 offset:14336
    v_mfma_f32_16x16x32_bf16 v[156:159], v[52:55], v[36:39], v[156:159]
    ds_read_b64_tr_b16 v[98:99], v7 offset:16128
    v_mfma_f32_16x16x32_bf16 v[160:163], v[56:59], v[36:39], v[160:163]
    ds_read_b64_tr_b16 v[100:101], v7 offset:21504
    v_mfma_f32_16x16x32_bf16 v[164:167], v[60:63], v[36:39], v[164:167]
    ds_read_b64_tr_b16 v[102:103], v7 offset:23296
    v_mfma_f32_16x16x32_bf16 v[168:171], v[64:67], v[36:39], v[168:171]
    v_mfma_f32_16x16x32_bf16 v[172:175], v[68:71], v[36:39], v[172:175]
    s_add_u32 m0, s46, 6144
    s_add_u32 s32, s30, 98304
    buffer_load_dwordx4 v22, s[12:15], s32 offen lds
    v_mfma_f32_16x16x32_bf16 v[176:179], v[48:51], v[40:43], v[176:179]
    ds_read_b64_tr_b16 v[104:105], v7 offset:14368
    v_mfma_f32_16x16x32_bf16 v[180:183], v[52:55], v[40:43], v[180:183]
    ds_read_b64_tr_b16 v[106:107], v7 offset:16160
    v_mfma_f32_16x16x32_bf16 v[184:187], v[56:59], v[40:43], v[184:187]
    ds_read_b64_tr_b16 v[108:109], v7 offset:21536
    v_mfma_f32_16x16x32_bf16 v[188:191], v[60:63], v[40:43], v[188:191]
    ds_read_b64_tr_b16 v[110:111], v7 offset:23328
    v_mfma_f32_16x16x32_bf16 v[192:195], v[64:67], v[40:43], v[192:195]
    v_mfma_f32_16x16x32_bf16 v[196:199], v[68:71], v[40:43], v[196:199]
    s_add_u32 m0, s46, 7168
    s_add_u32 s32, s30, 114688
    buffer_load_dwordx4 v22, s[12:15], s32 offen lds
    s_add_u32 s30, s30, 128
    s_add_u32 s46, s46, 32768
    s_add_u32 s32, s41, 98304
    s_cmp_eq_u32 s46, s32
    s_cselect_b32 s46, s41, s46
    v_mfma_f32_16x16x32_bf16 v[200:203], v[48:51], v[44:47], v[200:203]
    ds_read_b64_tr_b16 v[112:113], v8 offset:14336
    v_mfma_f32_16x16x32_bf16 v[204:207], v[52:55], v[44:47], v[204:207]
    ds_read_b64_tr_b16 v[114:115], v8 offset:16128
    v_mfma_f32_16x16x32_bf16 v[208:211], v[56:59], v[44:47], v[208:211]
    ds_read_b64_tr_b16 v[116:117], v8 offset:21504
    v_mfma_f32_16x16x32_bf16 v[212:215], v[60:63], v[44:47], v[212:215]
    ds_read_b64_tr_b16 v[118:119], v8 offset:23296
    v_mfma_f32_16x16x32_bf16 v[216:219], v[64:67], v[44:47], v[216:219]
    v_mfma_f32_16x16x32_bf16 v[220:223], v[68:71], v[44:47], v[220:223]
    s_waitcnt vmcnt(10) lgkmcnt(0)
    s_barrier
    v_add_u32 v5, s45, v28
    s_nop 0
    s_add_u32 m0, s46, 0
    s_add_u32 s32, s30, 0
    buffer_load_dwordx4 v22, s[12:15], s32 offen lds
    v_mfma_f32_16x16x32_bf16 v[128:131], v[96:99], v[80:83], v[128:131]
    ds_read_b128 v[32:35], v5 offset:0
    v_mfma_f32_16x16x32_bf16 v[132:135], v[100:103], v[80:83], v[132:135]
    ds_read_b128 v[36:39], v5 offset:2048
    v_mfma_f32_16x16x32_bf16 v[136:139], v[104:107], v[80:83], v[136:139]
    ds_read_b128 v[40:43], v5 offset:4096
    v_mfma_f32_16x16x32_bf16 v[140:143], v[108:111], v[80:83], v[140:143]
    ds_read_b128 v[44:47], v5 offset:6144
    v_mfma_f32_16x16x32_bf16 v[144:147], v[112:115], v[80:83], v[144:147]
    v_mfma_f32_16x16x32_bf16 v[148:151], v[116:119], v[80:83], v[148:151]
    s_add_u32 m0, s46, 1024
    s_add_u32 s32, s30, 16384
    buffer_load_dwordx4 v22, s[12:15], s32 offen lds
    v_mfma_f32_16x16x32_bf16 v[152:155], v[96:99], v[84:87], v[152:155]
    ds_read_b64_tr_b16 v[48:49], v7 offset:28672
    v_mfma_f32_16x16x32_bf16 v[156:159], v[100:103], v[84:87], v[156:159]
    ds_read_b64_tr_b16 v[50:51], v7 offset:30464
    v_mfma_f32_16x16x32_bf16 v[160:163], v[104:107], v[84:87], v[160:163]
    ds_read_b64_tr_b16 v[52:53], v7 offset:35840
    v_mfma_f32_16x16x32_bf16 v[164:167], v[108:111], v[84:87], v[164:167]
    ds_read_b64_tr_b16 v[54:55], v7 offset:37632
    v_mfma_f32_16x16x32_bf16 v[168:171], v[112:115], v[84:87], v[168:171]
    v_mfma_f32_16x16x32_bf16 v[172:175], v[116:119], v[84:87], v[172:175]
    s_add_u32 m0, s46, 2048
    s_add_u32 s32, s30, 32768
    buffer_load_dwordx4 v22, s[12:15], s32 offen lds
    v_mfma_f32_16x16x32_bf16 v[176:179], v[96:99], v[88:91], v[176:179]
    ds_read_b64_tr_b16 v[56:57], v7 offset:28704
    v_mfma_f32_16x16x32_bf16 v[180:183], v[100:103], v[88:91], v[180:183]
    ds_read_b64_tr_b16 v[58:59], v7 offset:30496
    v_mfma_f32_16x16x32_bf16 v[184:187], v[104:107], v[88:91], v[184:187]
    ds_read_b64_tr_b16 v[60:61], v7 offset:35872
    v_mfma_f32_16x16x32_bf16 v[188:191], v[108:111], v[88:91], v[188:191]
    ds_read_b64_tr_b16 v[62:63], v7 offset:37664
    v_mfma_f32_16x16x32_bf16 v[192:195], v[112:115], v[88:91], v[192:195]
    v_mfma_f32_16x16x32_bf16 v[196:199], v[116:119], v[88:91], v[196:199]
    s_add_u32 m0, s46, 3072
    s_add_u32 s32, s30, 49152
    buffer_load_dwordx4 v22, s[12:15], s32 offen lds
    v_mfma_f32_16x16x32_bf16 v[200:203], v[96:99], v[92:95], v[200:203]
    ds_read_b64_tr_b16 v[64:65], v8 offset:28672
    v_mfma_f32_16x16x32_bf16 v[204:207], v[100:103], v[92:95], v[204:207]
    ds_read_b64_tr_b16 v[66:67], v8 offset:30464
    v_mfma_f32_16x16x32_bf16 v[208:211], v[104:107], v[92:95], v[208:211]
    ds_read_b64_tr_b16 v[68:69], v8 offset:35840
    v_mfma_f32_16x16x32_bf16 v[212:215], v[108:111], v[92:95], v[212:215]
    ds_read_b64_tr_b16 v[70:71], v8 offset:37632
    v_mfma_f32_16x16x32_bf16 v[216:219], v[112:115], v[92:95], v[216:219]
    v_mfma_f32_16x16x32_bf16 v[220:223], v[116:119], v[92:95], v[220:223]
    s_waitcnt vmcnt(14) lgkmcnt(0)
    s_barrier
    v_add_u32 v6, s45, v29
    s_add_u32 s45, s45, 32768
    s_cmp_eq_u32 s45, 98304
    s_cselect_b32 s45, 0, s45
    s_nop 0
    s_add_u32 m0, s46, 4096
    s_add_u32 s32, s30, 65536
    buffer_load_dwordx4 v22, s[12:15], s32 offen lds
    v_mfma_f32_16x16x32_bf16 v[128:131], v[48:51], v[32:35], v[128:131]
    ds_read_b128 v[80:83], v6 offset:0
    v_mfma_f32_16x16x32_bf16 v[132:135], v[52:55], v[32:35], v[132:135]
    ds_read_b128 v[84:87], v6 offset:2048
    v_mfma_f32_16x16x32_bf16 v[136:139], v[56:59], v[32:35], v[136:139]
    ds_read_b128 v[88:91], v6 offset:4096
    v_mfma_f32_16x16x32_bf16 v[140:143], v[60:63], v[32:35], v[140:143]
    ds_read_b128 v[92:95], v6 offset:6144
    v_mfma_f32_16x16x32_bf16 v[144:147], v[64:67], v[32:35], v[144:147]
    v_mfma_f32_16x16x32_bf16 v[148:151], v[68:71], v[32:35], v[148:151]
    s_add_u32 m0, s46, 5120
    s_add_u32 s32, s30, 81920
    buffer_load_dwordx4 v22, s[12:15], s32 offen lds
    v_mfma_f32_16x16x32_bf16 v[152:155], v[48:51], v[36:39], v[152:155]
    ds_read_b64_tr_b16 v[96:97], v7 offset:43008
    v_mfma_f32_16x16x32_bf16 v[156:159], v[52:55], v[36:39], v[156:159]
    ds_read_b64_tr_b16 v[98:99], v7 offset:44800
    v_mfma_f32_16x16x32_bf16 v[160:163], v[56:59], v[36:39], v[160:163]
    ds_read_b64_tr_b16 v[100:101], v7 offset:50176
    v_mfma_f32_16x16x32_bf16 v[164:167], v[60:63], v[36:39], v[164:167]
    ds_read_b64_tr_b16 v[102:103], v7 offset:51968
    v_mfma_f32_16x16x32_bf16 v[168:171], v[64:67], v[36:39], v[168:171]
    v_mfma_f32_16x16x32_bf16 v[172:175], v[68:71], v[36:39], v[172:175]
    s_add_u32 m0, s46, 6144
    s_add_u32 s32, s30, 98304
    buffer_load_dwordx4 v22, s[12:15], s32 offen lds
    v_mfma_f32_16x16x32_bf16 v[176:179], v[48:51], v[40:43], v[176:179]
    ds_read_b64_tr_b16 v[104:105], v7 offset:43040
    v_mfma_f32_16x16x32_bf16 v[180:183], v[52:55], v[40:43], v[180:183]
    ds_read_b64_tr_b16 v[106:107], v7 offset:44832
    v_mfma_f32_16x16x32_bf16 v[184:187], v[56:59], v[40:43], v[184:187]
    ds_read_b64_tr_b16 v[108:109], v7 offset:50208
    v_mfma_f32_16x16x32_bf16 v[188:191], v[60:63], v[40:43], v[188:191]
    ds_read_b64_tr_b16 v[110:111], v7 offset:52000
    v_mfma_f32_16x16x32_bf16 v[192:195], v[64:67], v[40:43], v[192:195]
    v_mfma_f32_16x16x32_bf16 v[196:199], v[68:71], v[40:43], v[196:199]
    s_add_u32 m0, s46, 7168
    s_add_u32 s32, s30, 114688
    buffer_load_dwordx4 v22, s[12:15], s32 offen lds
    s_add_u32 s30, s30, 128
    s_add_u32 s46, s46, 32768
    s_add_u32 s32, s41, 98304
    s_cmp_eq_u32 s46, s32
    s_cselect_b32 s46, s41, s46
    v_mfma_f32_16x16x32_bf16 v[200:203], v[48:51], v[44:47], v[200:203]
    ds_read_b64_tr_b16 v[112:113], v8 offset:43008
    v_mfma_f32_16x16x32_bf16 v[204:207], v[52:55], v[44:47], v[204:207]
    ds_read_b64_tr_b16 v[114:115], v8 offset:44800
    v_mfma_f32_16x16x32_bf16 v[208:211], v[56:59], v[44:47], v[208:211]
    ds_read_b64_tr_b16 v[116:117], v8 offset:50176
    v_mfma_f32_16x16x32_bf16 v[212:215], v[60:63], v[44:47], v[212:215]
    ds_read_b64_tr_b16 v[118:119], v8 offset:51968
    v_mfma_f32_16x16x32_bf16 v[216:219], v[64:67], v[44:47], v[216:219]
    v_mfma_f32_16x16x32_bf16 v[220:223], v[68:71], v[44:47], v[220:223]
    s_waitcnt vmcnt(8) lgkmcnt(0)
    s_barrier
    v_add_u32 v5, s45, v28
    s_nop 0
    s_add_u32 m0, s46, 0
    s_add_u32 s32, s30, 0
    buffer_load_dwordx4 v22, s[12:15], s32 offen lds
    v_mfma_f32_16x16x32_bf16 v[128:131], v[96:99], v[80:83], v[128:131]
    ds_read_b128 v[32:35], v5 offset:0
    v_mfma_f32_16x16x32_bf16 v[132:135], v[100:103], v[80:83], v[132:135]
    ds_read_b128 v[36:39], v5 offset:2048
    v_mfma_f32_16x16x32_bf16 v[136:139], v[104:107], v[80:83], v[136:139]
    ds_read_b128 v[40:43], v5 offset:4096
    v_mfma_f32_16x16x32_bf16 v[140:143], v[108:111], v[80:83], v[140:143]
    ds_read_b128 v[44:47], v5 offset:6144
    v_mfma_f32_16x16x32_bf16 v[144:147], v[112:115], v[80:83], v[144:147]
    v_mfma_f32_16x16x32_bf16 v[148:151], v[116:119], v[80:83], v[148:151]
    s_add_u32 m0, s46, 1024
    s_add_u32 s32, s30, 16384
    buffer_load_dwordx4 v22, s[12:15], s32 offen lds
    v_mfma_f32_16x16x32_bf16 v[152:155], v[96:99], v[84:87], v[152:155]
    ds_read_b64_tr_b16 v[48:49], v7 offset:0
    v_mfma_f32_16x16x32_bf16 v[156:159], v[100:103], v[84:87], v[156:159]
    ds_read_b64_tr_b16 v[50:51], v7 offset:1792
    v_mfma_f32_16x16x32_bf16 v[160:163], v[104:107], v[84:87], v[160:163]
    ds_read_b64_tr_b16 v[52:53], v7 offset:7168
    v_mfma_f32_16x16x32_bf16 v[164:167], v[108:111], v[84:87], v[164:167]
    ds_read_b64_tr_b16 v[54:55], v7 offset:8960
    v_mfma_f32_16x16x32_bf16 v[168:171], v[112:115], v[84:87], v[168:171]
    v_mfma_f32_16x16x32_bf16 v[172:175], v[116:119], v[84:87], v[172:175]
    s_add_u32 m0, s46, 2048
    s_add_u32 s32, s30, 32768
    buffer_load_dwordx4 v22, s[12:15], s32 offen lds
    v_mfma_f32_16x16x32_bf16 v[176:179], v[96:99], v[88:91], v[176:179]
    ds_read_b64_tr_b16 v[56:57], v7 offset:32
    v_mfma_f32_16x16x32_bf16 v[180:183], v[100:103], v[88:91], v[180:183]
    ds_read_b64_tr_b16 v[58:59], v7 offset:1824
    v_mfma_f32_16x16x32_bf16 v[184:187], v[104:107], v[88:91], v[184:187]
    ds_read_b64_tr_b16 v[60:61], v7 offset:7200
    v_mfma_f32_16x16x32_bf16 v[188:191], v[108:111], v[88:91], v[188:191]
    ds_read_b64_tr_b16 v[62:63], v7 offset:8992
    v_mfma_f32_16x16x32_bf16 v[192:195], v[112:115], v[88:91], v[192:195]
    v_mfma_f32_16x16x32_bf16 v[196:199], v[116:119], v[88:91], v[196:199]
    s_add_u32 m0, s46, 3072
    s_add_u32 s32, s30, 49152
    buffer_load_dwordx4 v22, s[12:15], s32 offen lds
    v_mfma_f32_16x16x32_bf16 v[200:203], v[96:99], v[92:95], v[200:203]
    ds_read_b64_tr_b16 v[64:65], v8 offset:0
    v_mfma_f32_16x16x32_bf16 v[204:207], v[100:103], v[92:95], v[204:207]
    ds_read_b64_tr_b16 v[66:67], v8 offset:1792
    v_mfma_f32_16x16x32_bf16 v[208:211], v[104:107], v[92:95], v[208:211]
    ds_read_b64_tr_b16 v[68:69], v8 offset:7168
    v_mfma_f32_16x16x32_bf16 v[212:215], v[108:111], v[92:95], v[212:215]
    ds_read_b64_tr_b16 v[70:71], v8 offset:8960
    v_mfma_f32_16x16x32_bf16 v[216:219], v[112:115], v[92:95], v[216:219]
    v_mfma_f32_16x16x32_bf16 v[220:223], v[116:119], v[92:95], v[220:223]
    s_waitcnt vmcnt(12) lgkmcnt(0)
    s_barrier
    s_mov_b32 s29, 3
K1T10_LOOP:
    v_add_u32 v6, s45, v29
    s_add_u32 s45, s45, 32768
    s_cmp_eq_u32 s45, 98304
    s_cselect_b32 s45, 0, s45
    s_nop 0
    s_add_u32 m0, s46, 4096
    s_add_u32 s32, s30, 65536
    buffer_load_dwordx4 v22, s[12:15], s32 offen lds
    v_mfma_f32_16x16x32_bf16 v[128:131], v[48:51], v[32:35], v[128:131]
    ds_read_b128 v[80:83], v6 offset:0
    v_mfma_f32_16x16x32_bf16 v[132:135], v[52:55], v[32:35], v[132:135]
    ds_read_b128 v[84:87], v6 offset:2048
    v_mfma_f32_16x16x32_bf16 v[136:139], v[56:59], v[32:35], v[136:139]
    ds_read_b128 v[88:91], v6 offset:4096
    v_mfma_f32_16x16x32_bf16 v[140:143], v[60:63], v[32:35], v[140:143]
    ds_read_b128 v[92:95], v6 offset:6144
    v_mfma_f32_16x16x32_bf16 v[144:147], v[64:67], v[32:35], v[144:147]
    v_mfma_f32_16x16x32_bf16 v[148:151], v[68:71], v[32:35], v[148:151]
    s_add_u32 m0, s46, 5120
    s_add_u32 s32, s30, 81920
    buffer_load_dwordx4 v22, s[12:15], s32 offen lds
    v_mfma_f32_16x16x32_bf16 v[152:155], v[48:51], v[36:39], v[152:155]
    ds_read_b64_tr_b16 v[96:97], v7 offset:14336
    v_mfma_f32_16x16x32_bf16 v[156:159], v[52:55], v[36:39], v[156:159]
    ds_read_b64_tr_b16 v[98:99], v7 offset:16128
    v_mfma_f32_16x16x32_bf16 v[160:163], v[56:59], v[36:39], v[160:163]
    ds_read_b64_tr_b16 v[100:101], v7 offset:21504
    v_mfma_f32_16x16x32_bf16 v[164:167], v[60:63], v[36:39], v[164:167]
    ds_read_b64_tr_b16 v[102:103], v7 offset:23296
    v_mfma_f32_16x16x32_bf16 v[168:171], v[64:67], v[36:39], v[168:171]
    v_mfma_f32_16x16x32_bf16 v[172:175], v[68:71], v[36:39], v[172:175]
    s_add_u32 m0, s46, 6144
    s_add_u32 s32, s30, 98304
    buffer_load_dwordx4 v22, s[12:15], s32 offen lds
    v_mfma_f32_16x16x32_bf16 v[176:179], v[48:51], v[40:43], v[176:179]
    ds_read_b64_tr_b16 v[104:105], v7 offset:14368
    v_mfma_f32_16x16x32_bf16 v[180:183], v[52:55], v[40:43], v[180:183]
    ds_read_b64_tr_b16 v[106:107], v7 offset:16160
    v_mfma_f32_16x16x32_bf16 v[184:187], v[56:59], v[40:43], v[184:187]
    ds_read_b64_tr_b16 v[108:109], v7 offset:21536
    v_mfma_f32_16x16x32_bf16 v[188:191], v[60:63], v[40:43], v[188:191]
    ds_read_b64_tr_b16 v[110:111], v7 offset:23328
    v_mfma_f32_16x16x32_bf16 v[192:195], v[64:67], v[40:43], v[192:195]
    v_mfma_f32_16x16x32_bf16 v[196:199], v[68:71], v[40:43], v[196:199]
    s_add_u32 m0, s46, 7168
    s_add_u32 s32, s30, 114688
    buffer_load_dwordx4 v22, s[12:15], s32 offen lds
    s_add_u32 s30, s30, 128
    s_add_u32 s46, s46, 32768
    s_add_u32 s32, s41, 98304
    s_cmp_eq_u32 s46, s32
    s_cselect_b32 s46, s41, s46
    v_mfma_f32_16x16x32_bf16 v[200:203], v[48:51], v[44:47], v[200:203]
    ds_read_b64_tr_b16 v[112:113], v8 offset:14336
    v_mfma_f32_16x16x32_bf16 v[204:207], v[52:55], v[44:47], v[204:207]
    ds_read_b64_tr_b16 v[114:115], v8 offset:16128
    v_mfma_f32_16x16x32_bf16 v[208:211], v[56:59], v[44:47], v[208:211]
    ds_read_b64_tr_b16 v[116:117], v8 offset:21504
    v_mfma_f32_16x16x32_bf16 v[212:215], v[60:63], v[44:47], v[212:215]
    ds_read_b64_tr_b16 v[118:119], v8 offset:23296
    v_mfma_f32_16x16x32_bf16 v[216:219], v[64:67], v[44:47], v[216:219]
    v_mfma_f32_16x16x32_bf16 v[220:223], v[68:71], v[44:47], v[220:223]
    s_waitcnt vmcnt(8) lgkmcnt(0)
    s_barrier
    v_add_u32 v5, s45, v28
    s_nop 0
    s_add_u32 m0, s46, 0
    s_add_u32 s32, s30, 0
    buffer_load_dwordx4 v22, s[12:15], s32 offen lds
    v_mfma_f32_16x16x32_bf16 v[128:131], v[96:99], v[80:83], v[128:131]
    ds_read_b128 v[32:35], v5 offset:0
    v_mfma_f32_16x16x32_bf16 v[132:135], v[100:103], v[80:83], v[132:135]
    ds_read_b128 v[36:39], v5 offset:2048
    v_mfma_f32_16x16x32_bf16 v[136:139], v[104:107], v[80:83], v[136:139]
    ds_read_b128 v[40:43], v5 offset:4096
    v_mfma_f32_16x16x32_bf16 v[140:143], v[108:111], v[80:83], v[140:143]
    ds_read_b128 v[44:47], v5 offset:6144
    v_mfma_f32_16x16x32_bf16 v[144:147], v[112:115], v[80:83], v[144:147]
    v_mfma_f32_16x16x32_bf16 v[148:151], v[116:119], v[80:83], v[148:151]
    s_add_u32 m0, s46, 1024
    s_add_u32 s32, s30, 16384
    buffer_load_dwordx4 v22, s[12:15], s32 offen lds
    v_mfma_f32_16x16x32_bf16 v[152:155], v[96:99], v[84:87], v[152:155]
    ds_read_b64_tr_b16 v[48:49], v7 offset:28672
    v_mfma_f32_16x16x32_bf16 v[156:159], v[100:103], v[84:87], v[156:159]
    ds_read_b64_tr_b16 v[50:51], v7 offset:30464
    v_mfma_f32_16x16x32_bf16 v[160:163], v[104:107], v[84:87], v[160:163]
    ds_read_b64_tr_b16 v[52:53], v7 offset:35840
    v_mfma_f32_16x16x32_bf16 v[164:167], v[108:111], v[84:87], v[164:167]
    ds_read_b64_tr_b16 v[54:55], v7 offset:37632
    v_mfma_f32_16x16x32_bf16 v[168:171], v[112:115], v[84:87], v[168:171]
    v_mfma_f32_16x16x32_bf16 v[172:175], v[116:119], v[84:87], v[172:175]
    s_add_u32 m0, s46, 2048
    s_add_u32 s32, s30, 32768
    buffer_load_dwordx4 v22, s[12:15], s32 offen lds
    v_mfma_f32_16x16x32_bf16 v[176:179], v[96:99], v[88:91], v[176:179]
    ds_read_b64_tr_b16 v[56:57], v7 offset:28704
    v_mfma_f32_16x16x32_bf16 v[180:183], v[100:103], v[88:91], v[180:183]
    ds_read_b64_tr_b16 v[58:59], v7 offset:30496
    v_mfma_f32_16x16x32_bf16 v[184:187], v[104:107], v[88:91], v[184:187]
    ds_read_b64_tr_b16 v[60:61], v7 offset:35872
    v_mfma_f32_16x16x32_bf16 v[188:191], v[108:111], v[88:91], v[188:191]
    ds_read_b64_tr_b16 v[62:63], v7 offset:37664
    v_mfma_f32_16x16x32_bf16 v[192:195], v[112:115], v[88:91], v[192:195]
    v_mfma_f32_16x16x32_bf16 v[196:199], v[116:119], v[88:91], v[196:199]
    s_add_u32 m0, s46, 3072
    s_add_u32 s32, s30, 49152
    buffer_load_dwordx4 v22, s[12:15], s32 offen lds
    v_mfma_f32_16x16x32_bf16 v[200:203], v[96:99], v[92:95], v[200:203]
    ds_read_b64_tr_b16 v[64:65], v8 offset:28672
    v_mfma_f32_16x16x32_bf16 v[204:207], v[100:103], v[92:95], v[204:207]
    ds_read_b64_tr_b16 v[66:67], v8 offset:30464
    v_mfma_f32_16x16x32_bf16 v[208:211], v[104:107], v[92:95], v[208:211]
    ds_read_b64_tr_b16 v[68:69], v8 offset:35840
    v_mfma_f32_16x16x32_bf16 v[212:215], v[108:111], v[92:95], v[212:215]
    ds_read_b64_tr_b16 v[70:71], v8 offset:37632
    v_mfma_f32_16x16x32_bf16 v[216:219], v[112:115], v[92:95], v[216:219]
    v_mfma_f32_16x16x32_bf16 v[220:223], v[116:119], v[92:95], v[220:223]
    s_waitcnt vmcnt(12) lgkmcnt(0)
    s_barrier
    v_add_u32 v6, s45, v29
    s_add_u32 s45, s45, 32768
    s_cmp_eq_u32 s45, 98304
    s_cselect_b32 s45, 0, s45
    s_nop 0
    s_add_u32 m0, s46, 4096
    s_add_u32 s32, s30, 65536
    buffer_load_dwordx4 v22, s[12:15], s32 offen lds
    v_mfma_f32_16x16x32_bf16 v[128:131], v[48:51], v[32:35], v[128:131]
    ds_read_b128 v[80:83], v6 offset:0
    v_mfma_f32_16x16x32_bf16 v[132:135], v[52:55], v[32:35], v[132:135]
    ds_read_b128 v[84:87], v6 offset:2048
    v_mfma_f32_16x16x32_bf16 v[136:139], v[56:59], v[32:35], v[136:139]
    ds_read_b128 v[88:91], v6 offset:4096
    v_mfma_f32_16x16x32_bf16 v[140:143], v[60:63], v[32:35], v[140:143]
    ds_read_b128 v[92:95], v6 offset:6144
    v_mfma_f32_16x16x32_bf16 v[144:147], v[64:67], v[32:35], v[144:147]
    v_mfma_f32_16x16x32_bf16 v[148:151], v[68:71], v[32:35], v[148:151]
    s_add_u32 m0, s46, 5120
    s_add_u32 s32, s30, 81920
    buffer_load_dwordx4 v22, s[12:15], s32 offen lds
    v_mfma_f32_16x16x32_bf16 v[152:155], v[48:51], v[36:39], v[152:155]
    ds_read_b64_tr_b16 v[96:97], v7 offset:43008
    v_mfma_f32_16x16x32_bf16 v[156:159], v[52:55], v[36:39], v[156:159]
    ds_read_b64_tr_b16 v[98:99], v7 offset:44800
    v_mfma_f32_16x16x32_bf16 v[160:163], v[56:59], v[36:39], v[160:163]
    ds_read_b64_tr_b16 v[100:101], v7 offset:50176
    v_mfma_f32_16x16x32_bf16 v[164:167], v[60:63], v[36:39], v[164:167]
    ds_read_b64_tr_b16 v[102:103], v7 offset:51968
    v_mfma_f32_16x16x32_bf16 v[168:171], v[64:67], v[36:39], v[168:171]
    v_mfma_f32_16x16x32_bf16 v[172:175], v[68:71], v[36:39], v[172:175]
    s_add_u32 m0, s46, 6144
    s_add_u32 s32, s30, 98304
    buffer_load_dwordx4 v22, s[12:15], s32 offen lds
    v_mfma_f32_16x16x32_bf16 v[176:179], v[48:51], v[40:43], v[176:179]
    ds_read_b64_tr_b16 v[104:105], v7 offset:43040
    v_mfma_f32_16x16x32_bf16 v[180:183], v[52:55], v[40:43], v[180:183]
    ds_read_b64_tr_b16 v[106:107], v7 offset:44832
    v_mfma_f32_16x16x32_bf16 v[184:187], v[56:59], v[40:43], v[184:187]
    ds_read_b64_tr_b16 v[108:109], v7 offset:50208
    v_mfma_f32_16x16x32_bf16 v[188:191], v[60:63], v[40:43], v[188:191]
    ds_read_b64_tr_b16 v[110:111], v7 offset:52000
    v_mfma_f32_16x16x32_bf16 v[192:195], v[64:67], v[40:43], v[192:195]
    v_mfma_f32_16x16x32_bf16 v[196:199], v[68:71], v[40:43], v[196:199]
    s_add_u32 m0, s46, 7168
    s_add_u32 s32, s30, 114688
    buffer_load_dwordx4 v22, s[12:15], s32 offen lds
    s_add_u32 s30, s30, 128
    s_add_u32 s46, s46, 32768
    s_add_u32 s32, s41, 98304
    s_cmp_eq_u32 s46, s32
    s_cselect_b32 s46, s41, s46
    v_mfma_f32_16x16x32_bf16 v[200:203], v[48:51], v[44:47], v[200:203]
    ds_read_b64_tr_b16 v[112:113], v8 offset:43008
    v_mfma_f32_16x16x32_bf16 v[204:207], v[52:55], v[44:47], v[204:207]
    ds_read_b64_tr_b16 v[114:115], v8 offset:44800
    v_mfma_f32_16x16x32_bf16 v[208:211], v[56:59], v[44:47], v[208:211]
    ds_read_b64_tr_b16 v[116:117], v8 offset:50176
    v_mfma_f32_16x16x32_bf16 v[212:215], v[60:63], v[44:47], v[212:215]
    ds_read_b64_tr_b16 v[118:119], v8 offset:51968
    v_mfma_f32_16x16x32_bf16 v[216:219], v[64:67], v[44:47], v[216:219]
    v_mfma_f32_16x16x32_bf16 v[220:223], v[68:71], v[44:47], v[220:223]
    s_waitcnt vmcnt(8) lgkmcnt(0)
    s_barrier
    v_add_u32 v5, s45, v28
    s_nop 0
    s_add_u32 m0, s46, 0
    s_add_u32 s32, s30, 0
    buffer_load_dwordx4 v22, s[12:15], s32 offen lds
    v_mfma_f32_16x16x32_bf16 v[128:131], v[96:99], v[80:83], v[128:131]
    ds_read_b128 v[32:35], v5 offset:0
    v_mfma_f32_16x16x32_bf16 v[132:135], v[100:103], v[80:83], v[132:135]
    ds_read_b128 v[36:39], v5 offset:2048
    v_mfma_f32_16x16x32_bf16 v[136:139], v[104:107], v[80:83], v[136:139]
    ds_read_b128 v[40:43], v5 offset:4096
    v_mfma_f32_16x16x32_bf16 v[140:143], v[108:111], v[80:83], v[140:143]
    ds_read_b128 v[44:47], v5 offset:6144
    v_mfma_f32_16x16x32_bf16 v[144:147], v[112:115], v[80:83], v[144:147]
    v_mfma_f32_16x16x32_bf16 v[148:151], v[116:119], v[80:83], v[148:151]
    s_add_u32 m0, s46, 1024
    s_add_u32 s32, s30, 16384
    buffer_load_dwordx4 v22, s[12:15], s32 offen lds
    v_mfma_f32_16x16x32_bf16 v[152:155], v[96:99], v[84:87], v[152:155]
    ds_read_b64_tr_b16 v[48:49], v7 offset:0
    v_mfma_f32_16x16x32_bf16 v[156:159], v[100:103], v[84:87], v[156:159]
    ds_read_b64_tr_b16 v[50:51], v7 offset:1792
    v_mfma_f32_16x16x32_bf16 v[160:163], v[104:107], v[84:87], v[160:163]
    ds_read_b64_tr_b16 v[52:53], v7 offset:7168
    v_mfma_f32_16x16x32_bf16 v[164:167], v[108:111], v[84:87], v[164:167]
    ds_read_b64_tr_b16 v[54:55], v7 offset:8960
    v_mfma_f32_16x16x32_bf16 v[168:171], v[112:115], v[84:87], v[168:171]
    v_mfma_f32_16x16x32_bf16 v[172:175], v[116:119], v[84:87], v[172:175]
    s_add_u32 m0, s46, 2048
    s_add_u32 s32, s30, 32768
    buffer_load_dwordx4 v22, s[12:15], s32 offen lds
    v_mfma_f32_16x16x32_bf16 v[176:179], v[96:99], v[88:91], v[176:179]
    ds_read_b64_tr_b16 v[56:57], v7 offset:32
    v_mfma_f32_16x16x32_bf16 v[180:183], v[100:103], v[88:91], v[180:183]
    ds_read_b64_tr_b16 v[58:59], v7 offset:1824
    v_mfma_f32_16x16x32_bf16 v[184:187], v[104:107], v[88:91], v[184:187]
    ds_read_b64_tr_b16 v[60:61], v7 offset:7200
    v_mfma_f32_16x16x32_bf16 v[188:191], v[108:111], v[88:91], v[188:191]
    ds_read_b64_tr_b16 v[62:63], v7 offset:8992
    v_mfma_f32_16x16x32_bf16 v[192:195], v[112:115], v[88:91], v[192:195]
    v_mfma_f32_16x16x32_bf16 v[196:199], v[116:119], v[88:91], v[196:199]
    s_add_u32 m0, s46, 3072
    s_add_u32 s32, s30, 49152
    buffer_load_dwordx4 v22, s[12:15], s32 offen lds
    v_mfma_f32_16x16x32_bf16 v[200:203], v[96:99], v[92:95], v[200:203]
    ds_read_b64_tr_b16 v[64:65], v8 offset:0
    v_mfma_f32_16x16x32_bf16 v[204:207], v[100:103], v[92:95], v[204:207]
    ds_read_b64_tr_b16 v[66:67], v8 offset:1792
    v_mfma_f32_16x16x32_bf16 v[208:211], v[104:107], v[92:95], v[208:211]
    ds_read_b64_tr_b16 v[68:69], v8 offset:7168
    v_mfma_f32_16x16x32_bf16 v[212:215], v[108:111], v[92:95], v[212:215]
    ds_read_b64_tr_b16 v[70:71], v8 offset:8960
    v_mfma_f32_16x16x32_bf16 v[216:219], v[112:115], v[92:95], v[216:219]
    v_mfma_f32_16x16x32_bf16 v[220:223], v[116:119], v[92:95], v[220:223]
    s_waitcnt vmcnt(12) lgkmcnt(0)
    s_barrier
    s_sub_u32 s29, s29, 1
    s_cmp_lg_u32 s29, 0
    s_cbranch_scc1 K1T10_LOOP
    v_add_u32 v6, s45, v29
    s_add_u32 s45, s45, 32768
    s_cmp_eq_u32 s45, 98304
    s_cselect_b32 s45, 0, s45
    s_nop 0
    s_add_u32 m0, s46, 4096
    s_add_u32 s32, s30, 65536
    buffer_load_dwordx4 v22, s[12:15], s32 offen lds
    v_mfma_f32_16x16x32_bf16 v[128:131], v[48:51], v[32:35], v[128:131]
    ds_read_b128 v[80:83], v6 offset:0
    v_mfma_f32_16x16x32_bf16 v[132:135], v[52:55], v[32:35], v[132:135]
    ds_read_b128 v[84:87], v6 offset:2048
    v_mfma_f32_16x16x32_bf16 v[136:139], v[56:59], v[32:35], v[136:139]
    ds_read_b128 v[88:91], v6 offset:4096
    v_mfma_f32_16x16x32_bf16 v[140:143], v[60:63], v[32:35], v[140:143]
    ds_read_b128 v[92:95], v6 offset:6144
    v_mfma_f32_16x16x32_bf16 v[144:147], v[64:67], v[32:35], v[144:147]
    v_mfma_f32_16x16x32_bf16 v[148:151], v[68:71], v[32:35], v[148:151]
    s_add_u32 m0, s46, 5120
    s_add_u32 s32, s30, 81920
    buffer_load_dwordx4 v22, s[12:15], s32 offen lds
    v_mfma_f32_16x16x32_bf16 v[152:155], v[48:51], v[36:39], v[152:155]
    ds_read_b64_tr_b16 v[96:97], v7 offset:14336
    v_mfma_f32_16x16x32_bf16 v[156:159], v[52:55], v[36:39], v[156:159]
    ds_read_b64_tr_b16 v[98:99], v7 offset:16128
    v_mfma_f32_16x16x32_bf16 v[160:163], v[56:59], v[36:39], v[160:163]
    ds_read_b64_tr_b16 v[100:101], v7 offset:21504
    v_mfma_f32_16x16x32_bf16 v[164:167], v[60:63], v[36:39], v[164:167]
    ds_read_b64_tr_b16 v[102:103], v7 offset:23296
    v_mfma_f32_16x16x32_bf16 v[168:171], v[64:67], v[36:39], v[168:171]
    v_mfma_f32_16x16x32_bf16 v[172:175], v[68:71], v[36:39], v[172:175]
    s_add_u32 m0, s46, 6144
    s_add_u32 s32, s30, 98304
    buffer_load_dwordx4 v22, s[12:15], s32 offen lds
    v_mfma_f32_16x16x32_bf16 v[176:179], v[48:51], v[40:43], v[176:179]
    ds_read_b64_tr_b16 v[104:105], v7 offset:14368
    v_mfma_f32_16x16x32_bf16 v[180:183], v[52:55], v[40:43], v[180:183]
    ds_read_b64_tr_b16 v[106:107], v7 offset:16160
    v_mfma_f32_16x16x32_bf16 v[184:187], v[56:59], v[40:43], v[184:187]
    ds_read_b64_tr_b16 v[108:109], v7 offset:21536
    v_mfma_f32_16x16x32_bf16 v[188:191], v[60:63], v[40:43], v[188:191]
    ds_read_b64_tr_b16 v[110:111], v7 offset:23328
    v_mfma_f32_16x16x32_bf16 v[192:195], v[64:67], v[40:43], v[192:195]
    v_mfma_f32_16x16x32_bf16 v[196:199], v[68:71], v[40:43], v[196:199]
    s_add_u32 m0, s46, 7168
    s_add_u32 s32, s30, 114688
    buffer_load_dwordx4 v22, s[12:15], s32 offen lds
    s_add_u32 s30, s30, 128
    s_add_u32 s46, s46, 32768
    s_add_u32 s32, s41, 98304
    s_cmp_eq_u32 s46, s32
    s_cselect_b32 s46, s41, s46
    v_mfma_f32_16x16x32_bf16 v[200:203], v[48:51], v[44:47], v[200:203]
    ds_read_b64_tr_b16 v[112:113], v8 offset:14336
    v_mfma_f32_16x16x32_bf16 v[204:207], v[52:55], v[44:47], v[204:207]
    ds_read_b64_tr_b16 v[114:115], v8 offset:16128
    v_mfma_f32_16x16x32_bf16 v[208:211], v[56:59], v[44:47], v[208:211]
    ds_read_b64_tr_b16 v[116:117], v8 offset:21504
    v_mfma_f32_16x16x32_bf16 v[212:215], v[60:63], v[44:47], v[212:215]
    ds_read_b64_tr_b16 v[118:119], v8 offset:23296
    v_mfma_f32_16x16x32_bf16 v[216:219], v[64:67], v[44:47], v[216:219]
    v_mfma_f32_16x16x32_bf16 v[220:223], v[68:71], v[44:47], v[220:223]
    s_waitcnt vmcnt(8) lgkmcnt(0)
    s_barrier
    v_add_u32 v5, s45, v28
    s_nop 0
    s_add_u32 m0, s46, 0
    s_add_u32 s32, s30, 0
    buffer_load_dwordx4 v22, s[12:15], s32 offen lds
    v_mfma_f32_16x16x32_bf16 v[128:131], v[96:99], v[80:83], v[128:131]
    ds_read_b128 v[32:35], v5 offset:0
    v_mfma_f32_16x16x32_bf16 v[132:135], v[100:103], v[80:83], v[132:135]
    ds_read_b128 v[36:39], v5 offset:2048
    v_mfma_f32_16x16x32_bf16 v[136:139], v[104:107], v[80:83], v[136:139]
    ds_read_b128 v[40:43], v5 offset:4096
    v_mfma_f32_16x16x32_bf16 v[140:143], v[108:111], v[80:83], v[140:143]
    ds_read_b128 v[44:47], v5 offset:6144
    v_mfma_f32_16x16x32_bf16 v[144:147], v[112:115], v[80:83], v[144:147]
    v_mfma_f32_16x16x32_bf16 v[148:151], v[116:119], v[80:83], v[148:151]
    s_add_u32 m0, s46, 1024
    s_add_u32 s32, s30, 16384
    buffer_load_dwordx4 v22, s[12:15], s32 offen lds
    v_mfma_f32_16x16x32_bf16 v[152:155], v[96:99], v[84:87], v[152:155]
    ds_read_b64_tr_b16 v[48:49], v7 offset:28672
    v_mfma_f32_16x16x32_bf16 v[156:159], v[100:103], v[84:87], v[156:159]
    ds_read_b64_tr_b16 v[50:51], v7 offset:30464
    v_mfma_f32_16x16x32_bf16 v[160:163], v[104:107], v[84:87], v[160:163]
    ds_read_b64_tr_b16 v[52:53], v7 offset:35840
    v_mfma_f32_16x16x32_bf16 v[164:167], v[108:111], v[84:87], v[164:167]
    ds_read_b64_tr_b16 v[54:55], v7 offset:37632
    v_mfma_f32_16x16x32_bf16 v[168:171], v[112:115], v[84:87], v[168:171]
    v_mfma_f32_16x16x32_bf16 v[172:175], v[116:119], v[84:87], v[172:175]
    s_add_u32 m0, s46, 2048
    s_add_u32 s32, s30, 32768
    buffer_load_dwordx4 v22, s[12:15], s32 offen lds
    v_mfma_f32_16x16x32_bf16 v[176:179], v[96:99], v[88:91], v[176:179]
    ds_read_b64_tr_b16 v[56:57], v7 offset:28704
    v_mfma_f32_16x16x32_bf16 v[180:183], v[100:103], v[88:91], v[180:183]
    ds_read_b64_tr_b16 v[58:59], v7 offset:30496
    v_mfma_f32_16x16x32_bf16 v[184:187], v[104:107], v[88:91], v[184:187]
    ds_read_b64_tr_b16 v[60:61], v7 offset:35872
    v_mfma_f32_16x16x32_bf16 v[188:191], v[108:111], v[88:91], v[188:191]
    ds_read_b64_tr_b16 v[62:63], v7 offset:37664
    v_mfma_f32_16x16x32_bf16 v[192:195], v[112:115], v[88:91], v[192:195]
    v_mfma_f32_16x16x32_bf16 v[196:199], v[116:119], v[88:91], v[196:199]
    s_add_u32 m0, s46, 3072
    s_add_u32 s32, s30, 49152
    buffer_load_dwordx4 v22, s[12:15], s32 offen lds
    v_mfma_f32_16x16x32_bf16 v[200:203], v[96:99], v[92:95], v[200:203]
    ds_read_b64_tr_b16 v[64:65], v8 offset:28672
    v_mfma_f32_16x16x32_bf16 v[204:207], v[100:103], v[92:95], v[204:207]
    ds_read_b64_tr_b16 v[66:67], v8 offset:30464
    v_mfma_f32_16x16x32_bf16 v[208:211], v[104:107], v[92:95], v[208:211]
    ds_read_b64_tr_b16 v[68:69], v8 offset:35840
    v_mfma_f32_16x16x32_bf16 v[212:215], v[108:111], v[92:95], v[212:215]
    ds_read_b64_tr_b16 v[70:71], v8 offset:37632
    v_mfma_f32_16x16x32_bf16 v[216:219], v[112:115], v[92:95], v[216:219]
    v_mfma_f32_16x16x32_bf16 v[220:223], v[116:119], v[92:95], v[220:223]
    s_waitcnt vmcnt(12) lgkmcnt(0)
    s_barrier
    v_add_u32 v6, s45, v29
    s_add_u32 s45, s45, 32768
    s_cmp_eq_u32 s45, 98304
    s_cselect_b32 s45, 0, s45
    s_nop 0
    s_add_u32 m0, s46, 4096
    s_add_u32 s32, s30, 65536
    buffer_load_dwordx4 v22, s[12:15], s32 offen lds
    v_mfma_f32_16x16x32_bf16 v[128:131], v[48:51], v[32:35], v[128:131]
    ds_read_b128 v[80:83], v6 offset:0
    v_mfma_f32_16x16x32_bf16 v[132:135], v[52:55], v[32:35], v[132:135]
    ds_read_b128 v[84:87], v6 offset:2048
    v_mfma_f32_16x16x32_bf16 v[136:139], v[56:59], v[32:35], v[136:139]
    ds_read_b128 v[88:91], v6 offset:4096
    v_mfma_f32_16x16x32_bf16 v[140:143], v[60:63], v[32:35], v[140:143]
    ds_read_b128 v[92:95], v6 offset:6144
    v_mfma_f32_16x16x32_bf16 v[144:147], v[64:67], v[32:35], v[144:147]
    v_mfma_f32_16x16x32_bf16 v[148:151], v[68:71], v[32:35], v[148:151]
    s_add_u32 m0, s46, 5120
    s_add_u32 s32, s30, 81920
    buffer_load_dwordx4 v22, s[12:15], s32 offen lds
    v_mfma_f32_16x16x32_bf16 v[152:155], v[48:51], v[36:39], v[152:155]
    ds_read_b64_tr_b16 v[96:97], v7 offset:43008
    v_mfma_f32_16x16x32_bf16 v[156:159], v[52:55], v[36:39], v[156:159]
    ds_read_b64_tr_b16 v[98:99], v7 offset:44800
    v_mfma_f32_16x16x32_bf16 v[160:163], v[56:59], v[36:39], v[160:163]
    ds_read_b64_tr_b16 v[100:101], v7 offset:50176
    v_mfma_f32_16x16x32_bf16 v[164:167], v[60:63], v[36:39], v[164:167]
    ds_read_b64_tr_b16 v[102:103], v7 offset:51968
    v_mfma_f32_16x16x32_bf16 v[168:171], v[64:67], v[36:39], v[168:171]
    v_mfma_f32_16x16x32_bf16 v[172:175], v[68:71], v[36:39], v[172:175]
    s_add_u32 m0, s46, 6144
    s_add_u32 s32, s30, 98304
    buffer_load_dwordx4 v22, s[12:15], s32 offen lds
    v_mfma_f32_16x16x32_bf16 v[176:179], v[48:51], v[40:43], v[176:179]
    ds_read_b64_tr_b16 v[104:105], v7 offset:43040
    v_mfma_f32_16x16x32_bf16 v[180:183], v[52:55], v[40:43], v[180:183]
    ds_read_b64_tr_b16 v[106:107], v7 offset:44832
    v_mfma_f32_16x16x32_bf16 v[184:187], v[56:59], v[40:43], v[184:187]
    ds_read_b64_tr_b16 v[108:109], v7 offset:50208
    v_mfma_f32_16x16x32_bf16 v[188:191], v[60:63], v[40:43], v[188:191]
    ds_read_b64_tr_b16 v[110:111], v7 offset:52000
    v_mfma_f32_16x16x32_bf16 v[192:195], v[64:67], v[40:43], v[192:195]
    v_mfma_f32_16x16x32_bf16 v[196:199], v[68:71], v[40:43], v[196:199]
    s_add_u32 m0, s46, 7168
    s_add_u32 s32, s30, 114688
    buffer_load_dwordx4 v22, s[12:15], s32 offen lds
    s_add_u32 s30, s30, 128
    s_add_u32 s46, s46, 32768
    s_add_u32 s32, s41, 98304
    s_cmp_eq_u32 s46, s32
    s_cselect_b32 s46, s41, s46
    v_mfma_f32_16x16x32_bf16 v[200:203], v[48:51], v[44:47], v[200:203]
    ds_read_b64_tr_b16 v[112:113], v8 offset:43008
    v_mfma_f32_16x16x32_bf16 v[204:207], v[52:55], v[44:47], v[204:207]
    ds_read_b64_tr_b16 v[114:115], v8 offset:44800
    v_mfma_f32_16x16x32_bf16 v[208:211], v[56:59], v[44:47], v[208:211]
    ds_read_b64_tr_b16 v[116:117], v8 offset:50176
    v_mfma_f32_16x16x32_bf16 v[212:215], v[60:63], v[44:47], v[212:215]
    ds_read_b64_tr_b16 v[118:119], v8 offset:51968
    v_mfma_f32_16x16x32_bf16 v[216:219], v[64:67], v[44:47], v[216:219]
    v_mfma_f32_16x16x32_bf16 v[220:223], v[68:71], v[44:47], v[220:223]
    s_waitcnt vmcnt(8) lgkmcnt(0)
    s_barrier
    v_add_u32 v5, s45, v28
    s_nop 0
    ds_read_b128 v[32:35], v5 offset:0
    v_mfma_f32_16x16x32_bf16 v[128:131], v[96:99], v[80:83], v[128:131]
    ds_read_b128 v[36:39], v5 offset:2048
    v_mfma_f32_16x16x32_bf16 v[132:135], v[100:103], v[80:83], v[132:135]
    v_mfma_f32_16x16x32_bf16 v[136:139], v[104:107], v[80:83], v[136:139]
    ds_read_b128 v[40:43], v5 offset:4096
    v_mfma_f32_16x16x32_bf16 v[140:143], v[108:111], v[80:83], v[140:143]
    ds_read_b128 v[44:47], v5 offset:6144
    v_mfma_f32_16x16x32_bf16 v[144:147], v[112:115], v[80:83], v[144:147]
    v_mfma_f32_16x16x32_bf16 v[148:151], v[116:119], v[80:83], v[148:151]
    ds_read_b64_tr_b16 v[48:49], v7 offset:0
    v_mfma_f32_16x16x32_bf16 v[152:155], v[96:99], v[84:87], v[152:155]
    ds_read_b64_tr_b16 v[50:51], v7 offset:1792
    v_mfma_f32_16x16x32_bf16 v[156:159], v[100:103], v[84:87], v[156:159]
    v_mfma_f32_16x16x32_bf16 v[160:163], v[104:107], v[84:87], v[160:163]
    ds_read_b64_tr_b16 v[52:53], v7 offset:7168
    v_mfma_f32_16x16x32_bf16 v[164:167], v[108:111], v[84:87], v[164:167]
    ds_read_b64_tr_b16 v[54:55], v7 offset:8960
    v_mfma_f32_16x16x32_bf16 v[168:171], v[112:115], v[84:87], v[168:171]
    v_mfma_f32_16x16x32_bf16 v[172:175], v[116:119], v[84:87], v[172:175]
    ds_read_b64_tr_b16 v[56:57], v7 offset:32
    v_mfma_f32_16x16x32_bf16 v[176:179], v[96:99], v[88:91], v[176:179]
    ds_read_b64_tr_b16 v[58:59], v7 offset:1824
    v_mfma_f32_16x16x32_bf16 v[180:183], v[100:103], v[88:91], v[180:183]
    v_mfma_f32_16x16x32_bf16 v[184:187], v[104:107], v[88:91], v[184:187]
    ds_read_b64_tr_b16 v[60:61], v7 offset:7200
    v_mfma_f32_16x16x32_bf16 v[188:191], v[108:111], v[88:91], v[188:191]
    ds_read_b64_tr_b16 v[62:63], v7 offset:8992
    v_mfma_f32_16x16x32_bf16 v[192:195], v[112:115], v[88:91], v[192:195]
    v_mfma_f32_16x16x32_bf16 v[196:199], v[116:119], v[88:91], v[196:199]
    ds_read_b64_tr_b16 v[64:65], v8 offset:0
    v_mfma_f32_16x16x32_bf16 v[200:203], v[96:99], v[92:95], v[200:203]
    ds_read_b64_tr_b16 v[66:67], v8 offset:1792
    v_mfma_f32_16x16x32_bf16 v[204:207], v[100:103], v[92:95], v[204:207]
    v_mfma_f32_16x16x32_bf16 v[208:211], v[104:107], v[92:95], v[208:211]
    ds_read_b64_tr_b16 v[68:69], v8 offset:7168
    v_mfma_f32_16x16x32_bf16 v[212:215], v[108:111], v[92:95], v[212:215]
    ds_read_b64_tr_b16 v[70:71], v8 offset:8960
    v_mfma_f32_16x16x32_bf16 v[216:219], v[112:115], v[92:95], v[216:219]
    v_mfma_f32_16x16x32_bf16 v[220:223], v[116:119], v[92:95], v[220:223]
    s_waitcnt vmcnt(8) lgkmcnt(0)
    s_barrier
    v_add_u32 v6, s45, v29
    s_add_u32 s45, s45, 32768
    s_cmp_eq_u32 s45, 98304
    s_cselect_b32 s45, 0, s45
    s_nop 0
    ds_read_b128 v[80:83], v6 offset:0
    v_mfma_f32_16x16x32_bf16 v[128:131], v[48:51], v[32:35], v[128:131]
    ds_read_b128 v[84:87], v6 offset:2048
    v_mfma_f32_16x16x32_bf16 v[132:135], v[52:55], v[32:35], v[132:135]
    v_mfma_f32_16x16x32_bf16 v[136:139], v[56:59], v[32:35], v[136:139]
    ds_read_b128 v[88:91], v6 offset:4096
    v_mfma_f32_16x16x32_bf16 v[140:143], v[60:63], v[32:35], v[140:143]
    ds_read_b128 v[92:95], v6 offset:6144
    v_mfma_f32_16x16x32_bf16 v[144:147], v[64:67], v[32:35], v[144:147]
    v_mfma_f32_16x16x32_bf16 v[148:151], v[68:71], v[32:35], v[148:151]
    ds_read_b64_tr_b16 v[96:97], v7 offset:14336
    v_mfma_f32_16x16x32_bf16 v[152:155], v[48:51], v[36:39], v[152:155]
    ds_read_b64_tr_b16 v[98:99], v7 offset:16128
    v_mfma_f32_16x16x32_bf16 v[156:159], v[52:55], v[36:39], v[156:159]
    v_mfma_f32_16x16x32_bf16 v[160:163], v[56:59], v[36:39], v[160:163]
    ds_read_b64_tr_b16 v[100:101], v7 offset:21504
    v_mfma_f32_16x16x32_bf16 v[164:167], v[60:63], v[36:39], v[164:167]
    ds_read_b64_tr_b16 v[102:103], v7 offset:23296
    v_mfma_f32_16x16x32_bf16 v[168:171], v[64:67], v[36:39], v[168:171]
    v_mfma_f32_16x16x32_bf16 v[172:175], v[68:71], v[36:39], v[172:175]
    ds_read_b64_tr_b16 v[104:105], v7 offset:14368
    v_mfma_f32_16x16x32_bf16 v[176:179], v[48:51], v[40:43], v[176:179]
    ds_read_b64_tr_b16 v[106:107], v7 offset:16160
    v_mfma_f32_16x16x32_bf16 v[180:183], v[52:55], v[40:43], v[180:183]
    v_mfma_f32_16x16x32_bf16 v[184:187], v[56:59], v[40:43], v[184:187]
    ds_read_b64_tr_b16 v[108:109], v7 offset:21536
    v_mfma_f32_16x16x32_bf16 v[188:191], v[60:63], v[40:43], v[188:191]
    ds_read_b64_tr_b16 v[110:111], v7 offset:23328
    v_mfma_f32_16x16x32_bf16 v[192:195], v[64:67], v[40:43], v[192:195]
    v_mfma_f32_16x16x32_bf16 v[196:199], v[68:71], v[40:43], v[196:199]
    ds_read_b64_tr_b16 v[112:113], v8 offset:14336
    v_mfma_f32_16x16x32_bf16 v[200:203], v[48:51], v[44:47], v[200:203]
    ds_read_b64_tr_b16 v[114:115], v8 offset:16128
    v_mfma_f32_16x16x32_bf16 v[204:207], v[52:55], v[44:47], v[204:207]
    v_mfma_f32_16x16x32_bf16 v[208:211], v[56:59], v[44:47], v[208:211]
    ds_read_b64_tr_b16 v[116:117], v8 offset:21504
    v_mfma_f32_16x16x32_bf16 v[212:215], v[60:63], v[44:47], v[212:215]
    ds_read_b64_tr_b16 v[118:119], v8 offset:23296
    v_mfma_f32_16x16x32_bf16 v[216:219], v[64:67], v[44:47], v[216:219]
    v_mfma_f32_16x16x32_bf16 v[220:223], v[68:71], v[44:47], v[220:223]
    s_waitcnt vmcnt(0) lgkmcnt(0)
    s_barrier
    v_add_u32 v5, s45, v28
    s_nop 0
    ds_read_b128 v[32:35], v5 offset:0
    v_mfma_f32_16x16x32_bf16 v[128:131], v[96:99], v[80:83], v[128:131]
    ds_read_b128 v[36:39], v5 offset:2048
    v_mfma_f32_16x16x32_bf16 v[132:135], v[100:103], v[80:83], v[132:135]
    v_mfma_f32_16x16x32_bf16 v[136:139], v[104:107], v[80:83], v[136:139]
    ds_read_b128 v[40:43], v5 offset:4096
    v_mfma_f32_16x16x32_bf16 v[140:143], v[108:111], v[80:83], v[140:143]
    ds_read_b128 v[44:47], v5 offset:6144
    v_mfma_f32_16x16x32_bf16 v[144:147], v[112:115], v[80:83], v[144:147]
    v_mfma_f32_16x16x32_bf16 v[148:151], v[116:119], v[80:83], v[148:151]
    ds_read_b64_tr_b16 v[48:49], v7 offset:28672
    v_mfma_f32_16x16x32_bf16 v[152:155], v[96:99], v[84:87], v[152:155]
    ds_read_b64_tr_b16 v[50:51], v7 offset:30464
    v_mfma_f32_16x16x32_bf16 v[156:159], v[100:103], v[84:87], v[156:159]
    v_mfma_f32_16x16x32_bf16 v[160:163], v[104:107], v[84:87], v[160:163]
    ds_read_b64_tr_b16 v[52:53], v7 offset:35840
    v_mfma_f32_16x16x32_bf16 v[164:167], v[108:111], v[84:87], v[164:167]
    ds_read_b64_tr_b16 v[54:55], v7 offset:37632
    v_mfma_f32_16x16x32_bf16 v[168:171], v[112:115], v[84:87], v[168:171]
    v_mfma_f32_16x16x32_bf16 v[172:175], v[116:119], v[84:87], v[172:175]
    ds_read_b64_tr_b16 v[56:57], v7 offset:28704
    v_mfma_f32_16x16x32_bf16 v[176:179], v[96:99], v[88:91], v[176:179]
    ds_read_b64_tr_b16 v[58:59], v7 offset:30496
    v_mfma_f32_16x16x32_bf16 v[180:183], v[100:103], v[88:91], v[180:183]
    v_mfma_f32_16x16x32_bf16 v[184:187], v[104:107], v[88:91], v[184:187]
    ds_read_b64_tr_b16 v[60:61], v7 offset:35872
    v_mfma_f32_16x16x32_bf16 v[188:191], v[108:111], v[88:91], v[188:191]
    ds_read_b64_tr_b16 v[62:63], v7 offset:37664
    v_mfma_f32_16x16x32_bf16 v[192:195], v[112:115], v[88:91], v[192:195]
    v_mfma_f32_16x16x32_bf16 v[196:199], v[116:119], v[88:91], v[196:199]
    ds_read_b64_tr_b16 v[64:65], v8 offset:28672
    v_mfma_f32_16x16x32_bf16 v[200:203], v[96:99], v[92:95], v[200:203]
    ds_read_b64_tr_b16 v[66:67], v8 offset:30464
    v_mfma_f32_16x16x32_bf16 v[204:207], v[100:103], v[92:95], v[204:207]
    v_mfma_f32_16x16x32_bf16 v[208:211], v[104:107], v[92:95], v[208:211]
    ds_read_b64_tr_b16 v[68:69], v8 offset:35840
    v_mfma_f32_16x16x32_bf16 v[212:215], v[108:111], v[92:95], v[212:215]
    ds_read_b64_tr_b16 v[70:71], v8 offset:37632
    v_mfma_f32_16x16x32_bf16 v[216:219], v[112:115], v[92:95], v[216:219]
    v_mfma_f32_16x16x32_bf16 v[220:223], v[116:119], v[92:95], v[220:223]
    s_waitcnt vmcnt(0) lgkmcnt(0)
    s_barrier
    v_add_u32 v6, s45, v29
    s_add_u32 s45, s45, 32768
    s_cmp_eq_u32 s45, 98304
    s_cselect_b32 s45, 0, s45
    s_nop 0
    ds_read_b128 v[80:83], v6 offset:0
    v_mfma_f32_16x16x32_bf16 v[128:131], v[48:51], v[32:35], v[128:131]
    ds_read_b128 v[84:87], v6 offset:2048
    v_mfma_f32_16x16x32_bf16 v[132:135], v[52:55], v[32:35], v[132:135]
    v_mfma_f32_16x16x32_bf16 v[136:139], v[56:59], v[32:35], v[136:139]
    ds_read_b128 v[88:91], v6 offset:4096
    v_mfma_f32_16x16x32_bf16 v[140:143], v[60:63], v[32:35], v[140:143]
    ds_read_b128 v[92:95], v6 offset:6144
    v_mfma_f32_16x16x32_bf16 v[144:147], v[64:67], v[32:35], v[144:147]
    v_mfma_f32_16x16x32_bf16 v[148:151], v[68:71], v[32:35], v[148:151]
    ds_read_b64_tr_b16 v[96:97], v7 offset:43008
    v_mfma_f32_16x16x32_bf16 v[152:155], v[48:51], v[36:39], v[152:155]
    ds_read_b64_tr_b16 v[98:99], v7 offset:44800
    v_mfma_f32_16x16x32_bf16 v[156:159], v[52:55], v[36:39], v[156:159]
    v_mfma_f32_16x16x32_bf16 v[160:163], v[56:59], v[36:39], v[160:163]
    ds_read_b64_tr_b16 v[100:101], v7 offset:50176
    v_mfma_f32_16x16x32_bf16 v[164:167], v[60:63], v[36:39], v[164:167]
    ds_read_b64_tr_b16 v[102:103], v7 offset:51968
    v_mfma_f32_16x16x32_bf16 v[168:171], v[64:67], v[36:39], v[168:171]
    v_mfma_f32_16x16x32_bf16 v[172:175], v[68:71], v[36:39], v[172:175]
    ds_read_b64_tr_b16 v[104:105], v7 offset:43040
    v_mfma_f32_16x16x32_bf16 v[176:179], v[48:51], v[40:43], v[176:179]
    ds_read_b64_tr_b16 v[106:107], v7 offset:44832
    v_mfma_f32_16x16x32_bf16 v[180:183], v[52:55], v[40:43], v[180:183]
    v_mfma_f32_16x16x32_bf16 v[184:187], v[56:59], v[40:43], v[184:187]
    ds_read_b64_tr_b16 v[108:109], v7 offset:50208
    v_mfma_f32_16x16x32_bf16 v[188:191], v[60:63], v[40:43], v[188:191]
    ds_read_b64_tr_b16 v[110:111], v7 offset:52000
    v_mfma_f32_16x16x32_bf16 v[192:195], v[64:67], v[40:43], v[192:195]
    v_mfma_f32_16x16x32_bf16 v[196:199], v[68:71], v[40:43], v[196:199]
    ds_read_b64_tr_b16 v[112:113], v8 offset:43008
    v_mfma_f32_16x16x32_bf16 v[200:203], v[48:51], v[44:47], v[200:203]
    ds_read_b64_tr_b16 v[114:115], v8 offset:44800
    v_mfma_f32_16x16x32_bf16 v[204:207], v[52:55], v[44:47], v[204:207]
    v_mfma_f32_16x16x32_bf16 v[208:211], v[56:59], v[44:47], v[208:211]
    ds_read_b64_tr_b16 v[116:117], v8 offset:50176
    v_mfma_f32_16x16x32_bf16 v[212:215], v[60:63], v[44:47], v[212:215]
    ds_read_b64_tr_b16 v[118:119], v8 offset:51968
    v_mfma_f32_16x16x32_bf16 v[216:219], v[64:67], v[44:47], v[216:219]
    v_mfma_f32_16x16x32_bf16 v[220:223], v[68:71], v[44:47], v[220:223]
    s_waitcnt vmcnt(63) lgkmcnt(0)
    v_mfma_f32_16x16x32_bf16 v[128:131], v[96:99], v[80:83], v[128:131]
    v_mfma_f32_16x16x32_bf16 v[132:135], v[100:103], v[80:83], v[132:135]
    v_mfma_f32_16x16x32_bf16 v[136:139], v[104:107], v[80:83], v[136:139]
    v_mfma_f32_16x16x32_bf16 v[140:143], v[108:111], v[80:83], v[140:143]
    v_mfma_f32_16x16x32_bf16 v[144:147], v[112:115], v[80:83], v[144:147]
    v_mfma_f32_16x16x32_bf16 v[148:151], v[116:119], v[80:83], v[148:151]
    v_mfma_f32_16x16x32_bf16 v[152:155], v[96:99], v[84:87], v[152:155]
    v_mfma_f32_16x16x32_bf16 v[156:159], v[100:103], v[84:87], v[156:159]
    v_mfma_f32_16x16x32_bf16 v[160:163], v[104:107], v[84:87], v[160:163]
    v_mfma_f32_16x16x32_bf16 v[164:167], v[108:111], v[84:87], v[164:167]
    v_mfma_f32_16x16x32_bf16 v[168:171], v[112:115], v[84:87], v[168:171]
    v_mfma_f32_16x16x32_bf16 v[172:175], v[116:119], v[84:87], v[172:175]
    v_mfma_f32_16x16x32_bf16 v[176:179], v[96:99], v[88:91], v[176:179]
    v_mfma_f32_16x16x32_bf16 v[180:183], v[100:103], v[88:91], v[180:183]
    v_mfma_f32_16x16x32_bf16 v[184:187], v[104:107], v[88:91], v[184:187]
    v_mfma_f32_16x16x32_bf16 v[188:191], v[108:111], v[88:91], v[188:191]
    v_mfma_f32_16x16x32_bf16 v[192:195], v[112:115], v[88:91], v[192:195]
    v_mfma_f32_16x16x32_bf16 v[196:199], v[116:119], v[88:91], v[196:199]
    v_mfma_f32_16x16x32_bf16 v[200:203], v[96:99], v[92:95], v[200:203]
    v_mfma_f32_16x16x32_bf16 v[204:207], v[100:103], v[92:95], v[204:207]
    v_mfma_f32_16x16x32_bf16 v[208:211], v[104:107], v[92:95], v[208:211]
    v_mfma_f32_16x16x32_bf16 v[212:215], v[108:111], v[92:95], v[212:215]
    v_mfma_f32_16x16x32_bf16 v[216:219], v[112:115], v[92:95], v[216:219]
    v_mfma_f32_16x16x32_bf16 v[220:223], v[116:119], v[92:95], v[220:223]
    s_nop 7
    s_nop 7

    s_and_b32 s57, s57, 0xffff
    s_mov_b32 s58, 7340032
    s_mov_b32 s59, 0x20000
    s_mul_i32 s32, s2, 28672
    s_lshl_b32 s40, s24, 12
    s_add_u32 s32, s32, s40
    v_lshlrev_b32 v27, 4, v2

    s_cmp_eq_u32 s24, 7
    s_cbranch_scc1 K1T10_NOPF
    buffer_load_dwordx4 v[96:99], v27, s[56:59], s32 offen offset:0
    buffer_load_dwordx4 v[100:103], v27, s[56:59], s32 offen offset:1024
    buffer_load_dwordx4 v[104:107], v27, s[56:59], s32 offen offset:2048
    buffer_load_dwordx4 v[108:111], v27, s[56:59], s32 offen offset:3072
K1T10_NOPF:
    s_mov_b32 s42, 0xc0135761
    s_mov_b32 s43, 0xbdd2d3e8
    v_mov_b32 v25, s42
    s_mov_b32 s44, 0xffff0000
    s_mov_b32 s48, 0
    s_mov_b32 s49, 114688
    s_mov_b32 s50, 229376
    s_mov_b32 s51, 344064
    v_cvt_pk_bf16_f32 v32, v128, v129
    v_cvt_pk_bf16_f32 v33, v130, v131
    v_lshlrev_b32 v128, 16, v32
    v_and_b32 v129, s44, v32
    v_lshlrev_b32 v130, 16, v33
    v_and_b32 v131, s44, v33
    v_cvt_pk_bf16_f32 v32, v132, v133
    v_cvt_pk_bf16_f32 v33, v134, v135
    v_lshlrev_b32 v132, 16, v32
    v_and_b32 v133, s44, v32
    v_lshlrev_b32 v134, 16, v33
    v_and_b32 v135, s44, v33
    v_mul_f32 v32, v128, v128
    v_mul_f32 v33, v129, v129
    v_mul_f32 v34, v130, v130
    v_mul_f32 v35, v131, v131
    v_fma_f32 v32, v32, s43, v25
    v_fma_f32 v33, v33, s43, v25
    v_fma_f32 v34, v34, s43, v25
    v_fma_f32 v35, v35, s43, v25
    v_mul_f32 v32, v32, v128
    v_mul_f32 v33, v33, v129
    v_mul_f32 v34, v34, v130
    v_mul_f32 v35, v35, v131
    v_exp_f32 v32, v32
    v_exp_f32 v33, v33
    v_exp_f32 v34, v34
    v_exp_f32 v35, v35
    v_add_f32 v32, 1.0, v32
    v_add_f32 v33, 1.0, v33
    v_add_f32 v34, 1.0, v34
    v_add_f32 v35, 1.0, v35
    v_rcp_f32 v32, v32
    v_rcp_f32 v33, v33
    v_rcp_f32 v34, v34
    v_rcp_f32 v35, v35
    v_mul_f32 v32, v32, v128
    v_mul_f32 v33, v33, v129
    v_mul_f32 v34, v34, v130
    v_mul_f32 v35, v35, v131
    v_cvt_pk_bf16_f32 v36, v32, v33
    v_cvt_pk_bf16_f32 v37, v34, v35
    v_lshlrev_b32 v32, 16, v36
    v_and_b32 v33, s44, v36
    v_lshlrev_b32 v34, 16, v37
    v_and_b32 v35, s44, v37
    v_mul_f32 v32, v32, v132
    v_mul_f32 v33, v33, v133
    v_mul_f32 v34, v34, v134
    v_mul_f32 v35, v35, v135
    v_cvt_pk_bf16_f32 v64, v32, v33
    v_cvt_pk_bf16_f32 v65, v34, v35
    v_cvt_pk_bf16_f32 v40, v136, v137
    v_cvt_pk_bf16_f32 v41, v138, v139
    v_lshlrev_b32 v136, 16, v40
    v_and_b32 v137, s44, v40
    v_lshlrev_b32 v138, 16, v41
    v_and_b32 v139, s44, v41
    v_cvt_pk_bf16_f32 v40, v140, v141
    v_cvt_pk_bf16_f32 v41, v142, v143
    v_lshlrev_b32 v140, 16, v40
    v_and_b32 v141, s44, v40
    v_lshlrev_b32 v142, 16, v41
    v_and_b32 v143, s44, v41
    v_mul_f32 v40, v136, v136
    v_mul_f32 v41, v137, v137
    v_mul_f32 v42, v138, v138
    v_mul_f32 v43, v139, v139
    v_fma_f32 v40, v40, s43, v25
    v_fma_f32 v41, v41, s43, v25
    v_fma_f32 v42, v42, s43, v25
    v_fma_f32 v43, v43, s43, v25
    v_mul_f32 v40, v40, v136
    v_mul_f32 v41, v41, v137
    v_mul_f32 v42, v42, v138
    v_mul_f32 v43, v43, v139
    v_exp_f32 v40, v40
    v_exp_f32 v41, v41
    v_exp_f32 v42, v42
    v_exp_f32 v43, v43
    v_add_f32 v40, 1.0, v40
    v_add_f32 v41, 1.0, v41
    v_add_f32 v42, 1.0, v42
    v_add_f32 v43, 1.0, v43
    v_rcp_f32 v40, v40
    v_rcp_f32 v41, v41
    v_rcp_f32 v42, v42
    v_rcp_f32 v43, v43
    v_mul_f32 v40, v40, v136
    v_mul_f32 v41, v41, v137
    v_mul_f32 v42, v42, v138
    v_mul_f32 v43, v43, v139
    v_cvt_pk_bf16_f32 v44, v40, v41
    v_cvt_pk_bf16_f32 v45, v42, v43
    v_lshlrev_b32 v40, 16, v44
    v_and_b32 v41, s44, v44
    v_lshlrev_b32 v42, 16, v45
    v_and_b32 v43, s44, v45
    v_mul_f32 v40, v40, v140
    v_mul_f32 v41, v41, v141
    v_mul_f32 v42, v42, v142
    v_mul_f32 v43, v43, v143
    v_cvt_pk_bf16_f32 v66, v40, v41
    v_cvt_pk_bf16_f32 v67, v42, v43
    buffer_store_dwordx4 v[64:67], v23, s[20:23], s48 offen offset:0 sc0 sc1
    v_cvt_pk_bf16_f32 v48, v144, v145
    v_cvt_pk_bf16_f32 v49, v146, v147
    v_lshlrev_b32 v144, 16, v48
    v_and_b32 v145, s44, v48
    v_lshlrev_b32 v146, 16, v49
    v_and_b32 v147, s44, v49
    v_cvt_pk_bf16_f32 v48, v148, v149
    v_cvt_pk_bf16_f32 v49, v150, v151
    v_lshlrev_b32 v148, 16, v48
    v_and_b32 v149, s44, v48
    v_lshlrev_b32 v150, 16, v49
    v_and_b32 v151, s44, v49
    v_mul_f32 v48, v144, v144
    v_mul_f32 v49, v145, v145
    v_mul_f32 v50, v146, v146
    v_mul_f32 v51, v147, v147
    v_fma_f32 v48, v48, s43, v25
    v_fma_f32 v49, v49, s43, v25
    v_fma_f32 v50, v50, s43, v25
    v_fma_f32 v51, v51, s43, v25
    v_mul_f32 v48, v48, v144
    v_mul_f32 v49, v49, v145
    v_mul_f32 v50, v50, v146
    v_mul_f32 v51, v51, v147
    v_exp_f32 v48, v48
    v_exp_f32 v49, v49
    v_exp_f32 v50, v50
    v_exp_f32 v51, v51
    v_add_f32 v48, 1.0, v48
    v_add_f32 v49, 1.0, v49
    v_add_f32 v50, 1.0, v50
    v_add_f32 v51, 1.0, v51
    v_rcp_f32 v48, v48
    v_rcp_f32 v49, v49
    v_rcp_f32 v50, v50
    v_rcp_f32 v51, v51
    v_mul_f32 v48, v48, v144
    v_mul_f32 v49, v49, v145
    v_mul_f32 v50, v50, v146
    v_mul_f32 v51, v51, v147
    v_cvt_pk_bf16_f32 v52, v48, v49
    v_cvt_pk_bf16_f32 v53, v50, v51
    v_lshlrev_b32 v48, 16, v52
    v_and_b32 v49, s44, v52
    v_lshlrev_b32 v50, 16, v53
    v_and_b32 v51, s44, v53
    v_mul_f32 v48, v48, v148
    v_mul_f32 v49, v49, v149
    v_mul_f32 v50, v50, v150
    v_mul_f32 v51, v51, v151
    v_cvt_pk_bf16_f32 v68, v48, v49
    v_cvt_pk_bf16_f32 v69, v50, v51
    buffer_store_dwordx2 v[68:69], v24, s[20:23], s48 offen sc0 sc1
    v_cvt_pk_bf16_f32 v32, v152, v153
    v_cvt_pk_bf16_f32 v33, v154, v155
    v_lshlrev_b32 v152, 16, v32
    v_and_b32 v153, s44, v32
    v_lshlrev_b32 v154, 16, v33
    v_and_b32 v155, s44, v33
    v_cvt_pk_bf16_f32 v32, v156, v157
    v_cvt_pk_bf16_f32 v33, v158, v159
    v_lshlrev_b32 v156, 16, v32
    v_and_b32 v157, s44, v32
    v_lshlrev_b32 v158, 16, v33
    v_and_b32 v159, s44, v33
    v_mul_f32 v32, v152, v152
    v_mul_f32 v33, v153, v153
    v_mul_f32 v34, v154, v154
    v_mul_f32 v35, v155, v155
    v_fma_f32 v32, v32, s43, v25
    v_fma_f32 v33, v33, s43, v25
    v_fma_f32 v34, v34, s43, v25
    v_fma_f32 v35, v35, s43, v25
    v_mul_f32 v32, v32, v152
    v_mul_f32 v33, v33, v153
    v_mul_f32 v34, v34, v154
    v_mul_f32 v35, v35, v155
    v_exp_f32 v32, v32
    v_exp_f32 v33, v33
    v_exp_f32 v34, v34
    v_exp_f32 v35, v35
    v_add_f32 v32, 1.0, v32
    v_add_f32 v33, 1.0, v33
    v_add_f32 v34, 1.0, v34
    v_add_f32 v35, 1.0, v35
    v_rcp_f32 v32, v32
    v_rcp_f32 v33, v33
    v_rcp_f32 v34, v34
    v_rcp_f32 v35, v35
    v_mul_f32 v32, v32, v152
    v_mul_f32 v33, v33, v153
    v_mul_f32 v34, v34, v154
    v_mul_f32 v35, v35, v155
    v_cvt_pk_bf16_f32 v36, v32, v33
    v_cvt_pk_bf16_f32 v37, v34, v35
    v_lshlrev_b32 v32, 16, v36
    v_and_b32 v33, s44, v36
    v_lshlrev_b32 v34, 16, v37
    v_and_b32 v35, s44, v37
    v_mul_f32 v32, v32, v156
    v_mul_f32 v33, v33, v157
    v_mul_f32 v34, v34, v158
    v_mul_f32 v35, v35, v159
    v_cvt_pk_bf16_f32 v72, v32, v33
    v_cvt_pk_bf16_f32 v73, v34, v35
    v_cvt_pk_bf16_f32 v40, v160, v161
    v_cvt_pk_bf16_f32 v41, v162, v163
    v_lshlrev_b32 v160, 16, v40
    v_and_b32 v161, s44, v40
    v_lshlrev_b32 v162, 16, v41
    v_and_b32 v163, s44, v41
    v_cvt_pk_bf16_f32 v40, v164, v165
    v_cvt_pk_bf16_f32 v41, v166, v167
    v_lshlrev_b32 v164, 16, v40
    v_and_b32 v165, s44, v40
    v_lshlrev_b32 v166, 16, v41
    v_and_b32 v167, s44, v41
    v_mul_f32 v40, v160, v160
    v_mul_f32 v41, v161, v161
    v_mul_f32 v42, v162, v162
    v_mul_f32 v43, v163, v163
    v_fma_f32 v40, v40, s43, v25
    v_fma_f32 v41, v41, s43, v25
    v_fma_f32 v42, v42, s43, v25
    v_fma_f32 v43, v43, s43, v25
    v_mul_f32 v40, v40, v160
    v_mul_f32 v41, v41, v161
    v_mul_f32 v42, v42, v162
    v_mul_f32 v43, v43, v163
    v_exp_f32 v40, v40
    v_exp_f32 v41, v41
    v_exp_f32 v42, v42
    v_exp_f32 v43, v43
    v_add_f32 v40, 1.0, v40
    v_add_f32 v41, 1.0, v41
    v_add_f32 v42, 1.0, v42
    v_add_f32 v43, 1.0, v43
    v_rcp_f32 v40, v40
    v_rcp_f32 v41, v41
    v_rcp_f32 v42, v42
    v_rcp_f32 v43, v43
    v_mul_f32 v40, v40, v160
    v_mul_f32 v41, v41, v161
    v_mul_f32 v42, v42, v162
    v_mul_f32 v43, v43, v163
    v_cvt_pk_bf16_f32 v44, v40, v41
    v_cvt_pk_bf16_f32 v45, v42, v43
    v_lshlrev_b32 v40, 16, v44
    v_and_b32 v41, s44, v44
    v_lshlrev_b32 v42, 16, v45
    v_and_b32 v43, s44, v45
    v_mul_f32 v40, v40, v164
    v_mul_f32 v41, v41, v165
    v_mul_f32 v42, v42, v166
    v_mul_f32 v43, v43, v167
    v_cvt_pk_bf16_f32 v74, v40, v41
    v_cvt_pk_bf16_f32 v75, v42, v43
    buffer_store_dwordx4 v[72:75], v23, s[20:23], s49 offen offset:0 sc0 sc1
    v_cvt_pk_bf16_f32 v48, v168, v169
    v_cvt_pk_bf16_f32 v49, v170, v171
    v_lshlrev_b32 v168, 16, v48
    v_and_b32 v169, s44, v48
    v_lshlrev_b32 v170, 16, v49
    v_and_b32 v171, s44, v49
    v_cvt_pk_bf16_f32 v48, v172, v173
    v_cvt_pk_bf16_f32 v49, v174, v175
    v_lshlrev_b32 v172, 16, v48
    v_and_b32 v173, s44, v48
    v_lshlrev_b32 v174, 16, v49
    v_and_b32 v175, s44, v49
    v_mul_f32 v48, v168, v168
    v_mul_f32 v49, v169, v169
    v_mul_f32 v50, v170, v170
    v_mul_f32 v51, v171, v171
    v_fma_f32 v48, v48, s43, v25
    v_fma_f32 v49, v49, s43, v25
    v_fma_f32 v50, v50, s43, v25
    v_fma_f32 v51, v51, s43, v25
    v_mul_f32 v48, v48, v168
    v_mul_f32 v49, v49, v169
    v_mul_f32 v50, v50, v170
    v_mul_f32 v51, v51, v171
    v_exp_f32 v48, v48
    v_exp_f32 v49, v49
    v_exp_f32 v50, v50
    v_exp_f32 v51, v51
    v_add_f32 v48, 1.0, v48
    v_add_f32 v49, 1.0, v49
    v_add_f32 v50, 1.0, v50
    v_add_f32 v51, 1.0, v51
    v_rcp_f32 v48, v48
    v_rcp_f32 v49, v49
    v_rcp_f32 v50, v50
    v_rcp_f32 v51, v51
    v_mul_f32 v48, v48, v168
    v_mul_f32 v49, v49, v169
    v_mul_f32 v50, v50, v170
    v_mul_f32 v51, v51, v171
    v_cvt_pk_bf16_f32 v52, v48, v49
    v_cvt_pk_bf16_f32 v53, v50, v51
    v_lshlrev_b32 v48, 16, v52
    v_and_b32 v49, s44, v52
    v_lshlrev_b32 v50, 16, v53
    v_and_b32 v51, s44, v53
    v_mul_f32 v48, v48, v172
    v_mul_f32 v49, v49, v173
    v_mul_f32 v50, v50, v174
    v_mul_f32 v51, v51, v175
    v_cvt_pk_bf16_f32 v76, v48, v49
    v_cvt_pk_bf16_f32 v77, v50, v51
    buffer_store_dwordx2 v[76:77], v24, s[20:23], s49 offen sc0 sc1
    v_cvt_pk_bf16_f32 v32, v176, v177
    v_cvt_pk_bf16_f32 v33, v178, v179
    v_lshlrev_b32 v176, 16, v32
    v_and_b32 v177, s44, v32
    v_lshlrev_b32 v178, 16, v33
    v_and_b32 v179, s44, v33
    v_cvt_pk_bf16_f32 v32, v180, v181
    v_cvt_pk_bf16_f32 v33, v182, v183
    v_lshlrev_b32 v180, 16, v32
    v_and_b32 v181, s44, v32
    v_lshlrev_b32 v182, 16, v33
    v_and_b32 v183, s44, v33
    v_mul_f32 v32, v176, v176
    v_mul_f32 v33, v177, v177
    v_mul_f32 v34, v178, v178
    v_mul_f32 v35, v179, v179
    v_fma_f32 v32, v32, s43, v25
    v_fma_f32 v33, v33, s43, v25
    v_fma_f32 v34, v34, s43, v25
    v_fma_f32 v35, v35, s43, v25
    v_mul_f32 v32, v32, v176
    v_mul_f32 v33, v33, v177
    v_mul_f32 v34, v34, v178
    v_mul_f32 v35, v35, v179
    v_exp_f32 v32, v32
    v_exp_f32 v33, v33
    v_exp_f32 v34, v34
    v_exp_f32 v35, v35
    v_add_f32 v32, 1.0, v32
    v_add_f32 v33, 1.0, v33
    v_add_f32 v34, 1.0, v34
    v_add_f32 v35, 1.0, v35
    v_rcp_f32 v32, v32
    v_rcp_f32 v33, v33
    v_rcp_f32 v34, v34
    v_rcp_f32 v35, v35
    v_mul_f32 v32, v32, v176
    v_mul_f32 v33, v33, v177
    v_mul_f32 v34, v34, v178
    v_mul_f32 v35, v35, v179
    v_cvt_pk_bf16_f32 v36, v32, v33
    v_cvt_pk_bf16_f32 v37, v34, v35
    v_lshlrev_b32 v32, 16, v36
    v_and_b32 v33, s44, v36
    v_lshlrev_b32 v34, 16, v37
    v_and_b32 v35, s44, v37
    v_mul_f32 v32, v32, v180
    v_mul_f32 v33, v33, v181
    v_mul_f32 v34, v34, v182
    v_mul_f32 v35, v35, v183
    v_cvt_pk_bf16_f32 v80, v32, v33
    v_cvt_pk_bf16_f32 v81, v34, v35
    v_cvt_pk_bf16_f32 v40, v184, v185
    v_cvt_pk_bf16_f32 v41, v186, v187
    v_lshlrev_b32 v184, 16, v40
    v_and_b32 v185, s44, v40
    v_lshlrev_b32 v186, 16, v41
    v_and_b32 v187, s44, v41
    v_cvt_pk_bf16_f32 v40, v188, v189
    v_cvt_pk_bf16_f32 v41, v190, v191
    v_lshlrev_b32 v188, 16, v40
    v_and_b32 v189, s44, v40
    v_lshlrev_b32 v190, 16, v41
    v_and_b32 v191, s44, v41
    v_mul_f32 v40, v184, v184
    v_mul_f32 v41, v185, v185
    v_mul_f32 v42, v186, v186
    v_mul_f32 v43, v187, v187
    v_fma_f32 v40, v40, s43, v25
    v_fma_f32 v41, v41, s43, v25
    v_fma_f32 v42, v42, s43, v25
    v_fma_f32 v43, v43, s43, v25
    v_mul_f32 v40, v40, v184
    v_mul_f32 v41, v41, v185
    v_mul_f32 v42, v42, v186
    v_mul_f32 v43, v43, v187
    v_exp_f32 v40, v40
    v_exp_f32 v41, v41
    v_exp_f32 v42, v42
    v_exp_f32 v43, v43
    v_add_f32 v40, 1.0, v40
    v_add_f32 v41, 1.0, v41
    v_add_f32 v42, 1.0, v42
    v_add_f32 v43, 1.0, v43
    v_rcp_f32 v40, v40
    v_rcp_f32 v41, v41
    v_rcp_f32 v42, v42
    v_rcp_f32 v43, v43
    v_mul_f32 v40, v40, v184
    v_mul_f32 v41, v41, v185
    v_mul_f32 v42, v42, v186
    v_mul_f32 v43, v43, v187
    v_cvt_pk_bf16_f32 v44, v40, v41
    v_cvt_pk_bf16_f32 v45, v42, v43
    v_lshlrev_b32 v40, 16, v44
    v_and_b32 v41, s44, v44
    v_lshlrev_b32 v42, 16, v45
    v_and_b32 v43, s44, v45
    v_mul_f32 v40, v40, v188
    v_mul_f32 v41, v41, v189
    v_mul_f32 v42, v42, v190
    v_mul_f32 v43, v43, v191
    v_cvt_pk_bf16_f32 v82, v40, v41
    v_cvt_pk_bf16_f32 v83, v42, v43
    buffer_store_dwordx4 v[80:83], v23, s[20:23], s50 offen offset:0 sc0 sc1
    v_cvt_pk_bf16_f32 v48, v192, v193
    v_cvt_pk_bf16_f32 v49, v194, v195
    v_lshlrev_b32 v192, 16, v48
    v_and_b32 v193, s44, v48
    v_lshlrev_b32 v194, 16, v49
    v_and_b32 v195, s44, v49
    v_cvt_pk_bf16_f32 v48, v196, v197
    v_cvt_pk_bf16_f32 v49, v198, v199
    v_lshlrev_b32 v196, 16, v48
    v_and_b32 v197, s44, v48
    v_lshlrev_b32 v198, 16, v49
    v_and_b32 v199, s44, v49
    v_mul_f32 v48, v192, v192
    v_mul_f32 v49, v193, v193
    v_mul_f32 v50, v194, v194
    v_mul_f32 v51, v195, v195
    v_fma_f32 v48, v48, s43, v25
    v_fma_f32 v49, v49, s43, v25
    v_fma_f32 v50, v50, s43, v25
    v_fma_f32 v51, v51, s43, v25
    v_mul_f32 v48, v48, v192
    v_mul_f32 v49, v49, v193
    v_mul_f32 v50, v50, v194
    v_mul_f32 v51, v51, v195
    v_exp_f32 v48, v48
    v_exp_f32 v49, v49
    v_exp_f32 v50, v50
    v_exp_f32 v51, v51
    v_add_f32 v48, 1.0, v48
    v_add_f32 v49, 1.0, v49
    v_add_f32 v50, 1.0, v50
    v_add_f32 v51, 1.0, v51
    v_rcp_f32 v48, v48
    v_rcp_f32 v49, v49
    v_rcp_f32 v50, v50
    v_rcp_f32 v51, v51
    v_mul_f32 v48, v48, v192
    v_mul_f32 v49, v49, v193
    v_mul_f32 v50, v50, v194
    v_mul_f32 v51, v51, v195
    v_cvt_pk_bf16_f32 v52, v48, v49
    v_cvt_pk_bf16_f32 v53, v50, v51
    v_lshlrev_b32 v48, 16, v52
    v_and_b32 v49, s44, v52
    v_lshlrev_b32 v50, 16, v53
    v_and_b32 v51, s44, v53
    v_mul_f32 v48, v48, v196
    v_mul_f32 v49, v49, v197
    v_mul_f32 v50, v50, v198
    v_mul_f32 v51, v51, v199
    v_cvt_pk_bf16_f32 v84, v48, v49
    v_cvt_pk_bf16_f32 v85, v50, v51
    buffer_store_dwordx2 v[84:85], v24, s[20:23], s50 offen sc0 sc1
    v_cvt_pk_bf16_f32 v32, v200, v201
    v_cvt_pk_bf16_f32 v33, v202, v203
    v_lshlrev_b32 v200, 16, v32
    v_and_b32 v201, s44, v32
    v_lshlrev_b32 v202, 16, v33
    v_and_b32 v203, s44, v33
    v_cvt_pk_bf16_f32 v32, v204, v205
    v_cvt_pk_bf16_f32 v33, v206, v207
    v_lshlrev_b32 v204, 16, v32
    v_and_b32 v205, s44, v32
    v_lshlrev_b32 v206, 16, v33
    v_and_b32 v207, s44, v33
    v_mul_f32 v32, v200, v200
    v_mul_f32 v33, v201, v201
    v_mul_f32 v34, v202, v202
    v_mul_f32 v35, v203, v203
    v_fma_f32 v32, v32, s43, v25
    v_fma_f32 v33, v33, s43, v25
    v_fma_f32 v34, v34, s43, v25
    v_fma_f32 v35, v35, s43, v25
    v_mul_f32 v32, v32, v200
    v_mul_f32 v33, v33, v201
    v_mul_f32 v34, v34, v202
    v_mul_f32 v35, v35, v203
    v_exp_f32 v32, v32
    v_exp_f32 v33, v33
    v_exp_f32 v34, v34
    v_exp_f32 v35, v35
    v_add_f32 v32, 1.0, v32
    v_add_f32 v33, 1.0, v33
    v_add_f32 v34, 1.0, v34
    v_add_f32 v35, 1.0, v35
    v_rcp_f32 v32, v32
    v_rcp_f32 v33, v33
    v_rcp_f32 v34, v34
    v_rcp_f32 v35, v35
    v_mul_f32 v32, v32, v200
    v_mul_f32 v33, v33, v201
    v_mul_f32 v34, v34, v202
    v_mul_f32 v35, v35, v203
    v_cvt_pk_bf16_f32 v36, v32, v33
    v_cvt_pk_bf16_f32 v37, v34, v35
    v_lshlrev_b32 v32, 16, v36
    v_and_b32 v33, s44, v36
    v_lshlrev_b32 v34, 16, v37
    v_and_b32 v35, s44, v37
    v_mul_f32 v32, v32, v204
    v_mul_f32 v33, v33, v205
    v_mul_f32 v34, v34, v206
    v_mul_f32 v35, v35, v207
    v_cvt_pk_bf16_f32 v88, v32, v33
    v_cvt_pk_bf16_f32 v89, v34, v35
    v_cvt_pk_bf16_f32 v40, v208, v209
    v_cvt_pk_bf16_f32 v41, v210, v211
    v_lshlrev_b32 v208, 16, v40
    v_and_b32 v209, s44, v40
    v_lshlrev_b32 v210, 16, v41
    v_and_b32 v211, s44, v41
    v_cvt_pk_bf16_f32 v40, v212, v213
    v_cvt_pk_bf16_f32 v41, v214, v215
    v_lshlrev_b32 v212, 16, v40
    v_and_b32 v213, s44, v40
    v_lshlrev_b32 v214, 16, v41
    v_and_b32 v215, s44, v41
    v_mul_f32 v40, v208, v208
    v_mul_f32 v41, v209, v209
    v_mul_f32 v42, v210, v210
    v_mul_f32 v43, v211, v211
    v_fma_f32 v40, v40, s43, v25
    v_fma_f32 v41, v41, s43, v25
    v_fma_f32 v42, v42, s43, v25
    v_fma_f32 v43, v43, s43, v25
    v_mul_f32 v40, v40, v208
    v_mul_f32 v41, v41, v209
    v_mul_f32 v42, v42, v210
    v_mul_f32 v43, v43, v211
    v_exp_f32 v40, v40
    v_exp_f32 v41, v41
    v_exp_f32 v42, v42
    v_exp_f32 v43, v43
    v_add_f32 v40, 1.0, v40
    v_add_f32 v41, 1.0, v41
    v_add_f32 v42, 1.0, v42
    v_add_f32 v43, 1.0, v43
    v_rcp_f32 v40, v40
    v_rcp_f32 v41, v41
    v_rcp_f32 v42, v42
    v_rcp_f32 v43, v43
    v_mul_f32 v40, v40, v208
    v_mul_f32 v41, v41, v209
    v_mul_f32 v42, v42, v210
    v_mul_f32 v43, v43, v211
    v_cvt_pk_bf16_f32 v44, v40, v41
    v_cvt_pk_bf16_f32 v45, v42, v43
    v_lshlrev_b32 v40, 16, v44
    v_and_b32 v41, s44, v44
    v_lshlrev_b32 v42, 16, v45
    v_and_b32 v43, s44, v45
    v_mul_f32 v40, v40, v212
    v_mul_f32 v41, v41, v213
    v_mul_f32 v42, v42, v214
    v_mul_f32 v43, v43, v215
    v_cvt_pk_bf16_f32 v90, v40, v41
    v_cvt_pk_bf16_f32 v91, v42, v43
    buffer_store_dwordx4 v[88:91], v23, s[20:23], s51 offen offset:0 sc0 sc1
    v_cvt_pk_bf16_f32 v48, v216, v217
    v_cvt_pk_bf16_f32 v49, v218, v219
    v_lshlrev_b32 v216, 16, v48
    v_and_b32 v217, s44, v48
    v_lshlrev_b32 v218, 16, v49
    v_and_b32 v219, s44, v49
    v_cvt_pk_bf16_f32 v48, v220, v221
    v_cvt_pk_bf16_f32 v49, v222, v223
    v_lshlrev_b32 v220, 16, v48
    v_and_b32 v221, s44, v48
    v_lshlrev_b32 v222, 16, v49
    v_and_b32 v223, s44, v49
    v_mul_f32 v48, v216, v216
    v_mul_f32 v49, v217, v217
    v_mul_f32 v50, v218, v218
    v_mul_f32 v51, v219, v219
    v_fma_f32 v48, v48, s43, v25
    v_fma_f32 v49, v49, s43, v25
    v_fma_f32 v50, v50, s43, v25
    v_fma_f32 v51, v51, s43, v25
    v_mul_f32 v48, v48, v216
    v_mul_f32 v49, v49, v217
    v_mul_f32 v50, v50, v218
    v_mul_f32 v51, v51, v219
    v_exp_f32 v48, v48
    v_exp_f32 v49, v49
    v_exp_f32 v50, v50
    v_exp_f32 v51, v51
    v_add_f32 v48, 1.0, v48
    v_add_f32 v49, 1.0, v49
    v_add_f32 v50, 1.0, v50
    v_add_f32 v51, 1.0, v51
    v_rcp_f32 v48, v48
    v_rcp_f32 v49, v49
    v_rcp_f32 v50, v50
    v_rcp_f32 v51, v51
    v_mul_f32 v48, v48, v216
    v_mul_f32 v49, v49, v217
    v_mul_f32 v50, v50, v218
    v_mul_f32 v51, v51, v219
    v_cvt_pk_bf16_f32 v52, v48, v49
    v_cvt_pk_bf16_f32 v53, v50, v51
    v_lshlrev_b32 v48, 16, v52
    v_and_b32 v49, s44, v52
    v_lshlrev_b32 v50, 16, v53
    v_and_b32 v51, s44, v53
    v_mul_f32 v48, v48, v220
    v_mul_f32 v49, v49, v221
    v_mul_f32 v50, v50, v222
    v_mul_f32 v51, v51, v223
    v_cvt_pk_bf16_f32 v92, v48, v49
    v_cvt_pk_bf16_f32 v93, v50, v51
    buffer_store_dwordx2 v[92:93], v24, s[20:23], s51 offen sc0 sc1
    s_branch K1_TO_K2
K1_DONE:
    s_endpgm
K1_TO_K2:

    s_load_dwordx2 s[92:93], s[0:1], 40
    s_lshl_b32 s90, s26, 5
    s_waitcnt vmcnt(0) lgkmcnt(0)
    s_barrier
    s_and_b32 s93, s93, 0xffff
    s_mov_b32 s94, 256
    s_mov_b32 s95, 0x20000
    v_mov_b32 v252, 0
    v_mov_b32 v253, 1
    s_cmp_eq_u32 s24, 0
    s_cbranch_scc0 K2_NOPUB
    s_mov_b64 s[96:97], exec
    s_mov_b64 exec, 1
    buffer_atomic_add v253, v252, s[92:95], s90 offen sc1
    s_mov_b64 exec, s[96:97]
K2_NOPUB:

    s_load_dwordx4 s[4:7], s[0:1], 24
    s_load_dwordx2 s[8:9], s[0:1], 48
    v_lshrrev_b32 v1, 6, v0
    v_and_b32 v2, 63, v0
    s_nop 0
    v_readfirstlane_b32 s24, v1
    s_and_b32 s25, s2, 7
    s_lshr_b32 s26, s2, 3

    s_lshr_b32 s27, s25, 1
    s_lshl_b32 s27, s27, 2
    s_lshr_b32 s32, s26, 3
    s_add_u32 s27, s27, s32
    s_and_b32 s28, s25, 1
    s_lshl_b32 s28, s28, 3
    s_and_b32 s32, s26, 7
    s_add_u32 s28, s28, s32

    s_and_b32 s25, s24, 3
    s_lshr_b32 s26, s24, 2

    v_and_b32 v3, 15, v2
    v_lshrrev_b32 v4, 4, v2

    v_lshrrev_b32 v9, 2, v2
    v_and_b32 v9, 3, v9
    v_lshlrev_b32 v10, 2, v4
    v_add_u32 v9, v9, v10
    v_lshrrev_b32 v10, 1, v9
    v_and_b32 v10, 3, v10
    v_lshlrev_b32 v10, 5, v10
    s_lshl_b32 s32, s26, 6
    v_add_u32 v9, s32, v9
    v_lshlrev_b32 v9, 7, v9
    v_add_u32 v9, v9, v10
    v_and_b32 v10, 3, v2
    v_lshlrev_b32 v10, 3, v10
    v_add_u32 v5, v9, v10
    v_xor_b32 v6, 32, v5
    v_xor_b32 v7, 64, v5
    v_xor_b32 v8, 96, v5
    v_add_u32 v240, 0x10000, v5
    v_add_u32 v241, 0x10000, v6
    v_add_u32 v242, 0x10000, v7
    v_add_u32 v243, 0x10000, v8

    s_lshl_b32 s33, s27, 7
    s_lshl_b32 s32, s25, 5
    s_add_u32 s33, s33, s32
    s_lshr_b32 s32, s33, 4
    s_mul_i32 s32, s32, 114688
    v_lshlrev_b32 v9, 4, v2
    v_add_u32 v9, s32, v9
    s_lshl_b32 s32, s26, 11
    v_add_u32 v9, s32, v9
    v_add_u32 v10, 114688, v9

    v_lshrrev_b32 v12, 3, v2
    v_and_b32 v13, 7, v2
    v_and_b32 v14, 6, v12
    v_xor_b32 v13, v13, v14
    v_lshlrev_b32 v13, 4, v13
    s_lshl_b32 s32, s24, 4
    v_add_u32 v12, s32, v12
    v_lshlrev_b32 v12, 11, v12
    v_add_u32 v12, v12, v13
    s_lshl_b32 s32, s28, 7

    v_add_u32 v11, s32, v12
    s_lshl_b32 s34, s24, 11

    s_waitcnt lgkmcnt(0)
    s_mov_b32 s12, s4
    s_and_b32 s13, s5, 0xffff
    s_mov_b32 s14, 7340032
    s_mov_b32 s15, 0x20000
    s_mov_b32 s16, s8
    s_and_b32 s17, s9, 0xffff
    s_mov_b32 s18, 14680064
    s_mov_b32 s19, 0x20000
    s_mov_b32 s20, s6
    s_and_b32 s21, s7, 0xffff
    s_mov_b32 s22, 4194304
    s_mov_b32 s23, 0x20000

    s_mov_b32 s30, 0
    s_mov_b32 s31, 0
    s_waitcnt vmcnt(0)
    s_add_u32 m0, s34, 0
    s_nop 0
    buffer_load_dwordx4 v11, s[12:15], s30 offen lds
    s_add_u32 m0, s34, 1024
    s_add_u32 s32, s30, 16384
    buffer_load_dwordx4 v11, s[12:15], s32 offen lds
    s_add_u32 s30, s30, 262144
    s_add_u32 m0, s34, 16384
    s_nop 0
    buffer_load_dwordx4 v11, s[12:15], s30 offen lds
    s_add_u32 m0, s34, 17408
    s_add_u32 s32, s30, 16384
    buffer_load_dwordx4 v11, s[12:15], s32 offen lds
    s_add_u32 s30, s30, 262144
    s_add_u32 m0, s34, 32768
    s_nop 0
    buffer_load_dwordx4 v11, s[12:15], s30 offen lds
    s_add_u32 m0, s34, 33792
    s_add_u32 s32, s30, 16384
    buffer_load_dwordx4 v11, s[12:15], s32 offen lds
    s_add_u32 s30, s30, 262144
    s_add_u32 m0, s34, 49152
    s_nop 0
    buffer_load_dwordx4 v11, s[12:15], s30 offen lds
    s_add_u32 m0, s34, 50176
    s_add_u32 s32, s30, 16384
    buffer_load_dwordx4 v11, s[12:15], s32 offen lds
    s_add_u32 s30, s30, 262144

    s_lshr_b32 s91, s27, 1
    s_lshl_b32 s91, s91, 5
    s_cmp_eq_u32 s24, 0
    s_cbranch_scc0 K2_RDY
    s_mov_b64 s[96:97], exec
    s_mov_b64 exec, 1
    s_mov_b32 s99, 0x200000
K2_POLL:
    buffer_load_dword v254, v252, s[92:95], s91 offen sc0 sc1
    s_waitcnt vmcnt(0)
    v_readfirstlane_b32 s98, v254
    s_cmp_ge_u32 s98, 32
    s_cbranch_scc1 K2_POLLED
    s_sub_u32 s99, s99, 1
    s_cmp_eq_u32 s99, 0
    s_cbranch_scc1 K2_POLLED
    s_sleep 1
    s_branch K2_POLL
K2_POLLED:
    s_mov_b64 exec, s[96:97]
K2_RDY:
    s_barrier

    buffer_load_dwordx4 v[80:83], v9, s[16:19], s31 offen offset:0
    buffer_load_dwordx4 v[84:87], v10, s[16:19], s31 offen offset:0
    buffer_load_dwordx4 v[88:91], v9, s[16:19], s31 offen offset:1024
    buffer_load_dwordx4 v[92:95], v10, s[16:19], s31 offen offset:1024
    s_add_u32 s31, s31, 4096
    buffer_load_dwordx4 v[96:99], v9, s[16:19], s31 offen offset:0
    buffer_load_dwordx4 v[100:103], v10, s[16:19], s31 offen offset:0
    buffer_load_dwordx4 v[104:107], v9, s[16:19], s31 offen offset:1024
    buffer_load_dwordx4 v[108:111], v10, s[16:19], s31 offen offset:1024
    s_add_u32 s31, s31, 4096
    buffer_load_dwordx4 v[112:115], v9, s[16:19], s31 offen offset:0
    buffer_load_dwordx4 v[116:119], v10, s[16:19], s31 offen offset:0
    buffer_load_dwordx4 v[120:123], v9, s[16:19], s31 offen offset:1024
    buffer_load_dwordx4 v[124:127], v10, s[16:19], s31 offen offset:1024
    s_add_u32 s31, s31, 4096
    v_mov_b32 v16, 0
    v_mov_b32 v17, 0
    v_mov_b32 v18, 0
    v_mov_b32 v19, 0
    v_mov_b32 v20, 0
    v_mov_b32 v21, 0
    v_mov_b32 v22, 0
    v_mov_b32 v23, 0
    v_mov_b32 v24, 0
    v_mov_b32 v25, 0
    v_mov_b32 v26, 0
    v_mov_b32 v27, 0
    v_mov_b32 v28, 0
    v_mov_b32 v29, 0
    v_mov_b32 v30, 0
    v_mov_b32 v31, 0
    v_mov_b32 v32, 0
    v_mov_b32 v33, 0
    v_mov_b32 v34, 0
    v_mov_b32 v35, 0
    v_mov_b32 v36, 0
    v_mov_b32 v37, 0
    v_mov_b32 v38, 0
    v_mov_b32 v39, 0
    v_mov_b32 v40, 0
    v_mov_b32 v41, 0
    v_mov_b32 v42, 0
    v_mov_b32 v43, 0
    v_mov_b32 v44, 0
    v_mov_b32 v45, 0
    v_mov_b32 v46, 0
    v_mov_b32 v47, 0
    s_waitcnt vmcnt(8)
    s_barrier
    ds_read_b64_tr_b16 v[48:49], v5 offset:0
    ds_read_b64_tr_b16 v[50:51], v5 offset:2048
    ds_read_b64_tr_b16 v[52:53], v6 offset:0
    ds_read_b64_tr_b16 v[54:55], v6 offset:2048
    ds_read_b64_tr_b16 v[56:57], v7 offset:0
    ds_read_b64_tr_b16 v[58:59], v7 offset:2048
    ds_read_b64_tr_b16 v[60:61], v8 offset:0
    ds_read_b64_tr_b16 v[62:63], v8 offset:2048
    s_waitcnt lgkmcnt(0)
    ds_read_b64_tr_b16 v[64:65], v5 offset:4096
    ds_read_b64_tr_b16 v[66:67], v5 offset:6144
    v_mfma_f32_16x16x32_bf16 v[16:19], v[48:51], v[80:83], v[16:19]
    ds_read_b64_tr_b16 v[68:69], v6 offset:4096
    v_mfma_f32_16x16x32_bf16 v[32:35], v[48:51], v[84:87], v[32:35]
    ds_read_b64_tr_b16 v[70:71], v6 offset:6144
    buffer_load_dwordx4 v[128:131], v9, s[16:19], s31 offen offset:0
    v_mfma_f32_16x16x32_bf16 v[20:23], v[52:55], v[80:83], v[20:23]
    buffer_load_dwordx4 v[132:135], v10, s[16:19], s31 offen offset:0
    v_mfma_f32_16x16x32_bf16 v[36:39], v[52:55], v[84:87], v[36:39]
    ds_read_b64_tr_b16 v[72:73], v7 offset:4096
    ds_read_b64_tr_b16 v[74:75], v7 offset:6144
    v_mfma_f32_16x16x32_bf16 v[24:27], v[56:59], v[80:83], v[24:27]
    ds_read_b64_tr_b16 v[76:77], v8 offset:4096
    v_mfma_f32_16x16x32_bf16 v[40:43], v[56:59], v[84:87], v[40:43]
    ds_read_b64_tr_b16 v[78:79], v8 offset:6144
    buffer_load_dwordx4 v[136:139], v9, s[16:19], s31 offen offset:1024
    v_mfma_f32_16x16x32_bf16 v[28:31], v[60:63], v[80:83], v[28:31]
    buffer_load_dwordx4 v[140:143], v10, s[16:19], s31 offen offset:1024
    s_add_u32 s31, s31, 4096
    v_mfma_f32_16x16x32_bf16 v[44:47], v[60:63], v[84:87], v[44:47]
    s_waitcnt vmcnt(8) lgkmcnt(0)
    s_barrier
    s_add_u32 m0, s34, 0
    s_nop 0
    buffer_load_dwordx4 v11, s[12:15], s30 offen lds
    ds_read_b64_tr_b16 v[48:49], v5 offset:16384
    v_mfma_f32_16x16x32_bf16 v[16:19], v[64:67], v[88:91], v[16:19]
    ds_read_b64_tr_b16 v[50:51], v5 offset:18432
    v_mfma_f32_16x16x32_bf16 v[32:35], v[64:67], v[92:95], v[32:35]
    ds_read_b64_tr_b16 v[52:53], v6 offset:16384
    v_mfma_f32_16x16x32_bf16 v[20:23], v[68:71], v[88:91], v[20:23]
    ds_read_b64_tr_b16 v[54:55], v6 offset:18432
    v_mfma_f32_16x16x32_bf16 v[36:39], v[68:71], v[92:95], v[36:39]
    s_add_u32 m0, s34, 1024
    s_add_u32 s32, s30, 16384
    buffer_load_dwordx4 v11, s[12:15], s32 offen lds
    s_add_u32 s30, s30, 262144
    ds_read_b64_tr_b16 v[56:57], v7 offset:16384
    v_mfma_f32_16x16x32_bf16 v[24:27], v[72:75], v[88:91], v[24:27]
    ds_read_b64_tr_b16 v[58:59], v7 offset:18432
    v_mfma_f32_16x16x32_bf16 v[40:43], v[72:75], v[92:95], v[40:43]
    ds_read_b64_tr_b16 v[60:61], v8 offset:16384
    v_mfma_f32_16x16x32_bf16 v[28:31], v[76:79], v[88:91], v[28:31]
    ds_read_b64_tr_b16 v[62:63], v8 offset:18432
    v_mfma_f32_16x16x32_bf16 v[44:47], v[76:79], v[92:95], v[44:47]
    s_waitcnt lgkmcnt(0)
    ds_read_b64_tr_b16 v[64:65], v5 offset:20480
    ds_read_b64_tr_b16 v[66:67], v5 offset:22528
    v_mfma_f32_16x16x32_bf16 v[16:19], v[48:51], v[96:99], v[16:19]
    ds_read_b64_tr_b16 v[68:69], v6 offset:20480
    v_mfma_f32_16x16x32_bf16 v[32:35], v[48:51], v[100:103], v[32:35]
    ds_read_b64_tr_b16 v[70:71], v6 offset:22528
    buffer_load_dwordx4 v[80:83], v9, s[16:19], s31 offen offset:0
    v_mfma_f32_16x16x32_bf16 v[20:23], v[52:55], v[96:99], v[20:23]
    buffer_load_dwordx4 v[84:87], v10, s[16:19], s31 offen offset:0
    v_mfma_f32_16x16x32_bf16 v[36:39], v[52:55], v[100:103], v[36:39]
    ds_read_b64_tr_b16 v[72:73], v7 offset:20480
    ds_read_b64_tr_b16 v[74:75], v7 offset:22528
    v_mfma_f32_16x16x32_bf16 v[24:27], v[56:59], v[96:99], v[24:27]
    ds_read_b64_tr_b16 v[76:77], v8 offset:20480
    v_mfma_f32_16x16x32_bf16 v[40:43], v[56:59], v[100:103], v[40:43]
    ds_read_b64_tr_b16 v[78:79], v8 offset:22528
    buffer_load_dwordx4 v[88:91], v9, s[16:19], s31 offen offset:1024
    v_mfma_f32_16x16x32_bf16 v[28:31], v[60:63], v[96:99], v[28:31]
    buffer_load_dwordx4 v[92:95], v10, s[16:19], s31 offen offset:1024
    s_add_u32 s31, s31, 4096
    v_mfma_f32_16x16x32_bf16 v[44:47], v[60:63], v[100:103], v[44:47]
    s_waitcnt vmcnt(10) lgkmcnt(0)
    s_barrier
    s_add_u32 m0, s34, 16384
    s_nop 0
    buffer_load_dwordx4 v11, s[12:15], s30 offen lds
    ds_read_b64_tr_b16 v[48:49], v5 offset:32768
    v_mfma_f32_16x16x32_bf16 v[16:19], v[64:67], v[104:107], v[16:19]
    ds_read_b64_tr_b16 v[50:51], v5 offset:34816
    v_mfma_f32_16x16x32_bf16 v[32:35], v[64:67], v[108:111], v[32:35]
    ds_read_b64_tr_b16 v[52:53], v6 offset:32768
    v_mfma_f32_16x16x32_bf16 v[20:23], v[68:71], v[104:107], v[20:23]
    ds_read_b64_tr_b16 v[54:55], v6 offset:34816
    v_mfma_f32_16x16x32_bf16 v[36:39], v[68:71], v[108:111], v[36:39]
    s_add_u32 m0, s34, 17408
    s_add_u32 s32, s30, 16384
    buffer_load_dwordx4 v11, s[12:15], s32 offen lds
    s_add_u32 s30, s30, 262144
    ds_read_b64_tr_b16 v[56:57], v7 offset:32768
    v_mfma_f32_16x16x32_bf16 v[24:27], v[72:75], v[104:107], v[24:27]
    ds_read_b64_tr_b16 v[58:59], v7 offset:34816
    v_mfma_f32_16x16x32_bf16 v[40:43], v[72:75], v[108:111], v[40:43]
    ds_read_b64_tr_b16 v[60:61], v8 offset:32768
    v_mfma_f32_16x16x32_bf16 v[28:31], v[76:79], v[104:107], v[28:31]
    ds_read_b64_tr_b16 v[62:63], v8 offset:34816
    v_mfma_f32_16x16x32_bf16 v[44:47], v[76:79], v[108:111], v[44:47]
    s_waitcnt lgkmcnt(0)
    ds_read_b64_tr_b16 v[64:65], v5 offset:36864
    ds_read_b64_tr_b16 v[66:67], v5 offset:38912
    v_mfma_f32_16x16x32_bf16 v[16:19], v[48:51], v[112:115], v[16:19]
    ds_read_b64_tr_b16 v[68:69], v6 offset:36864
    v_mfma_f32_16x16x32_bf16 v[32:35], v[48:51], v[116:119], v[32:35]
    ds_read_b64_tr_b16 v[70:71], v6 offset:38912
    buffer_load_dwordx4 v[96:99], v9, s[16:19], s31 offen offset:0
    v_mfma_f32_16x16x32_bf16 v[20:23], v[52:55], v[112:115], v[20:23]
    buffer_load_dwordx4 v[100:103], v10, s[16:19], s31 offen offset:0
    v_mfma_f32_16x16x32_bf16 v[36:39], v[52:55], v[116:119], v[36:39]
    ds_read_b64_tr_b16 v[72:73], v7 offset:36864
    ds_read_b64_tr_b16 v[74:75], v7 offset:38912
    v_mfma_f32_16x16x32_bf16 v[24:27], v[56:59], v[112:115], v[24:27]
    ds_read_b64_tr_b16 v[76:77], v8 offset:36864
    v_mfma_f32_16x16x32_bf16 v[40:43], v[56:59], v[116:119], v[40:43]
    ds_read_b64_tr_b16 v[78:79], v8 offset:38912
    buffer_load_dwordx4 v[104:107], v9, s[16:19], s31 offen offset:1024
    v_mfma_f32_16x16x32_bf16 v[28:31], v[60:63], v[112:115], v[28:31]
    buffer_load_dwordx4 v[108:111], v10, s[16:19], s31 offen offset:1024
    s_add_u32 s31, s31, 4096
    v_mfma_f32_16x16x32_bf16 v[44:47], v[60:63], v[116:119], v[44:47]
    s_waitcnt vmcnt(12) lgkmcnt(0)
    s_barrier
    s_add_u32 m0, s34, 32768
    s_nop 0
    buffer_load_dwordx4 v11, s[12:15], s30 offen lds
    ds_read_b64_tr_b16 v[48:49], v5 offset:49152
    v_mfma_f32_16x16x32_bf16 v[16:19], v[64:67], v[120:123], v[16:19]
    ds_read_b64_tr_b16 v[50:51], v5 offset:51200
    v_mfma_f32_16x16x32_bf16 v[32:35], v[64:67], v[124:127], v[32:35]
    ds_read_b64_tr_b16 v[52:53], v6 offset:49152
    v_mfma_f32_16x16x32_bf16 v[20:23], v[68:71], v[120:123], v[20:23]
    ds_read_b64_tr_b16 v[54:55], v6 offset:51200
    v_mfma_f32_16x16x32_bf16 v[36:39], v[68:71], v[124:127], v[36:39]
    s_add_u32 m0, s34, 33792
    s_add_u32 s32, s30, 16384
    buffer_load_dwordx4 v11, s[12:15], s32 offen lds
    s_add_u32 s30, s30, 262144
    ds_read_b64_tr_b16 v[56:57], v7 offset:49152
    v_mfma_f32_16x16x32_bf16 v[24:27], v[72:75], v[120:123], v[24:27]
    ds_read_b64_tr_b16 v[58:59], v7 offset:51200
    v_mfma_f32_16x16x32_bf16 v[40:43], v[72:75], v[124:127], v[40:43]
    ds_read_b64_tr_b16 v[60:61], v8 offset:49152
    v_mfma_f32_16x16x32_bf16 v[28:31], v[76:79], v[120:123], v[28:31]
    ds_read_b64_tr_b16 v[62:63], v8 offset:51200
    v_mfma_f32_16x16x32_bf16 v[44:47], v[76:79], v[124:127], v[44:47]
    s_waitcnt lgkmcnt(0)
    ds_read_b64_tr_b16 v[64:65], v5 offset:53248
    ds_read_b64_tr_b16 v[66:67], v5 offset:55296
    v_mfma_f32_16x16x32_bf16 v[16:19], v[48:51], v[128:131], v[16:19]
    ds_read_b64_tr_b16 v[68:69], v6 offset:53248
    v_mfma_f32_16x16x32_bf16 v[32:35], v[48:51], v[132:135], v[32:35]
    ds_read_b64_tr_b16 v[70:71], v6 offset:55296
    buffer_load_dwordx4 v[112:115], v9, s[16:19], s31 offen offset:0
    v_mfma_f32_16x16x32_bf16 v[20:23], v[52:55], v[128:131], v[20:23]
    buffer_load_dwordx4 v[116:119], v10, s[16:19], s31 offen offset:0
    v_mfma_f32_16x16x32_bf16 v[36:39], v[52:55], v[132:135], v[36:39]
    ds_read_b64_tr_b16 v[72:73], v7 offset:53248
    ds_read_b64_tr_b16 v[74:75], v7 offset:55296
    v_mfma_f32_16x16x32_bf16 v[24:27], v[56:59], v[128:131], v[24:27]
    ds_read_b64_tr_b16 v[76:77], v8 offset:53248
    v_mfma_f32_16x16x32_bf16 v[40:43], v[56:59], v[132:135], v[40:43]
    ds_read_b64_tr_b16 v[78:79], v8 offset:55296
    buffer_load_dwordx4 v[120:123], v9, s[16:19], s31 offen offset:1024
    v_mfma_f32_16x16x32_bf16 v[28:31], v[60:63], v[128:131], v[28:31]
    buffer_load_dwordx4 v[124:127], v10, s[16:19], s31 offen offset:1024
    s_add_u32 s31, s31, 4096
    v_mfma_f32_16x16x32_bf16 v[44:47], v[60:63], v[132:135], v[44:47]
    s_waitcnt vmcnt(12) lgkmcnt(0)
    s_barrier
    s_add_u32 m0, s34, 49152
    s_nop 0
    buffer_load_dwordx4 v11, s[12:15], s30 offen lds
    ds_read_b64_tr_b16 v[48:49], v5 offset:0
    v_mfma_f32_16x16x32_bf16 v[16:19], v[64:67], v[136:139], v[16:19]
    ds_read_b64_tr_b16 v[50:51], v5 offset:2048
    v_mfma_f32_16x16x32_bf16 v[32:35], v[64:67], v[140:143], v[32:35]
    ds_read_b64_tr_b16 v[52:53], v6 offset:0
    v_mfma_f32_16x16x32_bf16 v[20:23], v[68:71], v[136:139], v[20:23]
    ds_read_b64_tr_b16 v[54:55], v6 offset:2048
    v_mfma_f32_16x16x32_bf16 v[36:39], v[68:71], v[140:143], v[36:39]
    s_add_u32 m0, s34, 50176
    s_add_u32 s32, s30, 16384
    buffer_load_dwordx4 v11, s[12:15], s32 offen lds
    s_add_u32 s30, s30, 262144
    ds_read_b64_tr_b16 v[56:57], v7 offset:0
    v_mfma_f32_16x16x32_bf16 v[24:27], v[72:75], v[136:139], v[24:27]
    ds_read_b64_tr_b16 v[58:59], v7 offset:2048
    v_mfma_f32_16x16x32_bf16 v[40:43], v[72:75], v[140:143], v[40:43]
    ds_read_b64_tr_b16 v[60:61], v8 offset:0
    v_mfma_f32_16x16x32_bf16 v[28:31], v[76:79], v[136:139], v[28:31]
    ds_read_b64_tr_b16 v[62:63], v8 offset:2048
    v_mfma_f32_16x16x32_bf16 v[44:47], v[76:79], v[140:143], v[44:47]
    s_waitcnt lgkmcnt(0)
    s_mov_b32 s29, 5
K2_LOOP:
    ds_read_b64_tr_b16 v[64:65], v5 offset:4096
    ds_read_b64_tr_b16 v[66:67], v5 offset:6144
    v_mfma_f32_16x16x32_bf16 v[16:19], v[48:51], v[80:83], v[16:19]
    ds_read_b64_tr_b16 v[68:69], v6 offset:4096
    v_mfma_f32_16x16x32_bf16 v[32:35], v[48:51], v[84:87], v[32:35]
    ds_read_b64_tr_b16 v[70:71], v6 offset:6144
    buffer_load_dwordx4 v[128:131], v9, s[16:19], s31 offen offset:0
    v_mfma_f32_16x16x32_bf16 v[20:23], v[52:55], v[80:83], v[20:23]
    buffer_load_dwordx4 v[132:135], v10, s[16:19], s31 offen offset:0
    v_mfma_f32_16x16x32_bf16 v[36:39], v[52:55], v[84:87], v[36:39]
    ds_read_b64_tr_b16 v[72:73], v7 offset:4096
    ds_read_b64_tr_b16 v[74:75], v7 offset:6144
    v_mfma_f32_16x16x32_bf16 v[24:27], v[56:59], v[80:83], v[24:27]
    ds_read_b64_tr_b16 v[76:77], v8 offset:4096
    v_mfma_f32_16x16x32_bf16 v[40:43], v[56:59], v[84:87], v[40:43]
    ds_read_b64_tr_b16 v[78:79], v8 offset:6144
    buffer_load_dwordx4 v[136:139], v9, s[16:19], s31 offen offset:1024
    v_mfma_f32_16x16x32_bf16 v[28:31], v[60:63], v[80:83], v[28:31]
    buffer_load_dwordx4 v[140:143], v10, s[16:19], s31 offen offset:1024
    s_add_u32 s31, s31, 4096
    v_mfma_f32_16x16x32_bf16 v[44:47], v[60:63], v[84:87], v[44:47]
    s_waitcnt vmcnt(12) lgkmcnt(0)
    s_barrier
    s_add_u32 m0, s34, 0
    s_nop 0
    buffer_load_dwordx4 v11, s[12:15], s30 offen lds
    ds_read_b64_tr_b16 v[48:49], v5 offset:16384
    v_mfma_f32_16x16x32_bf16 v[16:19], v[64:67], v[88:91], v[16:19]
    ds_read_b64_tr_b16 v[50:51], v5 offset:18432
    v_mfma_f32_16x16x32_bf16 v[32:35], v[64:67], v[92:95], v[32:35]
    ds_read_b64_tr_b16 v[52:53], v6 offset:16384
    v_mfma_f32_16x16x32_bf16 v[20:23], v[68:71], v[88:91], v[20:23]
    ds_read_b64_tr_b16 v[54:55], v6 offset:18432
    v_mfma_f32_16x16x32_bf16 v[36:39], v[68:71], v[92:95], v[36:39]
    s_add_u32 m0, s34, 1024
    s_add_u32 s32, s30, 16384
    buffer_load_dwordx4 v11, s[12:15], s32 offen lds
    s_add_u32 s30, s30, 262144
    ds_read_b64_tr_b16 v[56:57], v7 offset:16384
    v_mfma_f32_16x16x32_bf16 v[24:27], v[72:75], v[88:91], v[24:27]
    ds_read_b64_tr_b16 v[58:59], v7 offset:18432
    v_mfma_f32_16x16x32_bf16 v[40:43], v[72:75], v[92:95], v[40:43]
    ds_read_b64_tr_b16 v[60:61], v8 offset:16384
    v_mfma_f32_16x16x32_bf16 v[28:31], v[76:79], v[88:91], v[28:31]
    ds_read_b64_tr_b16 v[62:63], v8 offset:18432
    v_mfma_f32_16x16x32_bf16 v[44:47], v[76:79], v[92:95], v[44:47]
    s_waitcnt lgkmcnt(0)
    ds_read_b64_tr_b16 v[64:65], v5 offset:20480
    ds_read_b64_tr_b16 v[66:67], v5 offset:22528
    v_mfma_f32_16x16x32_bf16 v[16:19], v[48:51], v[96:99], v[16:19]
    ds_read_b64_tr_b16 v[68:69], v6 offset:20480
    v_mfma_f32_16x16x32_bf16 v[32:35], v[48:51], v[100:103], v[32:35]
    ds_read_b64_tr_b16 v[70:71], v6 offset:22528
    buffer_load_dwordx4 v[80:83], v9, s[16:19], s31 offen offset:0
    v_mfma_f32_16x16x32_bf16 v[20:23], v[52:55], v[96:99], v[20:23]
    buffer_load_dwordx4 v[84:87], v10, s[16:19], s31 offen offset:0
    v_mfma_f32_16x16x32_bf16 v[36:39], v[52:55], v[100:103], v[36:39]
    ds_read_b64_tr_b16 v[72:73], v7 offset:20480
    ds_read_b64_tr_b16 v[74:75], v7 offset:22528
    v_mfma_f32_16x16x32_bf16 v[24:27], v[56:59], v[96:99], v[24:27]
    ds_read_b64_tr_b16 v[76:77], v8 offset:20480
    v_mfma_f32_16x16x32_bf16 v[40:43], v[56:59], v[100:103], v[40:43]
    ds_read_b64_tr_b16 v[78:79], v8 offset:22528
    buffer_load_dwordx4 v[88:91], v9, s[16:19], s31 offen offset:1024
    v_mfma_f32_16x16x32_bf16 v[28:31], v[60:63], v[96:99], v[28:31]
    buffer_load_dwordx4 v[92:95], v10, s[16:19], s31 offen offset:1024
    s_add_u32 s31, s31, 4096
    v_mfma_f32_16x16x32_bf16 v[44:47], v[60:63], v[100:103], v[44:47]
    s_waitcnt vmcnt(12) lgkmcnt(0)
    s_barrier
    s_add_u32 m0, s34, 16384
    s_nop 0
    buffer_load_dwordx4 v11, s[12:15], s30 offen lds
    ds_read_b64_tr_b16 v[48:49], v5 offset:32768
    v_mfma_f32_16x16x32_bf16 v[16:19], v[64:67], v[104:107], v[16:19]
    ds_read_b64_tr_b16 v[50:51], v5 offset:34816
    v_mfma_f32_16x16x32_bf16 v[32:35], v[64:67], v[108:111], v[32:35]
    ds_read_b64_tr_b16 v[52:53], v6 offset:32768
    v_mfma_f32_16x16x32_bf16 v[20:23], v[68:71], v[104:107], v[20:23]
    ds_read_b64_tr_b16 v[54:55], v6 offset:34816
    v_mfma_f32_16x16x32_bf16 v[36:39], v[68:71], v[108:111], v[36:39]
    s_add_u32 m0, s34, 17408
    s_add_u32 s32, s30, 16384
    buffer_load_dwordx4 v11, s[12:15], s32 offen lds
    s_add_u32 s30, s30, 262144
    ds_read_b64_tr_b16 v[56:57], v7 offset:32768
    v_mfma_f32_16x16x32_bf16 v[24:27], v[72:75], v[104:107], v[24:27]
    ds_read_b64_tr_b16 v[58:59], v7 offset:34816
    v_mfma_f32_16x16x32_bf16 v[40:43], v[72:75], v[108:111], v[40:43]
    ds_read_b64_tr_b16 v[60:61], v8 offset:32768
    v_mfma_f32_16x16x32_bf16 v[28:31], v[76:79], v[104:107], v[28:31]
    ds_read_b64_tr_b16 v[62:63], v8 offset:34816
    v_mfma_f32_16x16x32_bf16 v[44:47], v[76:79], v[108:111], v[44:47]
    s_waitcnt lgkmcnt(0)
    ds_read_b64_tr_b16 v[64:65], v5 offset:36864
    ds_read_b64_tr_b16 v[66:67], v5 offset:38912
    v_mfma_f32_16x16x32_bf16 v[16:19], v[48:51], v[112:115], v[16:19]
    ds_read_b64_tr_b16 v[68:69], v6 offset:36864
    v_mfma_f32_16x16x32_bf16 v[32:35], v[48:51], v[116:119], v[32:35]
    ds_read_b64_tr_b16 v[70:71], v6 offset:38912
    buffer_load_dwordx4 v[96:99], v9, s[16:19], s31 offen offset:0
    v_mfma_f32_16x16x32_bf16 v[20:23], v[52:55], v[112:115], v[20:23]
    buffer_load_dwordx4 v[100:103], v10, s[16:19], s31 offen offset:0
    v_mfma_f32_16x16x32_bf16 v[36:39], v[52:55], v[116:119], v[36:39]
    ds_read_b64_tr_b16 v[72:73], v7 offset:36864
    ds_read_b64_tr_b16 v[74:75], v7 offset:38912
    v_mfma_f32_16x16x32_bf16 v[24:27], v[56:59], v[112:115], v[24:27]
    ds_read_b64_tr_b16 v[76:77], v8 offset:36864
    v_mfma_f32_16x16x32_bf16 v[40:43], v[56:59], v[116:119], v[40:43]
    ds_read_b64_tr_b16 v[78:79], v8 offset:38912
    buffer_load_dwordx4 v[104:107], v9, s[16:19], s31 offen offset:1024
    v_mfma_f32_16x16x32_bf16 v[28:31], v[60:63], v[112:115], v[28:31]
    buffer_load_dwordx4 v[108:111], v10, s[16:19], s31 offen offset:1024
    s_add_u32 s31, s31, 4096
    v_mfma_f32_16x16x32_bf16 v[44:47], v[60:63], v[116:119], v[44:47]
    s_waitcnt vmcnt(12) lgkmcnt(0)
    s_barrier
    s_add_u32 m0, s34, 32768
    s_nop 0
    buffer_load_dwordx4 v11, s[12:15], s30 offen lds
    ds_read_b64_tr_b16 v[48:49], v5 offset:49152
    v_mfma_f32_16x16x32_bf16 v[16:19], v[64:67], v[120:123], v[16:19]
    ds_read_b64_tr_b16 v[50:51], v5 offset:51200
    v_mfma_f32_16x16x32_bf16 v[32:35], v[64:67], v[124:127], v[32:35]
    ds_read_b64_tr_b16 v[52:53], v6 offset:49152
    v_mfma_f32_16x16x32_bf16 v[20:23], v[68:71], v[120:123], v[20:23]
    ds_read_b64_tr_b16 v[54:55], v6 offset:51200
    v_mfma_f32_16x16x32_bf16 v[36:39], v[68:71], v[124:127], v[36:39]
    s_add_u32 m0, s34, 33792
    s_add_u32 s32, s30, 16384
    buffer_load_dwordx4 v11, s[12:15], s32 offen lds
    s_add_u32 s30, s30, 262144
    ds_read_b64_tr_b16 v[56:57], v7 offset:49152
    v_mfma_f32_16x16x32_bf16 v[24:27], v[72:75], v[120:123], v[24:27]
    ds_read_b64_tr_b16 v[58:59], v7 offset:51200
    v_mfma_f32_16x16x32_bf16 v[40:43], v[72:75], v[124:127], v[40:43]
    ds_read_b64_tr_b16 v[60:61], v8 offset:49152
    v_mfma_f32_16x16x32_bf16 v[28:31], v[76:79], v[120:123], v[28:31]
    ds_read_b64_tr_b16 v[62:63], v8 offset:51200
    v_mfma_f32_16x16x32_bf16 v[44:47], v[76:79], v[124:127], v[44:47]
    s_waitcnt lgkmcnt(0)
    ds_read_b64_tr_b16 v[64:65], v5 offset:53248
    ds_read_b64_tr_b16 v[66:67], v5 offset:55296
    v_mfma_f32_16x16x32_bf16 v[16:19], v[48:51], v[128:131], v[16:19]
    ds_read_b64_tr_b16 v[68:69], v6 offset:53248
    v_mfma_f32_16x16x32_bf16 v[32:35], v[48:51], v[132:135], v[32:35]
    ds_read_b64_tr_b16 v[70:71], v6 offset:55296
    buffer_load_dwordx4 v[112:115], v9, s[16:19], s31 offen offset:0
    v_mfma_f32_16x16x32_bf16 v[20:23], v[52:55], v[128:131], v[20:23]
    buffer_load_dwordx4 v[116:119], v10, s[16:19], s31 offen offset:0
    v_mfma_f32_16x16x32_bf16 v[36:39], v[52:55], v[132:135], v[36:39]
    ds_read_b64_tr_b16 v[72:73], v7 offset:53248
    ds_read_b64_tr_b16 v[74:75], v7 offset:55296
    v_mfma_f32_16x16x32_bf16 v[24:27], v[56:59], v[128:131], v[24:27]
    ds_read_b64_tr_b16 v[76:77], v8 offset:53248
    v_mfma_f32_16x16x32_bf16 v[40:43], v[56:59], v[132:135], v[40:43]
    ds_read_b64_tr_b16 v[78:79], v8 offset:55296
    buffer_load_dwordx4 v[120:123], v9, s[16:19], s31 offen offset:1024
    v_mfma_f32_16x16x32_bf16 v[28:31], v[60:63], v[128:131], v[28:31]
    buffer_load_dwordx4 v[124:127], v10, s[16:19], s31 offen offset:1024
    s_add_u32 s31, s31, 4096
    v_mfma_f32_16x16x32_bf16 v[44:47], v[60:63], v[132:135], v[44:47]
    s_waitcnt vmcnt(12) lgkmcnt(0)
    s_barrier
    s_add_u32 m0, s34, 49152
    s_nop 0
    buffer_load_dwordx4 v11, s[12:15], s30 offen lds
    ds_read_b64_tr_b16 v[48:49], v5 offset:0
    v_mfma_f32_16x16x32_bf16 v[16:19], v[64:67], v[136:139], v[16:19]
    ds_read_b64_tr_b16 v[50:51], v5 offset:2048
    v_mfma_f32_16x16x32_bf16 v[32:35], v[64:67], v[140:143], v[32:35]
    ds_read_b64_tr_b16 v[52:53], v6 offset:0
    v_mfma_f32_16x16x32_bf16 v[20:23], v[68:71], v[136:139], v[20:23]
    ds_read_b64_tr_b16 v[54:55], v6 offset:2048
    v_mfma_f32_16x16x32_bf16 v[36:39], v[68:71], v[140:143], v[36:39]
    s_add_u32 m0, s34, 50176
    s_add_u32 s32, s30, 16384
    buffer_load_dwordx4 v11, s[12:15], s32 offen lds
    s_add_u32 s30, s30, 262144
    ds_read_b64_tr_b16 v[56:57], v7 offset:0
    v_mfma_f32_16x16x32_bf16 v[24:27], v[72:75], v[136:139], v[24:27]
    ds_read_b64_tr_b16 v[58:59], v7 offset:2048
    v_mfma_f32_16x16x32_bf16 v[40:43], v[72:75], v[140:143], v[40:43]
    ds_read_b64_tr_b16 v[60:61], v8 offset:0
    v_mfma_f32_16x16x32_bf16 v[28:31], v[76:79], v[136:139], v[28:31]
    ds_read_b64_tr_b16 v[62:63], v8 offset:2048
    v_mfma_f32_16x16x32_bf16 v[44:47], v[76:79], v[140:143], v[44:47]
    s_waitcnt lgkmcnt(0)
    s_sub_u32 s29, s29, 1
    s_cmp_lg_u32 s29, 0
    s_cbranch_scc1 K2_LOOP
    ds_read_b64_tr_b16 v[64:65], v5 offset:4096
    ds_read_b64_tr_b16 v[66:67], v5 offset:6144
    v_mfma_f32_16x16x32_bf16 v[16:19], v[48:51], v[80:83], v[16:19]
    ds_read_b64_tr_b16 v[68:69], v6 offset:4096
    v_mfma_f32_16x16x32_bf16 v[32:35], v[48:51], v[84:87], v[32:35]
    ds_read_b64_tr_b16 v[70:71], v6 offset:6144
    buffer_load_dwordx4 v[128:131], v9, s[16:19], s31 offen offset:0
    v_mfma_f32_16x16x32_bf16 v[20:23], v[52:55], v[80:83], v[20:23]
    buffer_load_dwordx4 v[132:135], v10, s[16:19], s31 offen offset:0
    v_mfma_f32_16x16x32_bf16 v[36:39], v[52:55], v[84:87], v[36:39]
    ds_read_b64_tr_b16 v[72:73], v7 offset:4096
    ds_read_b64_tr_b16 v[74:75], v7 offset:6144
    v_mfma_f32_16x16x32_bf16 v[24:27], v[56:59], v[80:83], v[24:27]
    ds_read_b64_tr_b16 v[76:77], v8 offset:4096
    v_mfma_f32_16x16x32_bf16 v[40:43], v[56:59], v[84:87], v[40:43]
    ds_read_b64_tr_b16 v[78:79], v8 offset:6144
    buffer_load_dwordx4 v[136:139], v9, s[16:19], s31 offen offset:1024
    v_mfma_f32_16x16x32_bf16 v[28:31], v[60:63], v[80:83], v[28:31]
    buffer_load_dwordx4 v[140:143], v10, s[16:19], s31 offen offset:1024
    s_add_u32 s31, s31, 4096
    v_mfma_f32_16x16x32_bf16 v[44:47], v[60:63], v[84:87], v[44:47]
    s_waitcnt vmcnt(12) lgkmcnt(0)
    s_barrier
    ds_read_b64_tr_b16 v[48:49], v5 offset:16384
    v_mfma_f32_16x16x32_bf16 v[16:19], v[64:67], v[88:91], v[16:19]
    ds_read_b64_tr_b16 v[50:51], v5 offset:18432
    v_mfma_f32_16x16x32_bf16 v[32:35], v[64:67], v[92:95], v[32:35]
    ds_read_b64_tr_b16 v[52:53], v6 offset:16384
    v_mfma_f32_16x16x32_bf16 v[20:23], v[68:71], v[88:91], v[20:23]
    ds_read_b64_tr_b16 v[54:55], v6 offset:18432
    v_mfma_f32_16x16x32_bf16 v[36:39], v[68:71], v[92:95], v[36:39]
    ds_read_b64_tr_b16 v[56:57], v7 offset:16384
    v_mfma_f32_16x16x32_bf16 v[24:27], v[72:75], v[88:91], v[24:27]
    ds_read_b64_tr_b16 v[58:59], v7 offset:18432
    v_mfma_f32_16x16x32_bf16 v[40:43], v[72:75], v[92:95], v[40:43]
    ds_read_b64_tr_b16 v[60:61], v8 offset:16384
    v_mfma_f32_16x16x32_bf16 v[28:31], v[76:79], v[88:91], v[28:31]
    ds_read_b64_tr_b16 v[62:63], v8 offset:18432
    v_mfma_f32_16x16x32_bf16 v[44:47], v[76:79], v[92:95], v[44:47]
    s_waitcnt lgkmcnt(0)
    ds_read_b64_tr_b16 v[64:65], v5 offset:20480
    v_mfma_f32_16x16x32_bf16 v[16:19], v[48:51], v[96:99], v[16:19]
    ds_read_b64_tr_b16 v[66:67], v5 offset:22528
    v_mfma_f32_16x16x32_bf16 v[32:35], v[48:51], v[100:103], v[32:35]
    ds_read_b64_tr_b16 v[68:69], v6 offset:20480
    v_mfma_f32_16x16x32_bf16 v[20:23], v[52:55], v[96:99], v[20:23]
    ds_read_b64_tr_b16 v[70:71], v6 offset:22528
    v_mfma_f32_16x16x32_bf16 v[36:39], v[52:55], v[100:103], v[36:39]
    ds_read_b64_tr_b16 v[72:73], v7 offset:20480
    v_mfma_f32_16x16x32_bf16 v[24:27], v[56:59], v[96:99], v[24:27]
    ds_read_b64_tr_b16 v[74:75], v7 offset:22528
    v_mfma_f32_16x16x32_bf16 v[40:43], v[56:59], v[100:103], v[40:43]
    ds_read_b64_tr_b16 v[76:77], v8 offset:20480
    v_mfma_f32_16x16x32_bf16 v[28:31], v[60:63], v[96:99], v[28:31]
    ds_read_b64_tr_b16 v[78:79], v8 offset:22528
    v_mfma_f32_16x16x32_bf16 v[44:47], v[60:63], v[100:103], v[44:47]
    s_waitcnt vmcnt(6) lgkmcnt(0)
    s_barrier
    ds_read_b64_tr_b16 v[48:49], v5 offset:32768
    v_mfma_f32_16x16x32_bf16 v[16:19], v[64:67], v[104:107], v[16:19]
    ds_read_b64_tr_b16 v[50:51], v5 offset:34816
    v_mfma_f32_16x16x32_bf16 v[32:35], v[64:67], v[108:111], v[32:35]
    ds_read_b64_tr_b16 v[52:53], v6 offset:32768
    v_mfma_f32_16x16x32_bf16 v[20:23], v[68:71], v[104:107], v[20:23]
    ds_read_b64_tr_b16 v[54:55], v6 offset:34816
    v_mfma_f32_16x16x32_bf16 v[36:39], v[68:71], v[108:111], v[36:39]
    ds_read_b64_tr_b16 v[56:57], v7 offset:32768
    v_mfma_f32_16x16x32_bf16 v[24:27], v[72:75], v[104:107], v[24:27]
    ds_read_b64_tr_b16 v[58:59], v7 offset:34816
    v_mfma_f32_16x16x32_bf16 v[40:43], v[72:75], v[108:111], v[40:43]
    ds_read_b64_tr_b16 v[60:61], v8 offset:32768
    v_mfma_f32_16x16x32_bf16 v[28:31], v[76:79], v[104:107], v[28:31]
    ds_read_b64_tr_b16 v[62:63], v8 offset:34816
    v_mfma_f32_16x16x32_bf16 v[44:47], v[76:79], v[108:111], v[44:47]
    s_waitcnt lgkmcnt(0)
    ds_read_b64_tr_b16 v[64:65], v5 offset:36864
    v_mfma_f32_16x16x32_bf16 v[16:19], v[48:51], v[112:115], v[16:19]
    ds_read_b64_tr_b16 v[66:67], v5 offset:38912
    v_mfma_f32_16x16x32_bf16 v[32:35], v[48:51], v[116:119], v[32:35]
    ds_read_b64_tr_b16 v[68:69], v6 offset:36864
    v_mfma_f32_16x16x32_bf16 v[20:23], v[52:55], v[112:115], v[20:23]
    ds_read_b64_tr_b16 v[70:71], v6 offset:38912
    v_mfma_f32_16x16x32_bf16 v[36:39], v[52:55], v[116:119], v[36:39]
    ds_read_b64_tr_b16 v[72:73], v7 offset:36864
    v_mfma_f32_16x16x32_bf16 v[24:27], v[56:59], v[112:115], v[24:27]
    ds_read_b64_tr_b16 v[74:75], v7 offset:38912
    v_mfma_f32_16x16x32_bf16 v[40:43], v[56:59], v[116:119], v[40:43]
    ds_read_b64_tr_b16 v[76:77], v8 offset:36864
    v_mfma_f32_16x16x32_bf16 v[28:31], v[60:63], v[112:115], v[28:31]
    ds_read_b64_tr_b16 v[78:79], v8 offset:38912
    v_mfma_f32_16x16x32_bf16 v[44:47], v[60:63], v[116:119], v[44:47]
    s_waitcnt vmcnt(0) lgkmcnt(0)
    s_barrier
    ds_read_b64_tr_b16 v[48:49], v5 offset:49152
    v_mfma_f32_16x16x32_bf16 v[16:19], v[64:67], v[120:123], v[16:19]
    ds_read_b64_tr_b16 v[50:51], v5 offset:51200
    v_mfma_f32_16x16x32_bf16 v[32:35], v[64:67], v[124:127], v[32:35]
    ds_read_b64_tr_b16 v[52:53], v6 offset:49152
    v_mfma_f32_16x16x32_bf16 v[20:23], v[68:71], v[120:123], v[20:23]
    ds_read_b64_tr_b16 v[54:55], v6 offset:51200
    v_mfma_f32_16x16x32_bf16 v[36:39], v[68:71], v[124:127], v[36:39]
    ds_read_b64_tr_b16 v[56:57], v7 offset:49152
    v_mfma_f32_16x16x32_bf16 v[24:27], v[72:75], v[120:123], v[24:27]
    ds_read_b64_tr_b16 v[58:59], v7 offset:51200
    v_mfma_f32_16x16x32_bf16 v[40:43], v[72:75], v[124:127], v[40:43]
    ds_read_b64_tr_b16 v[60:61], v8 offset:49152
    v_mfma_f32_16x16x32_bf16 v[28:31], v[76:79], v[120:123], v[28:31]
    ds_read_b64_tr_b16 v[62:63], v8 offset:51200
    v_mfma_f32_16x16x32_bf16 v[44:47], v[76:79], v[124:127], v[44:47]
    s_waitcnt lgkmcnt(0)
    ds_read_b64_tr_b16 v[64:65], v5 offset:53248
    v_mfma_f32_16x16x32_bf16 v[16:19], v[48:51], v[128:131], v[16:19]
    ds_read_b64_tr_b16 v[66:67], v5 offset:55296
    v_mfma_f32_16x16x32_bf16 v[32:35], v[48:51], v[132:135], v[32:35]
    ds_read_b64_tr_b16 v[68:69], v6 offset:53248
    v_mfma_f32_16x16x32_bf16 v[20:23], v[52:55], v[128:131], v[20:23]
    ds_read_b64_tr_b16 v[70:71], v6 offset:55296
    v_mfma_f32_16x16x32_bf16 v[36:39], v[52:55], v[132:135], v[36:39]
    ds_read_b64_tr_b16 v[72:73], v7 offset:53248
    v_mfma_f32_16x16x32_bf16 v[24:27], v[56:59], v[128:131], v[24:27]
    ds_read_b64_tr_b16 v[74:75], v7 offset:55296
    v_mfma_f32_16x16x32_bf16 v[40:43], v[56:59], v[132:135], v[40:43]
    ds_read_b64_tr_b16 v[76:77], v8 offset:53248
    v_mfma_f32_16x16x32_bf16 v[28:31], v[60:63], v[128:131], v[28:31]
    ds_read_b64_tr_b16 v[78:79], v8 offset:55296
    v_mfma_f32_16x16x32_bf16 v[44:47], v[60:63], v[132:135], v[44:47]
    s_waitcnt lgkmcnt(0)
    v_mfma_f32_16x16x32_bf16 v[16:19], v[64:67], v[136:139], v[16:19]
    v_mfma_f32_16x16x32_bf16 v[32:35], v[64:67], v[140:143], v[32:35]
    v_mfma_f32_16x16x32_bf16 v[20:23], v[68:71], v[136:139], v[20:23]
    v_mfma_f32_16x16x32_bf16 v[36:39], v[68:71], v[140:143], v[36:39]
    v_mfma_f32_16x16x32_bf16 v[24:27], v[72:75], v[136:139], v[24:27]
    v_mfma_f32_16x16x32_bf16 v[40:43], v[72:75], v[140:143], v[40:43]
    v_mfma_f32_16x16x32_bf16 v[28:31], v[76:79], v[136:139], v[28:31]
    v_mfma_f32_16x16x32_bf16 v[44:47], v[76:79], v[140:143], v[44:47]
    s_nop 7
    s_nop 7
    s_barrier

    s_lshl_b32 s32, s24, 12
    v_lshlrev_b32 v12, 4, v2
    v_add_u32 v13, s32, v12
    s_xor_b32 s32, s24, 4
    s_lshl_b32 s32, s32, 12
    v_add_u32 v14, s32, v12
    s_cmp_eq_u32 s26, 0
    s_cbranch_scc0 K2_S1

    ds_write_b128 v13, v[32:35] offset:0
    ds_write_b128 v13, v[36:39] offset:1024
    ds_write_b128 v13, v[40:43] offset:2048
    ds_write_b128 v13, v[44:47] offset:3072
    s_waitcnt lgkmcnt(0)
    s_barrier
    ds_read_b128 v[48:51], v14 offset:0
    ds_read_b128 v[52:55], v14 offset:1024
    ds_read_b128 v[56:59], v14 offset:2048
    ds_read_b128 v[60:63], v14 offset:3072
    s_waitcnt lgkmcnt(0)
    v_add_f32 v64, v16, v48
    v_add_f32 v65, v17, v49
    v_add_f32 v66, v18, v50
    v_add_f32 v67, v19, v51
    v_add_f32 v68, v20, v52
    v_add_f32 v69, v21, v53
    v_add_f32 v70, v22, v54
    v_add_f32 v71, v23, v55
    v_add_f32 v72, v24, v56
    v_add_f32 v73, v25, v57
    v_add_f32 v74, v26, v58
    v_add_f32 v75, v27, v59
    v_add_f32 v76, v28, v60
    v_add_f32 v77, v29, v61
    v_add_f32 v78, v30, v62
    v_add_f32 v79, v31, v63
    s_branch K2_FIN
K2_S1:
    ds_write_b128 v13, v[16:19] offset:0
    ds_write_b128 v13, v[20:23] offset:1024
    ds_write_b128 v13, v[24:27] offset:2048
    ds_write_b128 v13, v[28:31] offset:3072
    s_waitcnt lgkmcnt(0)
    s_barrier
    ds_read_b128 v[48:51], v14 offset:0
    ds_read_b128 v[52:55], v14 offset:1024
    ds_read_b128 v[56:59], v14 offset:2048
    ds_read_b128 v[60:63], v14 offset:3072
    s_waitcnt lgkmcnt(0)
    v_add_f32 v64, v32, v48
    v_add_f32 v65, v33, v49
    v_add_f32 v66, v34, v50
    v_add_f32 v67, v35, v51
    v_add_f32 v68, v36, v52
    v_add_f32 v69, v37, v53
    v_add_f32 v70, v38, v54
    v_add_f32 v71, v39, v55
    v_add_f32 v72, v40, v56
    v_add_f32 v73, v41, v57
    v_add_f32 v74, v42, v58
    v_add_f32 v75, v43, v59
    v_add_f32 v76, v44, v60
    v_add_f32 v77, v45, v61
    v_add_f32 v78, v46, v62
    v_add_f32 v79, v47, v63
K2_FIN:

    s_lshl_b32 s32, s26, 4
    s_add_u32 s32, s32, s33
    v_add_u32 v12, s32, v3
    v_lshlrev_b32 v12, 11, v12
    v_lshlrev_b32 v13, 3, v4
    v_add_u32 v12, v12, v13
    s_lshl_b32 s32, s28, 7
    v_add_u32 v12, s32, v12

    v_cvt_pk_bf16_f32 v80, v64, v65
    v_cvt_pk_bf16_f32 v81, v66, v67
    buffer_store_dwordx2 v[80:81], v12, s[20:23], 0 offen offset:0
    v_cvt_pk_bf16_f32 v82, v68, v69
    v_cvt_pk_bf16_f32 v83, v70, v71
    buffer_store_dwordx2 v[82:83], v12, s[20:23], 0 offen offset:32
    v_cvt_pk_bf16_f32 v84, v72, v73
    v_cvt_pk_bf16_f32 v85, v74, v75
    buffer_store_dwordx2 v[84:85], v12, s[20:23], 0 offen offset:64
    v_cvt_pk_bf16_f32 v86, v76, v77
    v_cvt_pk_bf16_f32 v87, v78, v79
    buffer_store_dwordx2 v[86:87], v12, s[20:23], 0 offen offset:96
K2_DONE:
    s_endpgm
.section .rodata,"a"
.p2align 6
.amdhsa_kernel k1_kernel
  .amdhsa_next_free_vgpr 256
  .amdhsa_next_free_sgpr 102
  .amdhsa_accum_offset 256
  .amdhsa_group_segment_fixed_size 0
  .amdhsa_kernarg_size 56
  .amdhsa_user_sgpr_count 2
  .amdhsa_user_sgpr_kernarg_segment_ptr 1
  .amdhsa_system_sgpr_workgroup_id_x 1
.end_amdhsa_kernel
```
